```python
import torch

def _softmax(x, axis=-1):
    return torch.softmax(x, dim=axis)

def _gelu(x):
    return torch.nn.functional.gelu(x, approximate='tanh')

def _silu(x):
    return torch.nn.functional.silu(x)

def _sigmoid(x):
    return torch.sigmoid(x)

def _layernorm(x, axis=-1, eps=1e-05):
    m = x.mean(dim=axis, keepdim=True)
    v = x.var(dim=axis, keepdim=True, unbiased=False)
    return (x - m) / torch.sqrt(v + eps)

def _scatter_add(tgt, idx, src, axis=0):
    return tgt.clone().index_add_(axis, idx, src)

def _segment_sum(src, seg, n):
    out = torch.zeros((n,) + src.shape[1:], dtype=src.dtype)
    return out.index_add_(0, seg, src)

def _pad(x, pw):
    flat = tuple((v for pair in reversed(pw) for v in pair))
    return torch.nn.functional.pad(x, flat)
kernel_name = 'parallel_sum__memory_aug_recurrent_mem_tr__glu_gated_glu__prompt'

def setup_inputs():

    _w = lambda a: (lambda t: t.to(torch.bfloat16) if t.is_floating_point() else t)(torch.as_tensor(a))

    def _A_setup():
        B, S, Dm = (1, 2048, 640)
        H, Dh = (32, 128)
        M, seg = (8, 32)
        seg = min(seg, S)
        S = S // seg * seg
        return {'x': _w((lambda *s: torch.randn(*s, dtype=torch.bfloat16) * 0.05)(B, S, Dm)), 'mem0': _w((lambda *s: torch.randn(*s, dtype=torch.bfloat16) * 1.6)(B, M, Dm)), 'Wq': _w((lambda *s: torch.randn(*s, dtype=torch.bfloat16) * 0.8)(Dm, H, Dh) * Dm ** (-0.5)), 'Wk': _w((lambda *s: torch.randn(*s, dtype=torch.bfloat16) * 0.8)(Dm, H, Dh) * Dm ** (-0.5)), 'Wv': _w((lambda *s: torch.randn(*s, dtype=torch.bfloat16) * 1.6)(Dm, H, Dh) * Dm ** (-0.5)), 'Wo': _w((lambda *s: torch.randn(*s, dtype=torch.bfloat16) * 1.6)(H, Dh, Dm) * (H * Dh) ** (-0.5)), 'seg_len': seg}
    _A_in = _A_setup()

    def _B_setup():
        B, S, D, F = (1, 2048, 640, 1728)
        return {'x': _w((lambda *s: torch.randn(*s, dtype=torch.bfloat16) * 0.05)(B, S, D)), 'w_gate': _w((lambda *s: torch.randn(*s, dtype=torch.bfloat16) * 0.05)(D, F)), 'w_up': _w((lambda *s: torch.randn(*s, dtype=torch.bfloat16) * 0.05)(D, F)), 'w_down': _w((lambda *s: torch.randn(*s, dtype=torch.bfloat16) * 0.05)(F, D))}
    _B_in = _B_setup()
    return {'A_x': _A_in['x'], 'A_mem0': _A_in['mem0'], 'A_Wq': _A_in['Wq'], 'A_Wk': _A_in['Wk'], 'A_Wv': _A_in['Wv'], 'A_Wo': _A_in['Wo'], 'A_seg_len': _A_in['seg_len'], 'B_x': _B_in['x'], 'B_w_gate': _B_in['w_gate'], 'B_w_up': _B_in['w_up'], 'B_w_down': _B_in['w_down']}

def reference(A_x, A_mem0, A_Wq, A_Wk, A_Wv, A_Wo, A_seg_len, B_x, B_w_gate, B_w_up, B_w_down):

    def _A_ref(x, mem0, Wq, Wk, Wv, Wo, seg_len):
        B, S, Dm = x.shape
        H, Dh = (Wq.shape[1], Wq.shape[2])
        M = mem0.shape[1]
        scale = Dh ** (-0.5)
        n_seg = S // seg_len
        L = M + seg_len
        idx = torch.arange(L)
        mask = (idx[:, None] < M) | (idx[:, None] >= idx[None, :])
        mem = mem0
        outs = []
        for s in range(n_seg):
            xs = x[:, s * seg_len:(s + 1) * seg_len, :].clone()
            h = torch.concatenate([mem, xs], axis=1)
            q = torch.einsum('btd,dhe->bhte', h, Wq)
            k = torch.einsum('btd,dhe->bhte', h, Wk)
            v = torch.einsum('btd,dhe->bhte', h, Wv)
            scores = torch.einsum('bhqe,bhke->bhqk', q, k) * scale
            scores = torch.where(mask[None, None], scores, -1000000000.0)
            p = _softmax(scores, axis=-1)
            o = torch.einsum('bhqk,bhke->bhqe', p, v)
            o = torch.einsum('bhte,hed->btd', o, Wo)
            mem = o[:, :M, :].clone()
            outs.append(o[:, M:, :])
        return torch.concatenate(outs, axis=1)

    def _B_ref(x, w_gate, w_up, w_down):
        g = torch.einsum('bsd,df->bsf', x, w_gate)
        u = torch.einsum('bsd,df->bsf', x, w_up)
        h = _sigmoid(g) * u
        return torch.einsum('bsf,fd->bsd', h, w_down)
    x = A_x
    xn = _layernorm(x, axis=-1)
    return x + _A_ref(xn, A_mem0, A_Wq, A_Wk, A_Wv, A_Wo, A_seg_len) + _B_ref(xn, B_w_gate, B_w_up, B_w_down)
```

```asm
; @launch grid=(256,1,1) block=(256,1,1) lds=163840
.amdgcn_target "amdgcn-amd-amdhsa--gfx950"
.text
.globl parallel_sum__memory_aug_recurrent_mem_tr__glu_gated_glu__prompt_kernel
.p2align 8
.type parallel_sum__memory_aug_recurrent_mem_tr__glu_gated_glu__prompt_kernel,@function
parallel_sum__memory_aug_recurrent_mem_tr__glu_gated_glu__prompt_kernel:
    s_cmp_ge_u32 s2, 256
    s_cbranch_scc1 L_exit
    s_and_b32 s3, s2, 7
    s_lshl_b32 s3, s3, 2
    s_lshr_b32 s3, 1985220658, s3
    s_and_b32 s3, s3, 7
    s_andn2_b32 s2, s2, 7
    s_or_b32 s2, s2, s3
    s_load_dwordx16 s[4:19], s[0:1], 0
    s_load_dwordx8 s[20:27], s[0:1], 64
    s_load_dwordx4 s[28:31], s[0:1], 96
    s_waitcnt lgkmcnt(0)
    s_mov_b32 s32, s30
    s_mov_b32 s33, s31
    s_mov_b32 s34, 98631680
    s_mov_b32 s35, 0x20000
    s_and_b32 s40, s2, 7
    s_lshr_b32 s41, s2, 3
    s_cmp_lt_u32 s40, 2
    s_cbranch_scc1 L_chain
    s_getpc_b64 s[92:93]
L_pc:
    s_lshl_b32 s3, s2, 7
    s_add_u32 s3, s3, L_table-L_pc
    s_add_u32 s92, s92, s3
    s_addc_u32 s93, s93, 0
    s_load_dwordx2 s[100:101], s[92:93], 0
    s_load_dwordx16 s[64:79], s[92:93], 16
    s_load_dwordx4 s[80:83], s[92:93], 80
    s_mov_b32 s99, 400000
    v_lshrrev_b32 v1, 6, v0
    v_and_b32 v9, 63, v0
    v_readfirstlane_b32 s51, v1
    s_waitcnt lgkmcnt(0)
    s_bfe_u32 s54, s100, 0x80010
    s_cmp_eq_u32 s54, 3
    s_cbranch_scc1 L_probe
    s_lshr_b32 s52, s64, 24
    s_bfe_u32 s61, s100, 0x80008
    s_cmp_eq_u32 s61, 255
    s_cbranch_scc1 L_noln
    s_mov_b32 s84, s4
    s_mov_b32 s85, s5
    s_mov_b32 s86, 2621440
    s_mov_b32 s87, 0x20000
    v_and_b32 v2, 63, v0
    v_and_b32 v3, 7, v2
    v_lshrrev_b32 v4, 3, v2
    s_lshl_b32 s88, s61, 5
    s_lshl_b32 s89, s51, 3
    s_add_u32 s88, s88, s89
    v_add_u32 v5, s88, v3
    s_mov_b32 s90, 1280
    v_mul_lo_u32 v5, v5, s90
    v_lshrrev_b32 v6, 1, v4
    v_lshl_add_u32 v5, v6, 6, v5
    v_and_b32 v6, 1, v4
    v_lshl_add_u32 v5, v6, 4, v5
    buffer_load_dwordx4 v[16:19], v5, s[84:87], 0 offen offset:0
    buffer_load_dwordx4 v[20:23], v5, s[84:87], 0 offen offset:32
    buffer_load_dwordx4 v[24:27], v5, s[84:87], 0 offen offset:256
    buffer_load_dwordx4 v[28:31], v5, s[84:87], 0 offen offset:288
    buffer_load_dwordx4 v[32:35], v5, s[84:87], 0 offen offset:512
    buffer_load_dwordx4 v[36:39], v5, s[84:87], 0 offen offset:544
    buffer_load_dwordx4 v[40:43], v5, s[84:87], 0 offen offset:768
    buffer_load_dwordx4 v[44:47], v5, s[84:87], 0 offen offset:800
    buffer_load_dwordx4 v[48:51], v5, s[84:87], 0 offen offset:1024
    buffer_load_dwordx4 v[52:55], v5, s[84:87], 0 offen offset:1056
    v_add_u32 v7, s89, v3
    v_lshlrev_b32 v7, 4, v7
    v_lshl_add_u32 v7, v4, 10, v7
    s_mul_i32 s91, s61, 40960
    s_add_u32 s91, s91, 0
    s_mov_b32 s97, 0xffff0000
    v_mov_b32 v8, 0
    v_mov_b32 v9, 0
    s_waitcnt vmcnt(9)
    v_lshlrev_b32 v64, 16, v16
    v_and_b32 v65, s97, v16
    v_lshlrev_b32 v66, 16, v17
    v_and_b32 v67, s97, v17
    v_lshlrev_b32 v68, 16, v18
    v_and_b32 v69, s97, v18
    v_lshlrev_b32 v70, 16, v19
    v_and_b32 v71, s97, v19
    v_pk_add_f32 v[8:9], v[8:9], v[64:65]
    v_pk_add_f32 v[8:9], v[8:9], v[66:67]
    v_pk_add_f32 v[8:9], v[8:9], v[68:69]
    v_pk_add_f32 v[8:9], v[8:9], v[70:71]
    s_waitcnt vmcnt(8)
    v_lshlrev_b32 v72, 16, v20
    v_and_b32 v73, s97, v20
    v_lshlrev_b32 v74, 16, v21
    v_and_b32 v75, s97, v21
    v_lshlrev_b32 v76, 16, v22
    v_and_b32 v77, s97, v22
    v_lshlrev_b32 v78, 16, v23
    v_and_b32 v79, s97, v23
    v_pk_add_f32 v[8:9], v[8:9], v[72:73]
    v_pk_add_f32 v[8:9], v[8:9], v[74:75]
    v_pk_add_f32 v[8:9], v[8:9], v[76:77]
    v_pk_add_f32 v[8:9], v[8:9], v[78:79]
    s_waitcnt vmcnt(7)
    v_lshlrev_b32 v80, 16, v24
    v_and_b32 v81, s97, v24
    v_lshlrev_b32 v82, 16, v25
    v_and_b32 v83, s97, v25
    v_lshlrev_b32 v84, 16, v26
    v_and_b32 v85, s97, v26
    v_lshlrev_b32 v86, 16, v27
    v_and_b32 v87, s97, v27
    v_pk_add_f32 v[8:9], v[8:9], v[80:81]
    v_pk_add_f32 v[8:9], v[8:9], v[82:83]
    v_pk_add_f32 v[8:9], v[8:9], v[84:85]
    v_pk_add_f32 v[8:9], v[8:9], v[86:87]
    s_waitcnt vmcnt(6)
    v_lshlrev_b32 v88, 16, v28
    v_and_b32 v89, s97, v28
    v_lshlrev_b32 v90, 16, v29
    v_and_b32 v91, s97, v29
    v_lshlrev_b32 v92, 16, v30
    v_and_b32 v93, s97, v30
    v_lshlrev_b32 v94, 16, v31
    v_and_b32 v95, s97, v31
    v_pk_add_f32 v[8:9], v[8:9], v[88:89]
    v_pk_add_f32 v[8:9], v[8:9], v[90:91]
    v_pk_add_f32 v[8:9], v[8:9], v[92:93]
    v_pk_add_f32 v[8:9], v[8:9], v[94:95]
    s_waitcnt vmcnt(5)
    v_lshlrev_b32 v96, 16, v32
    v_and_b32 v97, s97, v32
    v_lshlrev_b32 v98, 16, v33
    v_and_b32 v99, s97, v33
    v_lshlrev_b32 v100, 16, v34
    v_and_b32 v101, s97, v34
    v_lshlrev_b32 v102, 16, v35
    v_and_b32 v103, s97, v35
    v_pk_add_f32 v[8:9], v[8:9], v[96:97]
    v_pk_add_f32 v[8:9], v[8:9], v[98:99]
    v_pk_add_f32 v[8:9], v[8:9], v[100:101]
    v_pk_add_f32 v[8:9], v[8:9], v[102:103]
    s_waitcnt vmcnt(4)
    v_lshlrev_b32 v104, 16, v36
    v_and_b32 v105, s97, v36
    v_lshlrev_b32 v106, 16, v37
    v_and_b32 v107, s97, v37
    v_lshlrev_b32 v108, 16, v38
    v_and_b32 v109, s97, v38
    v_lshlrev_b32 v110, 16, v39
    v_and_b32 v111, s97, v39
    v_pk_add_f32 v[8:9], v[8:9], v[104:105]
    v_pk_add_f32 v[8:9], v[8:9], v[106:107]
    v_pk_add_f32 v[8:9], v[8:9], v[108:109]
    v_pk_add_f32 v[8:9], v[8:9], v[110:111]
    s_waitcnt vmcnt(3)
    v_lshlrev_b32 v112, 16, v40
    v_and_b32 v113, s97, v40
    v_lshlrev_b32 v114, 16, v41
    v_and_b32 v115, s97, v41
    v_lshlrev_b32 v116, 16, v42
    v_and_b32 v117, s97, v42
    v_lshlrev_b32 v118, 16, v43
    v_and_b32 v119, s97, v43
    v_pk_add_f32 v[8:9], v[8:9], v[112:113]
    v_pk_add_f32 v[8:9], v[8:9], v[114:115]
    v_pk_add_f32 v[8:9], v[8:9], v[116:117]
    v_pk_add_f32 v[8:9], v[8:9], v[118:119]
    s_waitcnt vmcnt(2)
    v_lshlrev_b32 v120, 16, v44
    v_and_b32 v121, s97, v44
    v_lshlrev_b32 v122, 16, v45
    v_and_b32 v123, s97, v45
    v_lshlrev_b32 v124, 16, v46
    v_and_b32 v125, s97, v46
    v_lshlrev_b32 v126, 16, v47
    v_and_b32 v127, s97, v47
    v_pk_add_f32 v[8:9], v[8:9], v[120:121]
    v_pk_add_f32 v[8:9], v[8:9], v[122:123]
    v_pk_add_f32 v[8:9], v[8:9], v[124:125]
    v_pk_add_f32 v[8:9], v[8:9], v[126:127]
    s_waitcnt vmcnt(1)
    v_lshlrev_b32 v128, 16, v48
    v_and_b32 v129, s97, v48
    v_lshlrev_b32 v130, 16, v49
    v_and_b32 v131, s97, v49
    v_lshlrev_b32 v132, 16, v50
    v_and_b32 v133, s97, v50
    v_lshlrev_b32 v134, 16, v51
    v_and_b32 v135, s97, v51
    v_pk_add_f32 v[8:9], v[8:9], v[128:129]
    v_pk_add_f32 v[8:9], v[8:9], v[130:131]
    v_pk_add_f32 v[8:9], v[8:9], v[132:133]
    v_pk_add_f32 v[8:9], v[8:9], v[134:135]
    s_waitcnt vmcnt(0)
    v_lshlrev_b32 v136, 16, v52
    v_and_b32 v137, s97, v52
    v_lshlrev_b32 v138, 16, v53
    v_and_b32 v139, s97, v53
    v_lshlrev_b32 v140, 16, v54
    v_and_b32 v141, s97, v54
    v_lshlrev_b32 v142, 16, v55
    v_and_b32 v143, s97, v55
    v_pk_add_f32 v[8:9], v[8:9], v[136:137]
    v_pk_add_f32 v[8:9], v[8:9], v[138:139]
    v_pk_add_f32 v[8:9], v[8:9], v[140:141]
    v_pk_add_f32 v[8:9], v[8:9], v[142:143]
    v_add_f32 v8, v8, v9
    s_nop 1
    v_add_f32_dpp v8, v8, v8 row_ror:8 row_mask:0xf bank_mask:0xf
    v_mov_b32 v9, v8
    s_nop 1
    v_permlane16_swap_b32 v8, v9
    v_add_f32 v8, v8, v9
    v_mov_b32 v9, v8
    s_nop 1
    v_permlane32_swap_b32 v8, v9
    v_add_f32 v8, v8, v9
    s_mov_b32 s98, 0x3acccccd
    v_mul_f32 v8, s98, v8
    v_sub_f32 v10, 0, v8
    v_mov_b32 v11, v10
    v_mov_b32 v12, 0
    v_mov_b32 v13, 0
    v_pk_add_f32 v[14:15], v[64:65], v[10:11]
    v_pk_fma_f32 v[12:13], v[14:15], v[14:15], v[12:13]
    v_pk_add_f32 v[14:15], v[66:67], v[10:11]
    v_pk_fma_f32 v[12:13], v[14:15], v[14:15], v[12:13]
    v_pk_add_f32 v[14:15], v[68:69], v[10:11]
    v_pk_fma_f32 v[12:13], v[14:15], v[14:15], v[12:13]
    v_pk_add_f32 v[14:15], v[70:71], v[10:11]
    v_pk_fma_f32 v[12:13], v[14:15], v[14:15], v[12:13]
    v_pk_add_f32 v[14:15], v[72:73], v[10:11]
    v_pk_fma_f32 v[12:13], v[14:15], v[14:15], v[12:13]
    v_pk_add_f32 v[14:15], v[74:75], v[10:11]
    v_pk_fma_f32 v[12:13], v[14:15], v[14:15], v[12:13]
    v_pk_add_f32 v[14:15], v[76:77], v[10:11]
    v_pk_fma_f32 v[12:13], v[14:15], v[14:15], v[12:13]
    v_pk_add_f32 v[14:15], v[78:79], v[10:11]
    v_pk_fma_f32 v[12:13], v[14:15], v[14:15], v[12:13]
    v_pk_add_f32 v[14:15], v[80:81], v[10:11]
    v_pk_fma_f32 v[12:13], v[14:15], v[14:15], v[12:13]
    v_pk_add_f32 v[14:15], v[82:83], v[10:11]
    v_pk_fma_f32 v[12:13], v[14:15], v[14:15], v[12:13]
    v_pk_add_f32 v[14:15], v[84:85], v[10:11]
    v_pk_fma_f32 v[12:13], v[14:15], v[14:15], v[12:13]
    v_pk_add_f32 v[14:15], v[86:87], v[10:11]
    v_pk_fma_f32 v[12:13], v[14:15], v[14:15], v[12:13]
    v_pk_add_f32 v[14:15], v[88:89], v[10:11]
    v_pk_fma_f32 v[12:13], v[14:15], v[14:15], v[12:13]
    v_pk_add_f32 v[14:15], v[90:91], v[10:11]
    v_pk_fma_f32 v[12:13], v[14:15], v[14:15], v[12:13]
    v_pk_add_f32 v[14:15], v[92:93], v[10:11]
    v_pk_fma_f32 v[12:13], v[14:15], v[14:15], v[12:13]
    v_pk_add_f32 v[14:15], v[94:95], v[10:11]
    v_pk_fma_f32 v[12:13], v[14:15], v[14:15], v[12:13]
    v_pk_add_f32 v[14:15], v[96:97], v[10:11]
    v_pk_fma_f32 v[12:13], v[14:15], v[14:15], v[12:13]
    v_pk_add_f32 v[14:15], v[98:99], v[10:11]
    v_pk_fma_f32 v[12:13], v[14:15], v[14:15], v[12:13]
    v_pk_add_f32 v[14:15], v[100:101], v[10:11]
    v_pk_fma_f32 v[12:13], v[14:15], v[14:15], v[12:13]
    v_pk_add_f32 v[14:15], v[102:103], v[10:11]
    v_pk_fma_f32 v[12:13], v[14:15], v[14:15], v[12:13]
    v_pk_add_f32 v[14:15], v[104:105], v[10:11]
    v_pk_fma_f32 v[12:13], v[14:15], v[14:15], v[12:13]
    v_pk_add_f32 v[14:15], v[106:107], v[10:11]
    v_pk_fma_f32 v[12:13], v[14:15], v[14:15], v[12:13]
    v_pk_add_f32 v[14:15], v[108:109], v[10:11]
    v_pk_fma_f32 v[12:13], v[14:15], v[14:15], v[12:13]
    v_pk_add_f32 v[14:15], v[110:111], v[10:11]
    v_pk_fma_f32 v[12:13], v[14:15], v[14:15], v[12:13]
    v_pk_add_f32 v[14:15], v[112:113], v[10:11]
    v_pk_fma_f32 v[12:13], v[14:15], v[14:15], v[12:13]
    v_pk_add_f32 v[14:15], v[114:115], v[10:11]
    v_pk_fma_f32 v[12:13], v[14:15], v[14:15], v[12:13]
    v_pk_add_f32 v[14:15], v[116:117], v[10:11]
    v_pk_fma_f32 v[12:13], v[14:15], v[14:15], v[12:13]
    v_pk_add_f32 v[14:15], v[118:119], v[10:11]
    v_pk_fma_f32 v[12:13], v[14:15], v[14:15], v[12:13]
    v_pk_add_f32 v[14:15], v[120:121], v[10:11]
    v_pk_fma_f32 v[12:13], v[14:15], v[14:15], v[12:13]
    v_pk_add_f32 v[14:15], v[122:123], v[10:11]
    v_pk_fma_f32 v[12:13], v[14:15], v[14:15], v[12:13]
    v_pk_add_f32 v[14:15], v[124:125], v[10:11]
    v_pk_fma_f32 v[12:13], v[14:15], v[14:15], v[12:13]
    v_pk_add_f32 v[14:15], v[126:127], v[10:11]
    v_pk_fma_f32 v[12:13], v[14:15], v[14:15], v[12:13]
    v_pk_add_f32 v[14:15], v[128:129], v[10:11]
    v_pk_fma_f32 v[12:13], v[14:15], v[14:15], v[12:13]
    v_pk_add_f32 v[14:15], v[130:131], v[10:11]
    v_pk_fma_f32 v[12:13], v[14:15], v[14:15], v[12:13]
    v_pk_add_f32 v[14:15], v[132:133], v[10:11]
    v_pk_fma_f32 v[12:13], v[14:15], v[14:15], v[12:13]
    v_pk_add_f32 v[14:15], v[134:135], v[10:11]
    v_pk_fma_f32 v[12:13], v[14:15], v[14:15], v[12:13]
    v_pk_add_f32 v[14:15], v[136:137], v[10:11]
    v_pk_fma_f32 v[12:13], v[14:15], v[14:15], v[12:13]
    v_pk_add_f32 v[14:15], v[138:139], v[10:11]
    v_pk_fma_f32 v[12:13], v[14:15], v[14:15], v[12:13]
    v_pk_add_f32 v[14:15], v[140:141], v[10:11]
    v_pk_fma_f32 v[12:13], v[14:15], v[14:15], v[12:13]
    v_pk_add_f32 v[14:15], v[142:143], v[10:11]
    v_pk_fma_f32 v[12:13], v[14:15], v[14:15], v[12:13]
    v_add_f32 v12, v12, v13
    s_nop 1
    v_add_f32_dpp v12, v12, v12 row_ror:8 row_mask:0xf bank_mask:0xf
    v_mov_b32 v13, v12
    s_nop 1
    v_permlane16_swap_b32 v12, v13
    v_add_f32 v12, v12, v13
    v_mov_b32 v13, v12
    s_nop 1
    v_permlane32_swap_b32 v12, v13
    v_add_f32 v12, v12, v13
    v_mul_f32 v12, s98, v12
    v_cvt_pk_bf16_f32 v9, v8, v12
    v_and_b32 v12, s97, v9
    v_lshlrev_b32 v8, 16, v9
    v_add_f32 v12, 0x3727c5ac, v12
    v_cvt_pk_bf16_f32 v12, v12, v12
    v_and_b32 v12, s97, v12
    v_sqrt_f32 v12, v12
    v_sub_f32 v10, 0, v8
    v_cvt_pk_bf16_f32 v12, v12, v12
    v_and_b32 v12, s97, v12
    v_rcp_f32 v12, v12
    v_mov_b32 v11, v10
    v_mov_b32 v13, v12
    v_pk_add_f32 v[64:65], v[64:65], v[10:11]
    v_pk_add_f32 v[66:67], v[66:67], v[10:11]
    v_pk_add_f32 v[68:69], v[68:69], v[10:11]
    v_pk_add_f32 v[70:71], v[70:71], v[10:11]
    v_cvt_pk_bf16_f32 v14, v64, v65
    v_lshlrev_b32 v64, 16, v14
    v_and_b32 v65, s97, v14
    v_cvt_pk_bf16_f32 v14, v66, v67
    v_lshlrev_b32 v66, 16, v14
    v_and_b32 v67, s97, v14
    v_cvt_pk_bf16_f32 v14, v68, v69
    v_lshlrev_b32 v68, 16, v14
    v_and_b32 v69, s97, v14
    v_cvt_pk_bf16_f32 v14, v70, v71
    v_lshlrev_b32 v70, 16, v14
    v_and_b32 v71, s97, v14
    v_pk_mul_f32 v[64:65], v[64:65], v[12:13]
    v_pk_mul_f32 v[66:67], v[66:67], v[12:13]
    v_pk_mul_f32 v[68:69], v[68:69], v[12:13]
    v_pk_mul_f32 v[70:71], v[70:71], v[12:13]
    v_cvt_pk_bf16_f32 v144, v64, v65
    v_cvt_pk_bf16_f32 v145, v66, v67
    v_cvt_pk_bf16_f32 v148, v68, v69
    v_cvt_pk_bf16_f32 v149, v70, v71
    v_pk_add_f32 v[72:73], v[72:73], v[10:11]
    v_pk_add_f32 v[74:75], v[74:75], v[10:11]
    v_pk_add_f32 v[76:77], v[76:77], v[10:11]
    v_pk_add_f32 v[78:79], v[78:79], v[10:11]
    v_cvt_pk_bf16_f32 v14, v72, v73
    v_lshlrev_b32 v72, 16, v14
    v_and_b32 v73, s97, v14
    v_cvt_pk_bf16_f32 v14, v74, v75
    v_lshlrev_b32 v74, 16, v14
    v_and_b32 v75, s97, v14
    v_cvt_pk_bf16_f32 v14, v76, v77
    v_lshlrev_b32 v76, 16, v14
    v_and_b32 v77, s97, v14
    v_cvt_pk_bf16_f32 v14, v78, v79
    v_lshlrev_b32 v78, 16, v14
    v_and_b32 v79, s97, v14
    v_pk_mul_f32 v[72:73], v[72:73], v[12:13]
    v_pk_mul_f32 v[74:75], v[74:75], v[12:13]
    v_pk_mul_f32 v[76:77], v[76:77], v[12:13]
    v_pk_mul_f32 v[78:79], v[78:79], v[12:13]
    v_cvt_pk_bf16_f32 v146, v72, v73
    v_cvt_pk_bf16_f32 v147, v74, v75
    v_cvt_pk_bf16_f32 v150, v76, v77
    v_cvt_pk_bf16_f32 v151, v78, v79
    buffer_store_dwordx4 v[144:147], v7, s[32:35], s91 offen sc1
    buffer_store_dwordx4 v[148:151], v7, s[32:35], s91 offen offset:512 sc1
    s_add_u32 s91, s91, 8192
    v_pk_add_f32 v[80:81], v[80:81], v[10:11]
    v_pk_add_f32 v[82:83], v[82:83], v[10:11]
    v_pk_add_f32 v[84:85], v[84:85], v[10:11]
    v_pk_add_f32 v[86:87], v[86:87], v[10:11]
    v_cvt_pk_bf16_f32 v14, v80, v81
    v_lshlrev_b32 v80, 16, v14
    v_and_b32 v81, s97, v14
    v_cvt_pk_bf16_f32 v14, v82, v83
    v_lshlrev_b32 v82, 16, v14
    v_and_b32 v83, s97, v14
    v_cvt_pk_bf16_f32 v14, v84, v85
    v_lshlrev_b32 v84, 16, v14
    v_and_b32 v85, s97, v14
    v_cvt_pk_bf16_f32 v14, v86, v87
    v_lshlrev_b32 v86, 16, v14
    v_and_b32 v87, s97, v14
    v_pk_mul_f32 v[80:81], v[80:81], v[12:13]
    v_pk_mul_f32 v[82:83], v[82:83], v[12:13]
    v_pk_mul_f32 v[84:85], v[84:85], v[12:13]
    v_pk_mul_f32 v[86:87], v[86:87], v[12:13]
    v_cvt_pk_bf16_f32 v152, v80, v81
    v_cvt_pk_bf16_f32 v153, v82, v83
    v_cvt_pk_bf16_f32 v156, v84, v85
    v_cvt_pk_bf16_f32 v157, v86, v87
    v_pk_add_f32 v[88:89], v[88:89], v[10:11]
    v_pk_add_f32 v[90:91], v[90:91], v[10:11]
    v_pk_add_f32 v[92:93], v[92:93], v[10:11]
    v_pk_add_f32 v[94:95], v[94:95], v[10:11]
    v_cvt_pk_bf16_f32 v14, v88, v89
    v_lshlrev_b32 v88, 16, v14
    v_and_b32 v89, s97, v14
    v_cvt_pk_bf16_f32 v14, v90, v91
    v_lshlrev_b32 v90, 16, v14
    v_and_b32 v91, s97, v14
    v_cvt_pk_bf16_f32 v14, v92, v93
    v_lshlrev_b32 v92, 16, v14
    v_and_b32 v93, s97, v14
    v_cvt_pk_bf16_f32 v14, v94, v95
    v_lshlrev_b32 v94, 16, v14
    v_and_b32 v95, s97, v14
    v_pk_mul_f32 v[88:89], v[88:89], v[12:13]
    v_pk_mul_f32 v[90:91], v[90:91], v[12:13]
    v_pk_mul_f32 v[92:93], v[92:93], v[12:13]
    v_pk_mul_f32 v[94:95], v[94:95], v[12:13]
    v_cvt_pk_bf16_f32 v154, v88, v89
    v_cvt_pk_bf16_f32 v155, v90, v91
    v_cvt_pk_bf16_f32 v158, v92, v93
    v_cvt_pk_bf16_f32 v159, v94, v95
    buffer_store_dwordx4 v[152:155], v7, s[32:35], s91 offen sc1
    buffer_store_dwordx4 v[156:159], v7, s[32:35], s91 offen offset:512 sc1
    s_add_u32 s91, s91, 8192
    v_pk_add_f32 v[96:97], v[96:97], v[10:11]
    v_pk_add_f32 v[98:99], v[98:99], v[10:11]
    v_pk_add_f32 v[100:101], v[100:101], v[10:11]
    v_pk_add_f32 v[102:103], v[102:103], v[10:11]
    v_cvt_pk_bf16_f32 v14, v96, v97
    v_lshlrev_b32 v96, 16, v14
    v_and_b32 v97, s97, v14
    v_cvt_pk_bf16_f32 v14, v98, v99
    v_lshlrev_b32 v98, 16, v14
    v_and_b32 v99, s97, v14
    v_cvt_pk_bf16_f32 v14, v100, v101
    v_lshlrev_b32 v100, 16, v14
    v_and_b32 v101, s97, v14
    v_cvt_pk_bf16_f32 v14, v102, v103
    v_lshlrev_b32 v102, 16, v14
    v_and_b32 v103, s97, v14
    v_pk_mul_f32 v[96:97], v[96:97], v[12:13]
    v_pk_mul_f32 v[98:99], v[98:99], v[12:13]
    v_pk_mul_f32 v[100:101], v[100:101], v[12:13]
    v_pk_mul_f32 v[102:103], v[102:103], v[12:13]
    v_cvt_pk_bf16_f32 v160, v96, v97
    v_cvt_pk_bf16_f32 v161, v98, v99
    v_cvt_pk_bf16_f32 v164, v100, v101
    v_cvt_pk_bf16_f32 v165, v102, v103
    v_pk_add_f32 v[104:105], v[104:105], v[10:11]
    v_pk_add_f32 v[106:107], v[106:107], v[10:11]
    v_pk_add_f32 v[108:109], v[108:109], v[10:11]
    v_pk_add_f32 v[110:111], v[110:111], v[10:11]
    v_cvt_pk_bf16_f32 v14, v104, v105
    v_lshlrev_b32 v104, 16, v14
    v_and_b32 v105, s97, v14
    v_cvt_pk_bf16_f32 v14, v106, v107
    v_lshlrev_b32 v106, 16, v14
    v_and_b32 v107, s97, v14
    v_cvt_pk_bf16_f32 v14, v108, v109
    v_lshlrev_b32 v108, 16, v14
    v_and_b32 v109, s97, v14
    v_cvt_pk_bf16_f32 v14, v110, v111
    v_lshlrev_b32 v110, 16, v14
    v_and_b32 v111, s97, v14
    v_pk_mul_f32 v[104:105], v[104:105], v[12:13]
    v_pk_mul_f32 v[106:107], v[106:107], v[12:13]
    v_pk_mul_f32 v[108:109], v[108:109], v[12:13]
    v_pk_mul_f32 v[110:111], v[110:111], v[12:13]
    v_cvt_pk_bf16_f32 v162, v104, v105
    v_cvt_pk_bf16_f32 v163, v106, v107
    v_cvt_pk_bf16_f32 v166, v108, v109
    v_cvt_pk_bf16_f32 v167, v110, v111
    buffer_store_dwordx4 v[160:163], v7, s[32:35], s91 offen sc1
    buffer_store_dwordx4 v[164:167], v7, s[32:35], s91 offen offset:512 sc1
    s_add_u32 s91, s91, 8192
    v_pk_add_f32 v[112:113], v[112:113], v[10:11]
    v_pk_add_f32 v[114:115], v[114:115], v[10:11]
    v_pk_add_f32 v[116:117], v[116:117], v[10:11]
    v_pk_add_f32 v[118:119], v[118:119], v[10:11]
    v_cvt_pk_bf16_f32 v14, v112, v113
    v_lshlrev_b32 v112, 16, v14
    v_and_b32 v113, s97, v14
    v_cvt_pk_bf16_f32 v14, v114, v115
    v_lshlrev_b32 v114, 16, v14
    v_and_b32 v115, s97, v14
    v_cvt_pk_bf16_f32 v14, v116, v117
    v_lshlrev_b32 v116, 16, v14
    v_and_b32 v117, s97, v14
    v_cvt_pk_bf16_f32 v14, v118, v119
    v_lshlrev_b32 v118, 16, v14
    v_and_b32 v119, s97, v14
    v_pk_mul_f32 v[112:113], v[112:113], v[12:13]
    v_pk_mul_f32 v[114:115], v[114:115], v[12:13]
    v_pk_mul_f32 v[116:117], v[116:117], v[12:13]
    v_pk_mul_f32 v[118:119], v[118:119], v[12:13]
    v_cvt_pk_bf16_f32 v168, v112, v113
    v_cvt_pk_bf16_f32 v169, v114, v115
    v_cvt_pk_bf16_f32 v172, v116, v117
    v_cvt_pk_bf16_f32 v173, v118, v119
    v_pk_add_f32 v[120:121], v[120:121], v[10:11]
    v_pk_add_f32 v[122:123], v[122:123], v[10:11]
    v_pk_add_f32 v[124:125], v[124:125], v[10:11]
    v_pk_add_f32 v[126:127], v[126:127], v[10:11]
    v_cvt_pk_bf16_f32 v14, v120, v121
    v_lshlrev_b32 v120, 16, v14
    v_and_b32 v121, s97, v14
    v_cvt_pk_bf16_f32 v14, v122, v123
    v_lshlrev_b32 v122, 16, v14
    v_and_b32 v123, s97, v14
    v_cvt_pk_bf16_f32 v14, v124, v125
    v_lshlrev_b32 v124, 16, v14
    v_and_b32 v125, s97, v14
    v_cvt_pk_bf16_f32 v14, v126, v127
    v_lshlrev_b32 v126, 16, v14
    v_and_b32 v127, s97, v14
    v_pk_mul_f32 v[120:121], v[120:121], v[12:13]
    v_pk_mul_f32 v[122:123], v[122:123], v[12:13]
    v_pk_mul_f32 v[124:125], v[124:125], v[12:13]
    v_pk_mul_f32 v[126:127], v[126:127], v[12:13]
    v_cvt_pk_bf16_f32 v170, v120, v121
    v_cvt_pk_bf16_f32 v171, v122, v123
    v_cvt_pk_bf16_f32 v174, v124, v125
    v_cvt_pk_bf16_f32 v175, v126, v127
    buffer_store_dwordx4 v[168:171], v7, s[32:35], s91 offen sc1
    buffer_store_dwordx4 v[172:175], v7, s[32:35], s91 offen offset:512 sc1
    s_add_u32 s91, s91, 8192
    v_pk_add_f32 v[128:129], v[128:129], v[10:11]
    v_pk_add_f32 v[130:131], v[130:131], v[10:11]
    v_pk_add_f32 v[132:133], v[132:133], v[10:11]
    v_pk_add_f32 v[134:135], v[134:135], v[10:11]
    v_cvt_pk_bf16_f32 v14, v128, v129
    v_lshlrev_b32 v128, 16, v14
    v_and_b32 v129, s97, v14
    v_cvt_pk_bf16_f32 v14, v130, v131
    v_lshlrev_b32 v130, 16, v14
    v_and_b32 v131, s97, v14
    v_cvt_pk_bf16_f32 v14, v132, v133
    v_lshlrev_b32 v132, 16, v14
    v_and_b32 v133, s97, v14
    v_cvt_pk_bf16_f32 v14, v134, v135
    v_lshlrev_b32 v134, 16, v14
    v_and_b32 v135, s97, v14
    v_pk_mul_f32 v[128:129], v[128:129], v[12:13]
    v_pk_mul_f32 v[130:131], v[130:131], v[12:13]
    v_pk_mul_f32 v[132:133], v[132:133], v[12:13]
    v_pk_mul_f32 v[134:135], v[134:135], v[12:13]
    v_cvt_pk_bf16_f32 v176, v128, v129
    v_cvt_pk_bf16_f32 v177, v130, v131
    v_cvt_pk_bf16_f32 v180, v132, v133
    v_cvt_pk_bf16_f32 v181, v134, v135
    v_pk_add_f32 v[136:137], v[136:137], v[10:11]
    v_pk_add_f32 v[138:139], v[138:139], v[10:11]
    v_pk_add_f32 v[140:141], v[140:141], v[10:11]
    v_pk_add_f32 v[142:143], v[142:143], v[10:11]
    v_cvt_pk_bf16_f32 v14, v136, v137
    v_lshlrev_b32 v136, 16, v14
    v_and_b32 v137, s97, v14
    v_cvt_pk_bf16_f32 v14, v138, v139
    v_lshlrev_b32 v138, 16, v14
    v_and_b32 v139, s97, v14
    v_cvt_pk_bf16_f32 v14, v140, v141
    v_lshlrev_b32 v140, 16, v14
    v_and_b32 v141, s97, v14
    v_cvt_pk_bf16_f32 v14, v142, v143
    v_lshlrev_b32 v142, 16, v14
    v_and_b32 v143, s97, v14
    v_pk_mul_f32 v[136:137], v[136:137], v[12:13]
    v_pk_mul_f32 v[138:139], v[138:139], v[12:13]
    v_pk_mul_f32 v[140:141], v[140:141], v[12:13]
    v_pk_mul_f32 v[142:143], v[142:143], v[12:13]
    v_cvt_pk_bf16_f32 v178, v136, v137
    v_cvt_pk_bf16_f32 v179, v138, v139
    v_cvt_pk_bf16_f32 v182, v140, v141
    v_cvt_pk_bf16_f32 v183, v142, v143
    buffer_store_dwordx4 v[176:179], v7, s[32:35], s91 offen sc1
    buffer_store_dwordx4 v[180:183], v7, s[32:35], s91 offen offset:512 sc1
    s_waitcnt vmcnt(0)
    s_barrier
    s_cmp_lg_u32 s51, 0
    s_cbranch_scc1 L_noln
    s_lshr_b32 s54, s61, 3
    s_cmp_ge_u32 s54, 2
    s_cselect_b32 s55, 32, 0
    s_add_u32 s54, s54, s55
    s_lshl_b32 s54, s54, 2
    v_mov_b32 v10, s54
    v_mov_b32 v11, 1
    s_mov_b64 exec, 1
    global_atomic_add v10, v11, s[28:29] offset:0
    s_mov_b64 exec, -1
L_noln:
    s_lshr_b32 s54, s100, 24
    s_cmp_ge_u32 s54, 80
    s_cbranch_scc1 L_nopf
    s_cmp_ge_u32 s54, 40
    s_cselect_b32 s56, s8, s12
    s_cselect_b32 s57, s9, s13
    s_cselect_b32 s55, 40, 0
    s_sub_u32 s54, s54, s55
    s_lshl_b32 s54, s54, 17
    s_lshr_b32 s55, s56, 8
    s_sub_u32 s55, 1, s55
    s_and_b32 s55, s55, 3
    s_lshl_b32 s55, s55, 8
    s_add_u32 s54, s54, s55
    v_lshrrev_b32 v10, 4, v0
    v_lshlrev_b32 v10, 13, v10
    v_bfe_u32 v11, v0, 1, 3
    v_lshl_add_u32 v10, v11, 10, v10
    v_and_b32 v11, 1, v0
    v_lshl_add_u32 v10, v11, 7, v10
    v_add_u32 v10, s54, v10
    global_load_dword v40, v10, s[56:57]
L_nopf:
    v_and_b32 v9, 63, v0
    v_lshlrev_b32 v8, 4, v9
    s_lshl_b32 s60, s51, 10
    v_lshrrev_b32 v10, 2, v9
    s_lshl_b32 s54, s51, 4
    v_add_u32 v10, s54, v10
    v_and_b32 v11, 3, v9
    v_lshlrev_b32 v11, 4, v11
    v_lshl_add_u32 v5, v10, 13, v11
    s_mov_b32 s54, 3456
    v_mad_u32_u24 v6, v10, s54, v11
    s_mov_b32 s39, 0x20000
    s_mov_b32 s43, 0x20000
    s_mov_b32 s53, 0
    s_and_b32 s54, s64, 255
    s_cmp_ge_u32 s54, 192
    s_cbranch_scc1 L_dg_pre
    s_lshr_b32 s55, s54, 6
    s_cmp_eq_u32 s55, 1
    s_cselect_b32 s36, s12, s10
    s_cselect_b32 s37, s13, s11
    s_cmp_eq_u32 s55, 2
    s_cselect_b32 s36, s8, s36
    s_cselect_b32 s37, s9, s37
    s_mov_b32 s40, s36
    s_mov_b32 s41, s37
    s_mov_b32 s38, 5242880
    s_mov_b32 s42, 5242880
    s_and_b32 s54, s54, 63
    s_lshl_b32 s44, s54, 7
    s_add_u32 s45, s44, 64
    s_mov_b32 s46, 524288
    v_mov_b32 v4, v5
    s_branch L_dd_pre
L_dg_pre:
    s_mov_b32 s36, s20
    s_mov_b32 s37, s21
    s_mov_b32 s40, s22
    s_mov_b32 s41, s23
    s_cmp_eq_u32 s54, 255
    s_cselect_b32 s38, 0, 2211840
    s_mov_b32 s42, s38
    s_sub_u32 s54, s54, 192
    s_lshl_b32 s44, s54, 6
    s_mov_b32 s45, s44
    s_mov_b32 s46, 221184
    v_mov_b32 v4, v6
L_dd_pre:
    v_lshrrev_b32 v10, 5, v9
    v_bfe_u32 v11, v9, 2, 2
    v_lshl_add_u32 v10, v10, 2, v11
    v_lshlrev_b32 v10, 6, v10
    v_bfe_u32 v11, v9, 4, 1
    v_lshl_add_u32 v10, v11, 5, v10
    v_and_b32 v11, 3, v9
    v_lshl_add_u32 v2, v11, 3, v10
    v_add_u32 v3, 40960, v2
    v_bfe_u32 v10, v9, 4, 1
    v_lshlrev_b32 v10, 10, v10
    v_lshrrev_b32 v11, 5, v9
    v_lshl_add_u32 v10, v11, 8, v10
    v_and_b32 v11, 15, v9
    v_lshl_add_u32 v7, v11, 4, v10
L_gx_panel:
    s_cmp_ge_u32 s52, 2
    s_cselect_b32 s54, 32, 0
    s_add_u32 s54, s54, s52
    s_lshl_b32 s54, s54, 2
    v_mov_b32 v11, s54
    s_cmp_lg_u32 s51, 0
    s_cbranch_scc1 L_polld0
L_poll0:
    global_load_dword v10, v11, s[28:29] sc1
    s_waitcnt vmcnt(0)
    v_cmp_gt_u32 vcc, 8, v10
    s_nop 0
    s_cbranch_vccz L_polld0
    s_sleep 16
    s_sub_u32 s99, s99, 1
    s_cbranch_scc0 L_poll0
    s_endpgm
L_polld0:
    s_barrier
    s_add_u32 m0, s60, 0
    s_nop 0
    buffer_load_dwordx4 v4, s[36:39], s44 offen lds
    s_add_u32 m0, s60, 4096
    s_add_u32 s44, s44, s46
    buffer_load_dwordx4 v4, s[40:43], s45 offen lds
    s_add_u32 s45, s45, s46
    s_add_u32 m0, s60, 8192
    s_nop 0
    buffer_load_dwordx4 v4, s[36:39], s44 offen lds
    s_add_u32 m0, s60, 12288
    s_add_u32 s44, s44, s46
    buffer_load_dwordx4 v4, s[40:43], s45 offen lds
    s_add_u32 s45, s45, s46
    s_lshl_b32 s54, s52, 3
    s_lshl_b32 s55, s51, 1
    s_add_u32 s56, s54, s55
    s_mul_i32 s54, s56, 40960
    s_add_u32 s54, s54, 0
    buffer_load_dwordx4 v[192:195], v8, s[32:35], s54 offen offset:0 sc1
    buffer_load_dwordx4 v[196:199], v8, s[32:35], s54 offen offset:1024 sc1
    buffer_load_dwordx4 v[200:203], v8, s[32:35], s54 offen offset:2048 sc1
    buffer_load_dwordx4 v[204:207], v8, s[32:35], s54 offen offset:3072 sc1
    s_add_u32 s54, s54, 4096
    buffer_load_dwordx4 v[208:211], v8, s[32:35], s54 offen offset:0 sc1
    buffer_load_dwordx4 v[212:215], v8, s[32:35], s54 offen offset:1024 sc1
    buffer_load_dwordx4 v[216:219], v8, s[32:35], s54 offen offset:2048 sc1
    buffer_load_dwordx4 v[220:223], v8, s[32:35], s54 offen offset:3072 sc1
    s_add_u32 s54, s54, 4096
    buffer_load_dwordx4 v[224:227], v8, s[32:35], s54 offen offset:0 sc1
    buffer_load_dwordx4 v[228:231], v8, s[32:35], s54 offen offset:1024 sc1
    buffer_load_dwordx4 v[232:235], v8, s[32:35], s54 offen offset:2048 sc1
    buffer_load_dwordx4 v[236:239], v8, s[32:35], s54 offen offset:3072 sc1
    s_add_u32 s54, s54, 4096
    buffer_load_dwordx4 v[240:243], v8, s[32:35], s54 offen offset:0 sc1
    buffer_load_dwordx4 v[244:247], v8, s[32:35], s54 offen offset:1024 sc1
    buffer_load_dwordx4 v[248:251], v8, s[32:35], s54 offen offset:2048 sc1
    buffer_load_dwordx4 v[252:255], v8, s[32:35], s54 offen offset:3072 sc1
    s_add_u32 s54, s54, 4096
    buffer_load_dwordx4 a[0:3], v8, s[32:35], s54 offen offset:0 sc1
    buffer_load_dwordx4 a[4:7], v8, s[32:35], s54 offen offset:1024 sc1
    buffer_load_dwordx4 a[8:11], v8, s[32:35], s54 offen offset:2048 sc1
    buffer_load_dwordx4 a[12:15], v8, s[32:35], s54 offen offset:3072 sc1
    s_add_u32 s54, s54, 4096
    buffer_load_dwordx4 a[16:19], v8, s[32:35], s54 offen offset:0 sc1
    buffer_load_dwordx4 a[20:23], v8, s[32:35], s54 offen offset:1024 sc1
    buffer_load_dwordx4 a[24:27], v8, s[32:35], s54 offen offset:2048 sc1
    buffer_load_dwordx4 a[28:31], v8, s[32:35], s54 offen offset:3072 sc1
    s_add_u32 s54, s54, 4096
    buffer_load_dwordx4 a[32:35], v8, s[32:35], s54 offen offset:0 sc1
    buffer_load_dwordx4 a[36:39], v8, s[32:35], s54 offen offset:1024 sc1
    buffer_load_dwordx4 a[40:43], v8, s[32:35], s54 offen offset:2048 sc1
    buffer_load_dwordx4 a[44:47], v8, s[32:35], s54 offen offset:3072 sc1
    s_add_u32 s54, s54, 4096
    buffer_load_dwordx4 a[48:51], v8, s[32:35], s54 offen offset:0 sc1
    buffer_load_dwordx4 a[52:55], v8, s[32:35], s54 offen offset:1024 sc1
    buffer_load_dwordx4 a[56:59], v8, s[32:35], s54 offen offset:2048 sc1
    buffer_load_dwordx4 a[60:63], v8, s[32:35], s54 offen offset:3072 sc1
    s_add_u32 s54, s54, 4096
    buffer_load_dwordx4 a[64:67], v8, s[32:35], s54 offen offset:0 sc1
    buffer_load_dwordx4 a[68:71], v8, s[32:35], s54 offen offset:1024 sc1
    buffer_load_dwordx4 a[72:75], v8, s[32:35], s54 offen offset:2048 sc1
    buffer_load_dwordx4 a[76:79], v8, s[32:35], s54 offen offset:3072 sc1
    s_add_u32 s54, s54, 4096
    buffer_load_dwordx4 a[80:83], v8, s[32:35], s54 offen offset:0 sc1
    buffer_load_dwordx4 a[84:87], v8, s[32:35], s54 offen offset:1024 sc1
    buffer_load_dwordx4 a[88:91], v8, s[32:35], s54 offen offset:2048 sc1
    buffer_load_dwordx4 a[92:95], v8, s[32:35], s54 offen offset:3072 sc1
    s_waitcnt vmcnt(4)
    s_add_u32 s54, s54, 4096
    buffer_load_dwordx4 a[96:99], v8, s[32:35], s54 offen offset:0 sc1
    buffer_load_dwordx4 a[100:103], v8, s[32:35], s54 offen offset:1024 sc1
    buffer_load_dwordx4 a[104:107], v8, s[32:35], s54 offen offset:2048 sc1
    buffer_load_dwordx4 a[108:111], v8, s[32:35], s54 offen offset:3072 sc1
    s_add_u32 s54, s54, 4096
    buffer_load_dwordx4 a[112:115], v8, s[32:35], s54 offen offset:0 sc1
    buffer_load_dwordx4 a[116:119], v8, s[32:35], s54 offen offset:1024 sc1
    buffer_load_dwordx4 a[120:123], v8, s[32:35], s54 offen offset:2048 sc1
    buffer_load_dwordx4 a[124:127], v8, s[32:35], s54 offen offset:3072 sc1
    s_add_u32 s54, s54, 4096
    buffer_load_dwordx4 a[128:131], v8, s[32:35], s54 offen offset:0 sc1
    buffer_load_dwordx4 a[132:135], v8, s[32:35], s54 offen offset:1024 sc1
    buffer_load_dwordx4 a[136:139], v8, s[32:35], s54 offen offset:2048 sc1
    buffer_load_dwordx4 a[140:143], v8, s[32:35], s54 offen offset:3072 sc1
    s_add_u32 s54, s54, 4096
    buffer_load_dwordx4 a[144:147], v8, s[32:35], s54 offen offset:0 sc1
    buffer_load_dwordx4 a[148:151], v8, s[32:35], s54 offen offset:1024 sc1
    buffer_load_dwordx4 a[152:155], v8, s[32:35], s54 offen offset:2048 sc1
    buffer_load_dwordx4 a[156:159], v8, s[32:35], s54 offen offset:3072 sc1
    s_add_u32 s54, s54, 4096
    buffer_load_dwordx4 a[160:163], v8, s[32:35], s54 offen offset:0 sc1
    buffer_load_dwordx4 a[164:167], v8, s[32:35], s54 offen offset:1024 sc1
    buffer_load_dwordx4 a[168:171], v8, s[32:35], s54 offen offset:2048 sc1
    buffer_load_dwordx4 a[172:175], v8, s[32:35], s54 offen offset:3072 sc1
    s_add_u32 s54, s54, 4096
    buffer_load_dwordx4 a[176:179], v8, s[32:35], s54 offen offset:0 sc1
    buffer_load_dwordx4 a[180:183], v8, s[32:35], s54 offen offset:1024 sc1
    buffer_load_dwordx4 a[184:187], v8, s[32:35], s54 offen offset:2048 sc1
    buffer_load_dwordx4 a[188:191], v8, s[32:35], s54 offen offset:3072 sc1
    s_add_u32 s54, s54, 4096
    buffer_load_dwordx4 a[192:195], v8, s[32:35], s54 offen offset:0 sc1
    buffer_load_dwordx4 a[196:199], v8, s[32:35], s54 offen offset:1024 sc1
    buffer_load_dwordx4 a[200:203], v8, s[32:35], s54 offen offset:2048 sc1
    buffer_load_dwordx4 a[204:207], v8, s[32:35], s54 offen offset:3072 sc1
    s_add_u32 s54, s54, 4096
    buffer_load_dwordx4 a[208:211], v8, s[32:35], s54 offen offset:0 sc1
    buffer_load_dwordx4 a[212:215], v8, s[32:35], s54 offen offset:1024 sc1
    buffer_load_dwordx4 a[216:219], v8, s[32:35], s54 offen offset:2048 sc1
    buffer_load_dwordx4 a[220:223], v8, s[32:35], s54 offen offset:3072 sc1
    s_add_u32 s54, s54, 4096
    buffer_load_dwordx4 a[224:227], v8, s[32:35], s54 offen offset:0 sc1
    buffer_load_dwordx4 a[228:231], v8, s[32:35], s54 offen offset:1024 sc1
    buffer_load_dwordx4 a[232:235], v8, s[32:35], s54 offen offset:2048 sc1
    buffer_load_dwordx4 a[236:239], v8, s[32:35], s54 offen offset:3072 sc1
    s_add_u32 s54, s54, 4096
    buffer_load_dwordx4 a[240:243], v8, s[32:35], s54 offen offset:0 sc1
    buffer_load_dwordx4 a[244:247], v8, s[32:35], s54 offen offset:1024 sc1
    buffer_load_dwordx4 a[248:251], v8, s[32:35], s54 offen offset:2048 sc1
    buffer_load_dwordx4 a[252:255], v8, s[32:35], s54 offen offset:3072 sc1
L_gx_fill:
    s_add_u32 m0, s60, 16384
    s_nop 0
    buffer_load_dwordx4 v4, s[36:39], s44 offen lds
    s_add_u32 m0, s60, 20480
    s_add_u32 s44, s44, s46
    buffer_load_dwordx4 v4, s[40:43], s45 offen lds
    s_add_u32 s45, s45, s46
    s_add_u32 m0, s60, 24576
    s_nop 0
    buffer_load_dwordx4 v4, s[36:39], s44 offen lds
    s_add_u32 m0, s60, 28672
    s_add_u32 s44, s44, s46
    buffer_load_dwordx4 v4, s[40:43], s45 offen lds
    s_add_u32 s45, s45, s46
    s_add_u32 m0, s60, 32768
    s_nop 0
    buffer_load_dwordx4 v4, s[36:39], s44 offen lds
    s_add_u32 m0, s60, 36864
    s_add_u32 s44, s44, s46
    buffer_load_dwordx4 v4, s[40:43], s45 offen lds
    s_add_u32 s45, s45, s46
    s_add_u32 m0, s60, 40960
    s_nop 0
    buffer_load_dwordx4 v4, s[36:39], s44 offen lds
    s_add_u32 m0, s60, 45056
    s_add_u32 s44, s44, s46
    buffer_load_dwordx4 v4, s[40:43], s45 offen lds
    s_add_u32 s45, s45, s46
    s_add_u32 m0, s60, 49152
    s_nop 0
    buffer_load_dwordx4 v4, s[36:39], s44 offen lds
    s_add_u32 m0, s60, 53248
    s_add_u32 s44, s44, s46
    buffer_load_dwordx4 v4, s[40:43], s45 offen lds
    s_add_u32 s45, s45, s46
    s_add_u32 m0, s60, 57344
    s_nop 0
    buffer_load_dwordx4 v4, s[36:39], s44 offen lds
    s_add_u32 m0, s60, 61440
    s_add_u32 s44, s44, s46
    buffer_load_dwordx4 v4, s[40:43], s45 offen lds
    s_add_u32 s45, s45, s46
    buffer_load_dword v40, v8, s[32:35], 0 offen
    buffer_load_dword v40, v8, s[32:35], 0 offen
    buffer_load_dword v40, v8, s[32:35], 0 offen
    buffer_load_dword v40, v8, s[32:35], 0 offen
    s_waitcnt vmcnt(16)
    s_barrier
    ds_read_b64_tr_b16 v[96:97], v2 offset:0
    ds_read_b64_tr_b16 v[98:99], v2 offset:1024
    ds_read_b64_tr_b16 v[100:101], v2 offset:4096
    ds_read_b64_tr_b16 v[102:103], v2 offset:5120
    ds_read_b64_tr_b16 v[104:105], v2 offset:512
    ds_read_b64_tr_b16 v[106:107], v2 offset:1536
    ds_read_b64_tr_b16 v[108:109], v2 offset:4608
    ds_read_b64_tr_b16 v[110:111], v2 offset:5632
L_gx_next:
    s_bitcmp1_b32 s53, 15
    s_cbranch_scc1 L_gx_eager
    s_mov_b32 s47, s64
    s_mov_b32 s64, s65
    s_mov_b32 s65, s66
    s_mov_b32 s66, s67
    s_mov_b32 s67, s68
    s_mov_b32 s68, s69
    s_mov_b32 s69, s70
    s_mov_b32 s70, s71
    s_mov_b32 s71, s72
    s_mov_b32 s72, s73
    s_mov_b32 s73, s74
    s_mov_b32 s74, s75
    s_mov_b32 s75, s76
    s_mov_b32 s76, s77
    s_mov_b32 s77, s78
    s_mov_b32 s78, s79
    s_mov_b32 s79, s80
    s_mov_b32 s80, s81
    s_mov_b32 s81, s82
    s_mov_b32 s82, s83
    s_mov_b32 s83, 255
    s_and_b32 s54, s47, 255
    s_cmp_eq_u32 s54, 255
    s_cbranch_scc1 L_gx_end
    s_cmp_ge_u32 s54, 192
    s_cbranch_scc1 L_gx_g
    s_lshr_b32 s55, s54, 6
    s_mov_b32 s57, 4194304
    s_cmp_eq_u32 s55, 2
    s_cselect_b32 s57, 4210688, s57
    s_cmp_eq_u32 s55, 1
    s_cselect_b32 s57, 4202496, s57
    s_bfe_u32 s58, s54, 0x50001
    s_mul_i32 s58, s58, 24576
    s_and_b32 s54, s54, 1
    s_lshl_b32 s54, s54, 12
    s_add_u32 s54, s54, s58
    s_mul_i32 s58, s56, 786432
    s_add_u32 s54, s54, s58
    s_add_u32 s49, s54, s57
    s_add_u32 s50, s49, 786432
    s_cmp_eq_u32 s55, 1
    s_cbranch_scc1 L_gx_v
    s_waitcnt lgkmcnt(6)
    v_mfma_f32_32x32x16_bf16 v[128:143], v[96:99], v[192:195], 0
    ds_read_b64_tr_b16 v[112:113], v2 offset:2048
    ds_read_b64_tr_b16 v[114:115], v2 offset:3072
    v_mfma_f32_32x32x16_bf16 v[144:159], v[96:99], a[96:99], 0
    s_waitcnt lgkmcnt(6)
    v_mfma_f32_32x32x16_bf16 v[160:175], v[100:103], v[192:195], 0
    ds_read_b64_tr_b16 v[116:117], v2 offset:6144
    ds_read_b64_tr_b16 v[118:119], v2 offset:7168
    v_mfma_f32_32x32x16_bf16 v[176:191], v[100:103], a[96:99], 0
    s_waitcnt lgkmcnt(6)
    v_mfma_f32_32x32x16_bf16 v[128:143], v[104:107], v[196:199], v[128:143]
    ds_read_b64_tr_b16 v[120:121], v2 offset:2560
    ds_read_b64_tr_b16 v[122:123], v2 offset:3584
    v_mfma_f32_32x32x16_bf16 v[144:159], v[104:107], a[100:103], v[144:159]
    s_waitcnt lgkmcnt(6)
    v_mfma_f32_32x32x16_bf16 v[160:175], v[108:111], v[196:199], v[160:175]
    ds_read_b64_tr_b16 v[124:125], v2 offset:6656
    ds_read_b64_tr_b16 v[126:127], v2 offset:7680
    v_mfma_f32_32x32x16_bf16 v[176:191], v[108:111], a[100:103], v[176:191]
    s_waitcnt lgkmcnt(6)
    v_mfma_f32_32x32x16_bf16 v[128:143], v[112:115], v[200:203], v[128:143]
    s_waitcnt vmcnt(16)
    s_barrier
    ds_read_b64_tr_b16 v[96:97], v2 offset:8192
    ds_read_b64_tr_b16 v[98:99], v2 offset:9216
    v_mfma_f32_32x32x16_bf16 v[144:159], v[112:115], a[104:107], v[144:159]
    s_add_u32 m0, s60, 65536
    s_nop 0
    buffer_load_dwordx4 v4, s[36:39], s44 offen lds
    s_add_u32 m0, s60, 69632
    s_add_u32 s44, s44, s46
    buffer_load_dwordx4 v4, s[40:43], s45 offen lds
    s_add_u32 s45, s45, s46
    s_waitcnt lgkmcnt(6)
    v_mfma_f32_32x32x16_bf16 v[160:175], v[116:119], v[200:203], v[160:175]
    ds_read_b64_tr_b16 v[100:101], v2 offset:12288
    ds_read_b64_tr_b16 v[102:103], v2 offset:13312
    v_mfma_f32_32x32x16_bf16 v[176:191], v[116:119], a[104:107], v[176:191]
    s_waitcnt lgkmcnt(6)
    v_mfma_f32_32x32x16_bf16 v[128:143], v[120:123], v[204:207], v[128:143]
    ds_read_b64_tr_b16 v[104:105], v2 offset:8704
    ds_read_b64_tr_b16 v[106:107], v2 offset:9728
    v_mfma_f32_32x32x16_bf16 v[144:159], v[120:123], a[108:111], v[144:159]
    s_waitcnt lgkmcnt(6)
    v_mfma_f32_32x32x16_bf16 v[160:175], v[124:127], v[204:207], v[160:175]
    ds_read_b64_tr_b16 v[108:109], v2 offset:12800
    ds_read_b64_tr_b16 v[110:111], v2 offset:13824
    v_mfma_f32_32x32x16_bf16 v[176:191], v[124:127], a[108:111], v[176:191]
    s_waitcnt lgkmcnt(6)
    v_mfma_f32_32x32x16_bf16 v[128:143], v[96:99], v[208:211], v[128:143]
    ds_read_b64_tr_b16 v[112:113], v2 offset:10240
    ds_read_b64_tr_b16 v[114:115], v2 offset:11264
    v_mfma_f32_32x32x16_bf16 v[144:159], v[96:99], a[112:115], v[144:159]
    s_waitcnt lgkmcnt(6)
    v_mfma_f32_32x32x16_bf16 v[160:175], v[100:103], v[208:211], v[160:175]
    ds_read_b64_tr_b16 v[116:117], v2 offset:14336
    ds_read_b64_tr_b16 v[118:119], v2 offset:15360
    v_mfma_f32_32x32x16_bf16 v[176:191], v[100:103], a[112:115], v[176:191]
    s_waitcnt lgkmcnt(6)
    v_mfma_f32_32x32x16_bf16 v[128:143], v[104:107], v[212:215], v[128:143]
    ds_read_b64_tr_b16 v[120:121], v2 offset:10752
    ds_read_b64_tr_b16 v[122:123], v2 offset:11776
    v_mfma_f32_32x32x16_bf16 v[144:159], v[104:107], a[116:119], v[144:159]
    s_waitcnt lgkmcnt(6)
    v_mfma_f32_32x32x16_bf16 v[160:175], v[108:111], v[212:215], v[160:175]
    ds_read_b64_tr_b16 v[124:125], v2 offset:14848
    ds_read_b64_tr_b16 v[126:127], v2 offset:15872
    v_mfma_f32_32x32x16_bf16 v[176:191], v[108:111], a[116:119], v[176:191]
    s_waitcnt lgkmcnt(6)
    v_mfma_f32_32x32x16_bf16 v[128:143], v[112:115], v[216:219], v[128:143]
    s_waitcnt vmcnt(16)
    s_barrier
    ds_read_b64_tr_b16 v[96:97], v2 offset:16384
    ds_read_b64_tr_b16 v[98:99], v2 offset:17408
    v_mfma_f32_32x32x16_bf16 v[144:159], v[112:115], a[120:123], v[144:159]
    s_add_u32 m0, s60, 73728
    s_nop 0
    buffer_load_dwordx4 v4, s[36:39], s44 offen lds
    s_add_u32 m0, s60, 77824
    s_add_u32 s44, s44, s46
    buffer_load_dwordx4 v4, s[40:43], s45 offen lds
    s_add_u32 s45, s45, s46
    s_waitcnt lgkmcnt(6)
    v_mfma_f32_32x32x16_bf16 v[160:175], v[116:119], v[216:219], v[160:175]
    ds_read_b64_tr_b16 v[100:101], v2 offset:20480
    ds_read_b64_tr_b16 v[102:103], v2 offset:21504
    v_mfma_f32_32x32x16_bf16 v[176:191], v[116:119], a[120:123], v[176:191]
    s_waitcnt lgkmcnt(6)
    v_mfma_f32_32x32x16_bf16 v[128:143], v[120:123], v[220:223], v[128:143]
    ds_read_b64_tr_b16 v[104:105], v2 offset:16896
    ds_read_b64_tr_b16 v[106:107], v2 offset:17920
    v_mfma_f32_32x32x16_bf16 v[144:159], v[120:123], a[124:127], v[144:159]
    s_waitcnt lgkmcnt(6)
    v_mfma_f32_32x32x16_bf16 v[160:175], v[124:127], v[220:223], v[160:175]
    ds_read_b64_tr_b16 v[108:109], v2 offset:20992
    ds_read_b64_tr_b16 v[110:111], v2 offset:22016
    v_mfma_f32_32x32x16_bf16 v[176:191], v[124:127], a[124:127], v[176:191]
    s_waitcnt lgkmcnt(6)
    v_mfma_f32_32x32x16_bf16 v[128:143], v[96:99], v[224:227], v[128:143]
    ds_read_b64_tr_b16 v[112:113], v2 offset:18432
    ds_read_b64_tr_b16 v[114:115], v2 offset:19456
    v_mfma_f32_32x32x16_bf16 v[144:159], v[96:99], a[128:131], v[144:159]
    s_waitcnt lgkmcnt(6)
    v_mfma_f32_32x32x16_bf16 v[160:175], v[100:103], v[224:227], v[160:175]
    ds_read_b64_tr_b16 v[116:117], v2 offset:22528
    ds_read_b64_tr_b16 v[118:119], v2 offset:23552
    v_mfma_f32_32x32x16_bf16 v[176:191], v[100:103], a[128:131], v[176:191]
    s_waitcnt lgkmcnt(6)
    v_mfma_f32_32x32x16_bf16 v[128:143], v[104:107], v[228:231], v[128:143]
    ds_read_b64_tr_b16 v[120:121], v2 offset:18944
    ds_read_b64_tr_b16 v[122:123], v2 offset:19968
    v_mfma_f32_32x32x16_bf16 v[144:159], v[104:107], a[132:135], v[144:159]
    s_waitcnt lgkmcnt(6)
    v_mfma_f32_32x32x16_bf16 v[160:175], v[108:111], v[228:231], v[160:175]
    ds_read_b64_tr_b16 v[124:125], v2 offset:23040
    ds_read_b64_tr_b16 v[126:127], v2 offset:24064
    v_mfma_f32_32x32x16_bf16 v[176:191], v[108:111], a[132:135], v[176:191]
    s_waitcnt lgkmcnt(6)
    v_mfma_f32_32x32x16_bf16 v[128:143], v[112:115], v[232:235], v[128:143]
    s_waitcnt vmcnt(16)
    s_barrier
    ds_read_b64_tr_b16 v[96:97], v2 offset:24576
    ds_read_b64_tr_b16 v[98:99], v2 offset:25600
    v_mfma_f32_32x32x16_bf16 v[144:159], v[112:115], a[136:139], v[144:159]
    s_bitcmp1_b32 s47, 23
    s_cselect_b32 s59, 255, s64
    s_and_b32 s54, s59, 255
    s_cmp_ge_u32 s54, 192
    s_cbranch_scc1 L_dg_T
    s_lshr_b32 s55, s54, 6
    s_cmp_eq_u32 s55, 1
    s_cselect_b32 s36, s12, s10
    s_cselect_b32 s37, s13, s11
    s_cmp_eq_u32 s55, 2
    s_cselect_b32 s36, s8, s36
    s_cselect_b32 s37, s9, s37
    s_mov_b32 s40, s36
    s_mov_b32 s41, s37
    s_mov_b32 s38, 5242880
    s_mov_b32 s42, 5242880
    s_and_b32 s54, s54, 63
    s_lshl_b32 s44, s54, 7
    s_add_u32 s45, s44, 64
    s_mov_b32 s46, 524288
    v_mov_b32 v4, v5
    s_branch L_dd_T
L_dg_T:
    s_mov_b32 s36, s20
    s_mov_b32 s37, s21
    s_mov_b32 s40, s22
    s_mov_b32 s41, s23
    s_cmp_eq_u32 s54, 255
    s_cselect_b32 s38, 0, 2211840
    s_mov_b32 s42, s38
    s_sub_u32 s54, s54, 192
    s_lshl_b32 s44, s54, 6
    s_mov_b32 s45, s44
    s_mov_b32 s46, 221184
    v_mov_b32 v4, v6
L_dd_T:
    s_add_u32 m0, s60, 0
    s_nop 0
    buffer_load_dwordx4 v4, s[36:39], s44 offen lds
    s_add_u32 m0, s60, 4096
    s_add_u32 s44, s44, s46
    buffer_load_dwordx4 v4, s[40:43], s45 offen lds
    s_add_u32 s45, s45, s46
    s_waitcnt lgkmcnt(6)
    v_mfma_f32_32x32x16_bf16 v[160:175], v[116:119], v[232:235], v[160:175]
    ds_read_b64_tr_b16 v[100:101], v2 offset:28672
    ds_read_b64_tr_b16 v[102:103], v2 offset:29696
    v_mfma_f32_32x32x16_bf16 v[176:191], v[116:119], a[136:139], v[176:191]
    s_waitcnt lgkmcnt(6)
    v_mfma_f32_32x32x16_bf16 v[128:143], v[120:123], v[236:239], v[128:143]
    ds_read_b64_tr_b16 v[104:105], v2 offset:25088
    ds_read_b64_tr_b16 v[106:107], v2 offset:26112
    v_mfma_f32_32x32x16_bf16 v[144:159], v[120:123], a[140:143], v[144:159]
    s_waitcnt lgkmcnt(6)
    v_mfma_f32_32x32x16_bf16 v[160:175], v[124:127], v[236:239], v[160:175]
    ds_read_b64_tr_b16 v[108:109], v2 offset:29184
    ds_read_b64_tr_b16 v[110:111], v2 offset:30208
    v_mfma_f32_32x32x16_bf16 v[176:191], v[124:127], a[140:143], v[176:191]
    s_waitcnt lgkmcnt(6)
    v_mfma_f32_32x32x16_bf16 v[128:143], v[96:99], v[240:243], v[128:143]
    ds_read_b64_tr_b16 v[112:113], v2 offset:26624
    ds_read_b64_tr_b16 v[114:115], v2 offset:27648
    v_mfma_f32_32x32x16_bf16 v[144:159], v[96:99], a[144:147], v[144:159]
    s_waitcnt lgkmcnt(6)
    v_mfma_f32_32x32x16_bf16 v[160:175], v[100:103], v[240:243], v[160:175]
    ds_read_b64_tr_b16 v[116:117], v2 offset:30720
    ds_read_b64_tr_b16 v[118:119], v2 offset:31744
    v_mfma_f32_32x32x16_bf16 v[176:191], v[100:103], a[144:147], v[176:191]
    s_waitcnt lgkmcnt(6)
    v_mfma_f32_32x32x16_bf16 v[128:143], v[104:107], v[244:247], v[128:143]
    ds_read_b64_tr_b16 v[120:121], v2 offset:27136
    ds_read_b64_tr_b16 v[122:123], v2 offset:28160
    v_mfma_f32_32x32x16_bf16 v[144:159], v[104:107], a[148:151], v[144:159]
    s_waitcnt lgkmcnt(6)
    v_mfma_f32_32x32x16_bf16 v[160:175], v[108:111], v[244:247], v[160:175]
    ds_read_b64_tr_b16 v[124:125], v2 offset:31232
    ds_read_b64_tr_b16 v[126:127], v2 offset:32256
    v_mfma_f32_32x32x16_bf16 v[176:191], v[108:111], a[148:151], v[176:191]
    s_waitcnt lgkmcnt(6)
    v_mfma_f32_32x32x16_bf16 v[128:143], v[112:115], v[248:251], v[128:143]
    s_waitcnt vmcnt(16)
    s_barrier
    ds_read_b64_tr_b16 v[96:97], v2 offset:32768
    ds_read_b64_tr_b16 v[98:99], v2 offset:33792
    v_mfma_f32_32x32x16_bf16 v[144:159], v[112:115], a[152:155], v[144:159]
    s_add_u32 m0, s60, 8192
    s_nop 0
    buffer_load_dwordx4 v4, s[36:39], s44 offen lds
    s_add_u32 m0, s60, 12288
    s_add_u32 s44, s44, s46
    buffer_load_dwordx4 v4, s[40:43], s45 offen lds
    s_add_u32 s45, s45, s46
    s_waitcnt lgkmcnt(6)
    v_mfma_f32_32x32x16_bf16 v[160:175], v[116:119], v[248:251], v[160:175]
    ds_read_b64_tr_b16 v[100:101], v2 offset:36864
    ds_read_b64_tr_b16 v[102:103], v2 offset:37888
    v_mfma_f32_32x32x16_bf16 v[176:191], v[116:119], a[152:155], v[176:191]
    s_waitcnt lgkmcnt(6)
    v_mfma_f32_32x32x16_bf16 v[128:143], v[120:123], v[252:255], v[128:143]
    ds_read_b64_tr_b16 v[104:105], v2 offset:33280
    ds_read_b64_tr_b16 v[106:107], v2 offset:34304
    v_mfma_f32_32x32x16_bf16 v[144:159], v[120:123], a[156:159], v[144:159]
    s_waitcnt lgkmcnt(6)
    v_mfma_f32_32x32x16_bf16 v[160:175], v[124:127], v[252:255], v[160:175]
    ds_read_b64_tr_b16 v[108:109], v2 offset:37376
    ds_read_b64_tr_b16 v[110:111], v2 offset:38400
    v_mfma_f32_32x32x16_bf16 v[176:191], v[124:127], a[156:159], v[176:191]
    s_waitcnt lgkmcnt(6)
    v_mfma_f32_32x32x16_bf16 v[128:143], v[96:99], a[0:3], v[128:143]
    ds_read_b64_tr_b16 v[112:113], v2 offset:34816
    ds_read_b64_tr_b16 v[114:115], v2 offset:35840
    v_mfma_f32_32x32x16_bf16 v[144:159], v[96:99], a[160:163], v[144:159]
    s_waitcnt lgkmcnt(6)
    v_mfma_f32_32x32x16_bf16 v[160:175], v[100:103], a[0:3], v[160:175]
    ds_read_b64_tr_b16 v[116:117], v2 offset:38912
    ds_read_b64_tr_b16 v[118:119], v2 offset:39936
    v_mfma_f32_32x32x16_bf16 v[176:191], v[100:103], a[160:163], v[176:191]
    s_waitcnt lgkmcnt(6)
    v_mfma_f32_32x32x16_bf16 v[128:143], v[104:107], a[4:7], v[128:143]
    ds_read_b64_tr_b16 v[120:121], v2 offset:35328
    ds_read_b64_tr_b16 v[122:123], v2 offset:36352
    v_mfma_f32_32x32x16_bf16 v[144:159], v[104:107], a[164:167], v[144:159]
    s_waitcnt lgkmcnt(6)
    v_mfma_f32_32x32x16_bf16 v[160:175], v[108:111], a[4:7], v[160:175]
    ds_read_b64_tr_b16 v[124:125], v2 offset:39424
    ds_read_b64_tr_b16 v[126:127], v2 offset:40448
    v_mfma_f32_32x32x16_bf16 v[176:191], v[108:111], a[164:167], v[176:191]
    s_waitcnt lgkmcnt(6)
    v_mfma_f32_32x32x16_bf16 v[128:143], v[112:115], a[8:11], v[128:143]
    s_cmp_eq_u32 s53, 0
    s_cbranch_scc1 L_lax_T
    s_waitcnt vmcnt(8)
L_lax_T:
    s_waitcnt vmcnt(16)
    s_barrier
    ds_read_b64_tr_b16 v[96:97], v3 offset:0
    ds_read_b64_tr_b16 v[98:99], v3 offset:1024
    v_mfma_f32_32x32x16_bf16 v[144:159], v[112:115], a[168:171], v[144:159]
    s_add_u32 m0, s60, 16384
    s_nop 0
    buffer_load_dwordx4 v4, s[36:39], s44 offen lds
    s_add_u32 m0, s60, 20480
    s_add_u32 s44, s44, s46
    buffer_load_dwordx4 v4, s[40:43], s45 offen lds
    s_add_u32 s45, s45, s46
    s_cmp_eq_u32 s53, 0
    s_cbranch_scc1 L_ns_T
    s_cmp_lg_u32 s51, 0
    s_cbranch_scc1 L_ns2_T
    s_and_b32 s54, s53, 255
    s_lshl_b32 s54, s54, 3
    s_and_b32 s55, s2, 7
    s_add_u32 s54, s54, s55
    s_lshl_b32 s54, s54, 7
    s_add_u32 s54, s54, 95828992
    s_bfe_u32 s55, s53, 0x70008
    v_mov_b32 v10, s54
    v_mov_b32 v11, s55
    s_mov_b64 exec, 1
    buffer_atomic_add v11, v10, s[32:35], 0 offen
    s_mov_b64 exec, -1
L_ns2_T:
    s_mov_b32 s53, 0
L_ns_T:
    s_waitcnt lgkmcnt(6)
    v_mfma_f32_32x32x16_bf16 v[160:175], v[116:119], a[8:11], v[160:175]
    ds_read_b64_tr_b16 v[100:101], v3 offset:4096
    ds_read_b64_tr_b16 v[102:103], v3 offset:5120
    v_mfma_f32_32x32x16_bf16 v[176:191], v[116:119], a[168:171], v[176:191]
    s_waitcnt lgkmcnt(6)
    v_mfma_f32_32x32x16_bf16 v[128:143], v[120:123], a[12:15], v[128:143]
    ds_read_b64_tr_b16 v[104:105], v3 offset:512
    ds_read_b64_tr_b16 v[106:107], v3 offset:1536
    v_mfma_f32_32x32x16_bf16 v[144:159], v[120:123], a[172:175], v[144:159]
    s_waitcnt lgkmcnt(6)
    v_mfma_f32_32x32x16_bf16 v[160:175], v[124:127], a[12:15], v[160:175]
    ds_read_b64_tr_b16 v[108:109], v3 offset:4608
    ds_read_b64_tr_b16 v[110:111], v3 offset:5632
    v_mfma_f32_32x32x16_bf16 v[176:191], v[124:127], a[172:175], v[176:191]
    s_waitcnt lgkmcnt(6)
    v_mfma_f32_32x32x16_bf16 v[128:143], v[96:99], a[16:19], v[128:143]
    ds_read_b64_tr_b16 v[112:113], v3 offset:2048
    ds_read_b64_tr_b16 v[114:115], v3 offset:3072
    v_mfma_f32_32x32x16_bf16 v[144:159], v[96:99], a[176:179], v[144:159]
    s_waitcnt lgkmcnt(6)
    v_mfma_f32_32x32x16_bf16 v[160:175], v[100:103], a[16:19], v[160:175]
    ds_read_b64_tr_b16 v[116:117], v3 offset:6144
    ds_read_b64_tr_b16 v[118:119], v3 offset:7168
    v_mfma_f32_32x32x16_bf16 v[176:191], v[100:103], a[176:179], v[176:191]
    s_waitcnt lgkmcnt(6)
    v_mfma_f32_32x32x16_bf16 v[128:143], v[104:107], a[20:23], v[128:143]
    ds_read_b64_tr_b16 v[120:121], v3 offset:2560
    ds_read_b64_tr_b16 v[122:123], v3 offset:3584
    v_mfma_f32_32x32x16_bf16 v[144:159], v[104:107], a[180:183], v[144:159]
    s_waitcnt lgkmcnt(6)
    v_mfma_f32_32x32x16_bf16 v[160:175], v[108:111], a[20:23], v[160:175]
    ds_read_b64_tr_b16 v[124:125], v3 offset:6656
    ds_read_b64_tr_b16 v[126:127], v3 offset:7680
    v_mfma_f32_32x32x16_bf16 v[176:191], v[108:111], a[180:183], v[176:191]
    s_waitcnt lgkmcnt(6)
    v_mfma_f32_32x32x16_bf16 v[128:143], v[112:115], a[24:27], v[128:143]
    s_waitcnt vmcnt(16)
    s_barrier
    ds_read_b64_tr_b16 v[96:97], v3 offset:8192
    ds_read_b64_tr_b16 v[98:99], v3 offset:9216
    v_mfma_f32_32x32x16_bf16 v[144:159], v[112:115], a[184:187], v[144:159]
    s_add_u32 m0, s60, 24576
    s_nop 0
    buffer_load_dwordx4 v4, s[36:39], s44 offen lds
    s_add_u32 m0, s60, 28672
    s_add_u32 s44, s44, s46
    buffer_load_dwordx4 v4, s[40:43], s45 offen lds
    s_add_u32 s45, s45, s46
    s_waitcnt lgkmcnt(6)
    v_mfma_f32_32x32x16_bf16 v[160:175], v[116:119], a[24:27], v[160:175]
    ds_read_b64_tr_b16 v[100:101], v3 offset:12288
    ds_read_b64_tr_b16 v[102:103], v3 offset:13312
    v_mfma_f32_32x32x16_bf16 v[176:191], v[116:119], a[184:187], v[176:191]
    s_waitcnt lgkmcnt(6)
    v_mfma_f32_32x32x16_bf16 v[128:143], v[120:123], a[28:31], v[128:143]
    ds_read_b64_tr_b16 v[104:105], v3 offset:8704
    ds_read_b64_tr_b16 v[106:107], v3 offset:9728
    v_mfma_f32_32x32x16_bf16 v[144:159], v[120:123], a[188:191], v[144:159]
    s_waitcnt lgkmcnt(6)
    v_mfma_f32_32x32x16_bf16 v[160:175], v[124:127], a[28:31], v[160:175]
    ds_read_b64_tr_b16 v[108:109], v3 offset:12800
    ds_read_b64_tr_b16 v[110:111], v3 offset:13824
    v_mfma_f32_32x32x16_bf16 v[176:191], v[124:127], a[188:191], v[176:191]
    s_waitcnt lgkmcnt(6)
    v_mfma_f32_32x32x16_bf16 v[128:143], v[96:99], a[32:35], v[128:143]
    ds_read_b64_tr_b16 v[112:113], v3 offset:10240
    ds_read_b64_tr_b16 v[114:115], v3 offset:11264
    v_mfma_f32_32x32x16_bf16 v[144:159], v[96:99], a[192:195], v[144:159]
    s_waitcnt lgkmcnt(6)
    v_mfma_f32_32x32x16_bf16 v[160:175], v[100:103], a[32:35], v[160:175]
    ds_read_b64_tr_b16 v[116:117], v3 offset:14336
    ds_read_b64_tr_b16 v[118:119], v3 offset:15360
    v_mfma_f32_32x32x16_bf16 v[176:191], v[100:103], a[192:195], v[176:191]
    s_waitcnt lgkmcnt(6)
    v_mfma_f32_32x32x16_bf16 v[128:143], v[104:107], a[36:39], v[128:143]
    ds_read_b64_tr_b16 v[120:121], v3 offset:10752
    ds_read_b64_tr_b16 v[122:123], v3 offset:11776
    v_mfma_f32_32x32x16_bf16 v[144:159], v[104:107], a[196:199], v[144:159]
    s_waitcnt lgkmcnt(6)
    v_mfma_f32_32x32x16_bf16 v[160:175], v[108:111], a[36:39], v[160:175]
    ds_read_b64_tr_b16 v[124:125], v3 offset:14848
    ds_read_b64_tr_b16 v[126:127], v3 offset:15872
    v_mfma_f32_32x32x16_bf16 v[176:191], v[108:111], a[196:199], v[176:191]
    s_waitcnt lgkmcnt(6)
    v_mfma_f32_32x32x16_bf16 v[128:143], v[112:115], a[40:43], v[128:143]
    s_waitcnt vmcnt(16)
    s_barrier
    ds_read_b64_tr_b16 v[96:97], v3 offset:16384
    ds_read_b64_tr_b16 v[98:99], v3 offset:17408
    v_mfma_f32_32x32x16_bf16 v[144:159], v[112:115], a[200:203], v[144:159]
    s_add_u32 m0, s60, 32768
    s_nop 0
    buffer_load_dwordx4 v4, s[36:39], s44 offen lds
    s_add_u32 m0, s60, 36864
    s_add_u32 s44, s44, s46
    buffer_load_dwordx4 v4, s[40:43], s45 offen lds
    s_add_u32 s45, s45, s46
    s_waitcnt lgkmcnt(6)
    v_mfma_f32_32x32x16_bf16 v[160:175], v[116:119], a[40:43], v[160:175]
    ds_read_b64_tr_b16 v[100:101], v3 offset:20480
    ds_read_b64_tr_b16 v[102:103], v3 offset:21504
    v_mfma_f32_32x32x16_bf16 v[176:191], v[116:119], a[200:203], v[176:191]
    s_waitcnt lgkmcnt(6)
    v_mfma_f32_32x32x16_bf16 v[128:143], v[120:123], a[44:47], v[128:143]
    ds_read_b64_tr_b16 v[104:105], v3 offset:16896
    ds_read_b64_tr_b16 v[106:107], v3 offset:17920
    v_mfma_f32_32x32x16_bf16 v[144:159], v[120:123], a[204:207], v[144:159]
    s_waitcnt lgkmcnt(6)
    v_mfma_f32_32x32x16_bf16 v[160:175], v[124:127], a[44:47], v[160:175]
    ds_read_b64_tr_b16 v[108:109], v3 offset:20992
    ds_read_b64_tr_b16 v[110:111], v3 offset:22016
    v_mfma_f32_32x32x16_bf16 v[176:191], v[124:127], a[204:207], v[176:191]
    s_waitcnt lgkmcnt(6)
    v_mfma_f32_32x32x16_bf16 v[128:143], v[96:99], a[48:51], v[128:143]
    ds_read_b64_tr_b16 v[112:113], v3 offset:18432
    ds_read_b64_tr_b16 v[114:115], v3 offset:19456
    v_mfma_f32_32x32x16_bf16 v[144:159], v[96:99], a[208:211], v[144:159]
    s_waitcnt lgkmcnt(6)
    v_mfma_f32_32x32x16_bf16 v[160:175], v[100:103], a[48:51], v[160:175]
    ds_read_b64_tr_b16 v[116:117], v3 offset:22528
    ds_read_b64_tr_b16 v[118:119], v3 offset:23552
    v_mfma_f32_32x32x16_bf16 v[176:191], v[100:103], a[208:211], v[176:191]
    s_waitcnt lgkmcnt(6)
    v_mfma_f32_32x32x16_bf16 v[128:143], v[104:107], a[52:55], v[128:143]
    ds_read_b64_tr_b16 v[120:121], v3 offset:18944
    ds_read_b64_tr_b16 v[122:123], v3 offset:19968
    v_mfma_f32_32x32x16_bf16 v[144:159], v[104:107], a[212:215], v[144:159]
    s_waitcnt lgkmcnt(6)
    v_mfma_f32_32x32x16_bf16 v[160:175], v[108:111], a[52:55], v[160:175]
    ds_read_b64_tr_b16 v[124:125], v3 offset:23040
    ds_read_b64_tr_b16 v[126:127], v3 offset:24064
    v_mfma_f32_32x32x16_bf16 v[176:191], v[108:111], a[212:215], v[176:191]
    s_waitcnt lgkmcnt(6)
    v_mfma_f32_32x32x16_bf16 v[128:143], v[112:115], a[56:59], v[128:143]
    s_waitcnt vmcnt(12)
    s_barrier
    ds_read_b64_tr_b16 v[96:97], v3 offset:24576
    ds_read_b64_tr_b16 v[98:99], v3 offset:25600
    v_mfma_f32_32x32x16_bf16 v[144:159], v[112:115], a[216:219], v[144:159]
    s_add_u32 m0, s60, 40960
    s_nop 0
    buffer_load_dwordx4 v4, s[36:39], s44 offen lds
    s_add_u32 m0, s60, 45056
    s_add_u32 s44, s44, s46
    buffer_load_dwordx4 v4, s[40:43], s45 offen lds
    s_add_u32 s45, s45, s46
    s_waitcnt lgkmcnt(6)
    v_mfma_f32_32x32x16_bf16 v[160:175], v[116:119], a[56:59], v[160:175]
    ds_read_b64_tr_b16 v[100:101], v3 offset:28672
    ds_read_b64_tr_b16 v[102:103], v3 offset:29696
    v_mfma_f32_32x32x16_bf16 v[176:191], v[116:119], a[216:219], v[176:191]
    s_waitcnt lgkmcnt(6)
    v_mfma_f32_32x32x16_bf16 v[128:143], v[120:123], a[60:63], v[128:143]
    ds_read_b64_tr_b16 v[104:105], v3 offset:25088
    ds_read_b64_tr_b16 v[106:107], v3 offset:26112
    v_mfma_f32_32x32x16_bf16 v[144:159], v[120:123], a[220:223], v[144:159]
    s_waitcnt lgkmcnt(6)
    v_mfma_f32_32x32x16_bf16 v[160:175], v[124:127], a[60:63], v[160:175]
    ds_read_b64_tr_b16 v[108:109], v3 offset:29184
    ds_read_b64_tr_b16 v[110:111], v3 offset:30208
    v_mfma_f32_32x32x16_bf16 v[176:191], v[124:127], a[220:223], v[176:191]
    s_waitcnt lgkmcnt(6)
    v_mfma_f32_32x32x16_bf16 v[128:143], v[96:99], a[64:67], v[128:143]
    ds_read_b64_tr_b16 v[112:113], v3 offset:26624
    ds_read_b64_tr_b16 v[114:115], v3 offset:27648
    v_mfma_f32_32x32x16_bf16 v[144:159], v[96:99], a[224:227], v[144:159]
    s_waitcnt lgkmcnt(6)
    v_mfma_f32_32x32x16_bf16 v[160:175], v[100:103], a[64:67], v[160:175]
    ds_read_b64_tr_b16 v[116:117], v3 offset:30720
    ds_read_b64_tr_b16 v[118:119], v3 offset:31744
    v_mfma_f32_32x32x16_bf16 v[176:191], v[100:103], a[224:227], v[176:191]
    s_waitcnt lgkmcnt(6)
    v_mfma_f32_32x32x16_bf16 v[128:143], v[104:107], a[68:71], v[128:143]
    ds_read_b64_tr_b16 v[120:121], v3 offset:27136
    ds_read_b64_tr_b16 v[122:123], v3 offset:28160
    v_mfma_f32_32x32x16_bf16 v[144:159], v[104:107], a[228:231], v[144:159]
    s_waitcnt lgkmcnt(6)
    v_mfma_f32_32x32x16_bf16 v[160:175], v[108:111], a[68:71], v[160:175]
    ds_read_b64_tr_b16 v[124:125], v3 offset:31232
    ds_read_b64_tr_b16 v[126:127], v3 offset:32256
    v_mfma_f32_32x32x16_bf16 v[176:191], v[108:111], a[228:231], v[176:191]
    s_waitcnt lgkmcnt(6)
    v_mfma_f32_32x32x16_bf16 v[128:143], v[112:115], a[72:75], v[128:143]
    s_waitcnt vmcnt(12)
    s_barrier
    ds_read_b64_tr_b16 v[96:97], v3 offset:32768
    ds_read_b64_tr_b16 v[98:99], v3 offset:33792
    v_mfma_f32_32x32x16_bf16 v[144:159], v[112:115], a[232:235], v[144:159]
    s_add_u32 m0, s60, 49152
    s_nop 0
    buffer_load_dwordx4 v4, s[36:39], s44 offen lds
    s_add_u32 m0, s60, 53248
    s_add_u32 s44, s44, s46
    buffer_load_dwordx4 v4, s[40:43], s45 offen lds
    s_add_u32 s45, s45, s46
    s_waitcnt lgkmcnt(6)
    v_mfma_f32_32x32x16_bf16 v[160:175], v[116:119], a[72:75], v[160:175]
    ds_read_b64_tr_b16 v[100:101], v3 offset:36864
    ds_read_b64_tr_b16 v[102:103], v3 offset:37888
    v_mfma_f32_32x32x16_bf16 v[176:191], v[116:119], a[232:235], v[176:191]
    s_waitcnt lgkmcnt(6)
    v_mfma_f32_32x32x16_bf16 v[128:143], v[120:123], a[76:79], v[128:143]
    ds_read_b64_tr_b16 v[104:105], v3 offset:33280
    ds_read_b64_tr_b16 v[106:107], v3 offset:34304
    v_mfma_f32_32x32x16_bf16 v[144:159], v[120:123], a[236:239], v[144:159]
    s_waitcnt lgkmcnt(6)
    v_mfma_f32_32x32x16_bf16 v[160:175], v[124:127], a[76:79], v[160:175]
    ds_read_b64_tr_b16 v[108:109], v3 offset:37376
    ds_read_b64_tr_b16 v[110:111], v3 offset:38400
    v_mfma_f32_32x32x16_bf16 v[176:191], v[124:127], a[236:239], v[176:191]
    s_waitcnt lgkmcnt(6)
    v_mfma_f32_32x32x16_bf16 v[128:143], v[96:99], a[80:83], v[128:143]
    ds_read_b64_tr_b16 v[112:113], v3 offset:34816
    ds_read_b64_tr_b16 v[114:115], v3 offset:35840
    v_mfma_f32_32x32x16_bf16 v[144:159], v[96:99], a[240:243], v[144:159]
    s_waitcnt lgkmcnt(6)
    v_mfma_f32_32x32x16_bf16 v[160:175], v[100:103], a[80:83], v[160:175]
    ds_read_b64_tr_b16 v[116:117], v3 offset:38912
    ds_read_b64_tr_b16 v[118:119], v3 offset:39936
    v_mfma_f32_32x32x16_bf16 v[176:191], v[100:103], a[240:243], v[176:191]
    s_waitcnt lgkmcnt(6)
    v_mfma_f32_32x32x16_bf16 v[128:143], v[104:107], a[84:87], v[128:143]
    ds_read_b64_tr_b16 v[120:121], v3 offset:35328
    ds_read_b64_tr_b16 v[122:123], v3 offset:36352
    v_mfma_f32_32x32x16_bf16 v[144:159], v[104:107], a[244:247], v[144:159]
    s_waitcnt lgkmcnt(6)
    v_mfma_f32_32x32x16_bf16 v[160:175], v[108:111], a[84:87], v[160:175]
    ds_read_b64_tr_b16 v[124:125], v3 offset:39424
    ds_read_b64_tr_b16 v[126:127], v3 offset:40448
    v_mfma_f32_32x32x16_bf16 v[176:191], v[108:111], a[244:247], v[176:191]
    s_waitcnt lgkmcnt(6)
    v_mfma_f32_32x32x16_bf16 v[128:143], v[112:115], a[88:91], v[128:143]
    s_waitcnt vmcnt(12)
    s_barrier
    ds_read_b64_tr_b16 v[96:97], v2 offset:0
    ds_read_b64_tr_b16 v[98:99], v2 offset:1024
    v_mfma_f32_32x32x16_bf16 v[144:159], v[112:115], a[248:251], v[144:159]
    s_add_u32 m0, s60, 57344
    s_nop 0
    buffer_load_dwordx4 v4, s[36:39], s44 offen lds
    s_add_u32 m0, s60, 61440
    s_add_u32 s44, s44, s46
    buffer_load_dwordx4 v4, s[40:43], s45 offen lds
    s_add_u32 s45, s45, s46
    s_waitcnt lgkmcnt(6)
    v_mfma_f32_32x32x16_bf16 v[160:175], v[116:119], a[88:91], v[160:175]
    ds_read_b64_tr_b16 v[100:101], v2 offset:4096
    ds_read_b64_tr_b16 v[102:103], v2 offset:5120
    v_mfma_f32_32x32x16_bf16 v[176:191], v[116:119], a[248:251], v[176:191]
    s_waitcnt lgkmcnt(6)
    v_mfma_f32_32x32x16_bf16 v[128:143], v[120:123], a[92:95], v[128:143]
    ds_read_b64_tr_b16 v[104:105], v2 offset:512
    ds_read_b64_tr_b16 v[106:107], v2 offset:1536
    v_mfma_f32_32x32x16_bf16 v[144:159], v[120:123], a[252:255], v[144:159]
    s_waitcnt lgkmcnt(6)
    v_mfma_f32_32x32x16_bf16 v[160:175], v[124:127], a[92:95], v[160:175]
    ds_read_b64_tr_b16 v[108:109], v2 offset:4608
    ds_read_b64_tr_b16 v[110:111], v2 offset:5632
    v_mfma_f32_32x32x16_bf16 v[176:191], v[124:127], a[252:255], v[176:191]
    v_cvt_pk_bf16_f32 v64, v128, v129
    v_cvt_pk_bf16_f32 v65, v130, v131
    v_cvt_pk_bf16_f32 v66, v136, v137
    v_cvt_pk_bf16_f32 v67, v138, v139
    buffer_store_dwordx4 v[64:67], v7, s[32:35], s49 offen offset:0 sc1
    v_cvt_pk_bf16_f32 v68, v132, v133
    v_cvt_pk_bf16_f32 v69, v134, v135
    v_cvt_pk_bf16_f32 v70, v140, v141
    v_cvt_pk_bf16_f32 v71, v142, v143
    buffer_store_dwordx4 v[68:71], v7, s[32:35], s49 offen offset:512 sc1
    v_cvt_pk_bf16_f32 v72, v144, v145
    v_cvt_pk_bf16_f32 v73, v146, v147
    v_cvt_pk_bf16_f32 v74, v152, v153
    v_cvt_pk_bf16_f32 v75, v154, v155
    buffer_store_dwordx4 v[72:75], v7, s[32:35], s50 offen offset:0 sc1
    v_cvt_pk_bf16_f32 v76, v148, v149
    v_cvt_pk_bf16_f32 v77, v150, v151
    v_cvt_pk_bf16_f32 v78, v156, v157
    v_cvt_pk_bf16_f32 v79, v158, v159
    buffer_store_dwordx4 v[76:79], v7, s[32:35], s50 offen offset:512 sc1
    v_cvt_pk_bf16_f32 v80, v160, v161
    v_cvt_pk_bf16_f32 v81, v162, v163
    v_cvt_pk_bf16_f32 v82, v168, v169
    v_cvt_pk_bf16_f32 v83, v170, v171
    buffer_store_dwordx4 v[80:83], v7, s[32:35], s49 offen offset:2048 sc1
    v_cvt_pk_bf16_f32 v84, v164, v165
    v_cvt_pk_bf16_f32 v85, v166, v167
    v_cvt_pk_bf16_f32 v86, v172, v173
    v_cvt_pk_bf16_f32 v87, v174, v175
    buffer_store_dwordx4 v[84:87], v7, s[32:35], s49 offen offset:2560 sc1
    v_cvt_pk_bf16_f32 v88, v176, v177
    v_cvt_pk_bf16_f32 v89, v178, v179
    v_cvt_pk_bf16_f32 v90, v184, v185
    v_cvt_pk_bf16_f32 v91, v186, v187
    buffer_store_dwordx4 v[88:91], v7, s[32:35], s50 offen offset:2048 sc1
    v_cvt_pk_bf16_f32 v92, v180, v181
    v_cvt_pk_bf16_f32 v93, v182, v183
    v_cvt_pk_bf16_f32 v94, v188, v189
    v_cvt_pk_bf16_f32 v95, v190, v191
    buffer_store_dwordx4 v[92:95], v7, s[32:35], s50 offen offset:2560 sc1
    s_bfe_u32 s53, s47, 0x100008
    s_branch L_gx_next
L_gx_v:
    s_waitcnt lgkmcnt(6)
    v_mfma_f32_32x32x16_bf16 v[128:143], v[192:195], v[96:99], 0
    ds_read_b64_tr_b16 v[112:113], v2 offset:2048
    ds_read_b64_tr_b16 v[114:115], v2 offset:3072
    v_mfma_f32_32x32x16_bf16 v[144:159], a[96:99], v[96:99], 0
    s_waitcnt lgkmcnt(6)
    v_mfma_f32_32x32x16_bf16 v[160:175], v[192:195], v[100:103], 0
    ds_read_b64_tr_b16 v[116:117], v2 offset:6144
    ds_read_b64_tr_b16 v[118:119], v2 offset:7168
    v_mfma_f32_32x32x16_bf16 v[176:191], a[96:99], v[100:103], 0
    s_waitcnt lgkmcnt(6)
    v_mfma_f32_32x32x16_bf16 v[128:143], v[196:199], v[104:107], v[128:143]
    ds_read_b64_tr_b16 v[120:121], v2 offset:2560
    ds_read_b64_tr_b16 v[122:123], v2 offset:3584
    v_mfma_f32_32x32x16_bf16 v[144:159], a[100:103], v[104:107], v[144:159]
    s_waitcnt lgkmcnt(6)
    v_mfma_f32_32x32x16_bf16 v[160:175], v[196:199], v[108:111], v[160:175]
    ds_read_b64_tr_b16 v[124:125], v2 offset:6656
    ds_read_b64_tr_b16 v[126:127], v2 offset:7680
    v_mfma_f32_32x32x16_bf16 v[176:191], a[100:103], v[108:111], v[176:191]
    s_waitcnt lgkmcnt(6)
    v_mfma_f32_32x32x16_bf16 v[128:143], v[200:203], v[112:115], v[128:143]
    s_waitcnt vmcnt(16)
    s_barrier
    ds_read_b64_tr_b16 v[96:97], v2 offset:8192
    ds_read_b64_tr_b16 v[98:99], v2 offset:9216
    v_mfma_f32_32x32x16_bf16 v[144:159], a[104:107], v[112:115], v[144:159]
    s_add_u32 m0, s60, 65536
    s_nop 0
    buffer_load_dwordx4 v4, s[36:39], s44 offen lds
    s_add_u32 m0, s60, 69632
    s_add_u32 s44, s44, s46
    buffer_load_dwordx4 v4, s[40:43], s45 offen lds
    s_add_u32 s45, s45, s46
    s_waitcnt lgkmcnt(6)
    v_mfma_f32_32x32x16_bf16 v[160:175], v[200:203], v[116:119], v[160:175]
    ds_read_b64_tr_b16 v[100:101], v2 offset:12288
    ds_read_b64_tr_b16 v[102:103], v2 offset:13312
    v_mfma_f32_32x32x16_bf16 v[176:191], a[104:107], v[116:119], v[176:191]
    s_waitcnt lgkmcnt(6)
    v_mfma_f32_32x32x16_bf16 v[128:143], v[204:207], v[120:123], v[128:143]
    ds_read_b64_tr_b16 v[104:105], v2 offset:8704
    ds_read_b64_tr_b16 v[106:107], v2 offset:9728
    v_mfma_f32_32x32x16_bf16 v[144:159], a[108:111], v[120:123], v[144:159]
    s_waitcnt lgkmcnt(6)
    v_mfma_f32_32x32x16_bf16 v[160:175], v[204:207], v[124:127], v[160:175]
    ds_read_b64_tr_b16 v[108:109], v2 offset:12800
    ds_read_b64_tr_b16 v[110:111], v2 offset:13824
    v_mfma_f32_32x32x16_bf16 v[176:191], a[108:111], v[124:127], v[176:191]
    s_waitcnt lgkmcnt(6)
    v_mfma_f32_32x32x16_bf16 v[128:143], v[208:211], v[96:99], v[128:143]
    ds_read_b64_tr_b16 v[112:113], v2 offset:10240
    ds_read_b64_tr_b16 v[114:115], v2 offset:11264
    v_mfma_f32_32x32x16_bf16 v[144:159], a[112:115], v[96:99], v[144:159]
    s_waitcnt lgkmcnt(6)
    v_mfma_f32_32x32x16_bf16 v[160:175], v[208:211], v[100:103], v[160:175]
    ds_read_b64_tr_b16 v[116:117], v2 offset:14336
    ds_read_b64_tr_b16 v[118:119], v2 offset:15360
    v_mfma_f32_32x32x16_bf16 v[176:191], a[112:115], v[100:103], v[176:191]
    s_waitcnt lgkmcnt(6)
    v_mfma_f32_32x32x16_bf16 v[128:143], v[212:215], v[104:107], v[128:143]
    ds_read_b64_tr_b16 v[120:121], v2 offset:10752
    ds_read_b64_tr_b16 v[122:123], v2 offset:11776
    v_mfma_f32_32x32x16_bf16 v[144:159], a[116:119], v[104:107], v[144:159]
    s_waitcnt lgkmcnt(6)
    v_mfma_f32_32x32x16_bf16 v[160:175], v[212:215], v[108:111], v[160:175]
    ds_read_b64_tr_b16 v[124:125], v2 offset:14848
    ds_read_b64_tr_b16 v[126:127], v2 offset:15872
    v_mfma_f32_32x32x16_bf16 v[176:191], a[116:119], v[108:111], v[176:191]
    s_waitcnt lgkmcnt(6)
    v_mfma_f32_32x32x16_bf16 v[128:143], v[216:219], v[112:115], v[128:143]
    s_waitcnt vmcnt(16)
    s_barrier
    ds_read_b64_tr_b16 v[96:97], v2 offset:16384
    ds_read_b64_tr_b16 v[98:99], v2 offset:17408
    v_mfma_f32_32x32x16_bf16 v[144:159], a[120:123], v[112:115], v[144:159]
    s_add_u32 m0, s60, 73728
    s_nop 0
    buffer_load_dwordx4 v4, s[36:39], s44 offen lds
    s_add_u32 m0, s60, 77824
    s_add_u32 s44, s44, s46
    buffer_load_dwordx4 v4, s[40:43], s45 offen lds
    s_add_u32 s45, s45, s46
    s_waitcnt lgkmcnt(6)
    v_mfma_f32_32x32x16_bf16 v[160:175], v[216:219], v[116:119], v[160:175]
    ds_read_b64_tr_b16 v[100:101], v2 offset:20480
    ds_read_b64_tr_b16 v[102:103], v2 offset:21504
    v_mfma_f32_32x32x16_bf16 v[176:191], a[120:123], v[116:119], v[176:191]
    s_waitcnt lgkmcnt(6)
    v_mfma_f32_32x32x16_bf16 v[128:143], v[220:223], v[120:123], v[128:143]
    ds_read_b64_tr_b16 v[104:105], v2 offset:16896
    ds_read_b64_tr_b16 v[106:107], v2 offset:17920
    v_mfma_f32_32x32x16_bf16 v[144:159], a[124:127], v[120:123], v[144:159]
    s_waitcnt lgkmcnt(6)
    v_mfma_f32_32x32x16_bf16 v[160:175], v[220:223], v[124:127], v[160:175]
    ds_read_b64_tr_b16 v[108:109], v2 offset:20992
    ds_read_b64_tr_b16 v[110:111], v2 offset:22016
    v_mfma_f32_32x32x16_bf16 v[176:191], a[124:127], v[124:127], v[176:191]
    s_waitcnt lgkmcnt(6)
    v_mfma_f32_32x32x16_bf16 v[128:143], v[224:227], v[96:99], v[128:143]
    ds_read_b64_tr_b16 v[112:113], v2 offset:18432
    ds_read_b64_tr_b16 v[114:115], v2 offset:19456
    v_mfma_f32_32x32x16_bf16 v[144:159], a[128:131], v[96:99], v[144:159]
    s_waitcnt lgkmcnt(6)
    v_mfma_f32_32x32x16_bf16 v[160:175], v[224:227], v[100:103], v[160:175]
    ds_read_b64_tr_b16 v[116:117], v2 offset:22528
    ds_read_b64_tr_b16 v[118:119], v2 offset:23552
    v_mfma_f32_32x32x16_bf16 v[176:191], a[128:131], v[100:103], v[176:191]
    s_waitcnt lgkmcnt(6)
    v_mfma_f32_32x32x16_bf16 v[128:143], v[228:231], v[104:107], v[128:143]
    ds_read_b64_tr_b16 v[120:121], v2 offset:18944
    ds_read_b64_tr_b16 v[122:123], v2 offset:19968
    v_mfma_f32_32x32x16_bf16 v[144:159], a[132:135], v[104:107], v[144:159]
    s_waitcnt lgkmcnt(6)
    v_mfma_f32_32x32x16_bf16 v[160:175], v[228:231], v[108:111], v[160:175]
    ds_read_b64_tr_b16 v[124:125], v2 offset:23040
    ds_read_b64_tr_b16 v[126:127], v2 offset:24064
    v_mfma_f32_32x32x16_bf16 v[176:191], a[132:135], v[108:111], v[176:191]
    s_waitcnt lgkmcnt(6)
    v_mfma_f32_32x32x16_bf16 v[128:143], v[232:235], v[112:115], v[128:143]
    s_waitcnt vmcnt(16)
    s_barrier
    ds_read_b64_tr_b16 v[96:97], v2 offset:24576
    ds_read_b64_tr_b16 v[98:99], v2 offset:25600
    v_mfma_f32_32x32x16_bf16 v[144:159], a[136:139], v[112:115], v[144:159]
    s_bitcmp1_b32 s47, 23
    s_cselect_b32 s59, 255, s64
    s_and_b32 s54, s59, 255
    s_cmp_ge_u32 s54, 192
    s_cbranch_scc1 L_dg_V
    s_lshr_b32 s55, s54, 6
    s_cmp_eq_u32 s55, 1
    s_cselect_b32 s36, s12, s10
    s_cselect_b32 s37, s13, s11
    s_cmp_eq_u32 s55, 2
    s_cselect_b32 s36, s8, s36
    s_cselect_b32 s37, s9, s37
    s_mov_b32 s40, s36
    s_mov_b32 s41, s37
    s_mov_b32 s38, 5242880
    s_mov_b32 s42, 5242880
    s_and_b32 s54, s54, 63
    s_lshl_b32 s44, s54, 7
    s_add_u32 s45, s44, 64
    s_mov_b32 s46, 524288
    v_mov_b32 v4, v5
    s_branch L_dd_V
L_dg_V:
    s_mov_b32 s36, s20
    s_mov_b32 s37, s21
    s_mov_b32 s40, s22
    s_mov_b32 s41, s23
    s_cmp_eq_u32 s54, 255
    s_cselect_b32 s38, 0, 2211840
    s_mov_b32 s42, s38
    s_sub_u32 s54, s54, 192
    s_lshl_b32 s44, s54, 6
    s_mov_b32 s45, s44
    s_mov_b32 s46, 221184
    v_mov_b32 v4, v6
L_dd_V:
    s_add_u32 m0, s60, 0
    s_nop 0
    buffer_load_dwordx4 v4, s[36:39], s44 offen lds
    s_add_u32 m0, s60, 4096
    s_add_u32 s44, s44, s46
    buffer_load_dwordx4 v4, s[40:43], s45 offen lds
    s_add_u32 s45, s45, s46
    s_waitcnt lgkmcnt(6)
    v_mfma_f32_32x32x16_bf16 v[160:175], v[232:235], v[116:119], v[160:175]
    ds_read_b64_tr_b16 v[100:101], v2 offset:28672
    ds_read_b64_tr_b16 v[102:103], v2 offset:29696
    v_mfma_f32_32x32x16_bf16 v[176:191], a[136:139], v[116:119], v[176:191]
    s_waitcnt lgkmcnt(6)
    v_mfma_f32_32x32x16_bf16 v[128:143], v[236:239], v[120:123], v[128:143]
    ds_read_b64_tr_b16 v[104:105], v2 offset:25088
    ds_read_b64_tr_b16 v[106:107], v2 offset:26112
    v_mfma_f32_32x32x16_bf16 v[144:159], a[140:143], v[120:123], v[144:159]
    s_waitcnt lgkmcnt(6)
    v_mfma_f32_32x32x16_bf16 v[160:175], v[236:239], v[124:127], v[160:175]
    ds_read_b64_tr_b16 v[108:109], v2 offset:29184
    ds_read_b64_tr_b16 v[110:111], v2 offset:30208
    v_mfma_f32_32x32x16_bf16 v[176:191], a[140:143], v[124:127], v[176:191]
    s_waitcnt lgkmcnt(6)
    v_mfma_f32_32x32x16_bf16 v[128:143], v[240:243], v[96:99], v[128:143]
    ds_read_b64_tr_b16 v[112:113], v2 offset:26624
    ds_read_b64_tr_b16 v[114:115], v2 offset:27648
    v_mfma_f32_32x32x16_bf16 v[144:159], a[144:147], v[96:99], v[144:159]
    s_waitcnt lgkmcnt(6)
    v_mfma_f32_32x32x16_bf16 v[160:175], v[240:243], v[100:103], v[160:175]
    ds_read_b64_tr_b16 v[116:117], v2 offset:30720
    ds_read_b64_tr_b16 v[118:119], v2 offset:31744
    v_mfma_f32_32x32x16_bf16 v[176:191], a[144:147], v[100:103], v[176:191]
    s_waitcnt lgkmcnt(6)
    v_mfma_f32_32x32x16_bf16 v[128:143], v[244:247], v[104:107], v[128:143]
    ds_read_b64_tr_b16 v[120:121], v2 offset:27136
    ds_read_b64_tr_b16 v[122:123], v2 offset:28160
    v_mfma_f32_32x32x16_bf16 v[144:159], a[148:151], v[104:107], v[144:159]
    s_waitcnt lgkmcnt(6)
    v_mfma_f32_32x32x16_bf16 v[160:175], v[244:247], v[108:111], v[160:175]
    ds_read_b64_tr_b16 v[124:125], v2 offset:31232
    ds_read_b64_tr_b16 v[126:127], v2 offset:32256
    v_mfma_f32_32x32x16_bf16 v[176:191], a[148:151], v[108:111], v[176:191]
    s_waitcnt lgkmcnt(6)
    v_mfma_f32_32x32x16_bf16 v[128:143], v[248:251], v[112:115], v[128:143]
    s_waitcnt vmcnt(16)
    s_barrier
    ds_read_b64_tr_b16 v[96:97], v2 offset:32768
    ds_read_b64_tr_b16 v[98:99], v2 offset:33792
    v_mfma_f32_32x32x16_bf16 v[144:159], a[152:155], v[112:115], v[144:159]
    s_add_u32 m0, s60, 8192
    s_nop 0
    buffer_load_dwordx4 v4, s[36:39], s44 offen lds
    s_add_u32 m0, s60, 12288
    s_add_u32 s44, s44, s46
    buffer_load_dwordx4 v4, s[40:43], s45 offen lds
    s_add_u32 s45, s45, s46
    s_waitcnt lgkmcnt(6)
    v_mfma_f32_32x32x16_bf16 v[160:175], v[248:251], v[116:119], v[160:175]
    ds_read_b64_tr_b16 v[100:101], v2 offset:36864
    ds_read_b64_tr_b16 v[102:103], v2 offset:37888
    v_mfma_f32_32x32x16_bf16 v[176:191], a[152:155], v[116:119], v[176:191]
    s_waitcnt lgkmcnt(6)
    v_mfma_f32_32x32x16_bf16 v[128:143], v[252:255], v[120:123], v[128:143]
    ds_read_b64_tr_b16 v[104:105], v2 offset:33280
    ds_read_b64_tr_b16 v[106:107], v2 offset:34304
    v_mfma_f32_32x32x16_bf16 v[144:159], a[156:159], v[120:123], v[144:159]
    s_waitcnt lgkmcnt(6)
    v_mfma_f32_32x32x16_bf16 v[160:175], v[252:255], v[124:127], v[160:175]
    ds_read_b64_tr_b16 v[108:109], v2 offset:37376
    ds_read_b64_tr_b16 v[110:111], v2 offset:38400
    v_mfma_f32_32x32x16_bf16 v[176:191], a[156:159], v[124:127], v[176:191]
    s_waitcnt lgkmcnt(6)
    v_mfma_f32_32x32x16_bf16 v[128:143], a[0:3], v[96:99], v[128:143]
    ds_read_b64_tr_b16 v[112:113], v2 offset:34816
    ds_read_b64_tr_b16 v[114:115], v2 offset:35840
    v_mfma_f32_32x32x16_bf16 v[144:159], a[160:163], v[96:99], v[144:159]
    s_waitcnt lgkmcnt(6)
    v_mfma_f32_32x32x16_bf16 v[160:175], a[0:3], v[100:103], v[160:175]
    ds_read_b64_tr_b16 v[116:117], v2 offset:38912
    ds_read_b64_tr_b16 v[118:119], v2 offset:39936
    v_mfma_f32_32x32x16_bf16 v[176:191], a[160:163], v[100:103], v[176:191]
    s_waitcnt lgkmcnt(6)
    v_mfma_f32_32x32x16_bf16 v[128:143], a[4:7], v[104:107], v[128:143]
    ds_read_b64_tr_b16 v[120:121], v2 offset:35328
    ds_read_b64_tr_b16 v[122:123], v2 offset:36352
    v_mfma_f32_32x32x16_bf16 v[144:159], a[164:167], v[104:107], v[144:159]
    s_waitcnt lgkmcnt(6)
    v_mfma_f32_32x32x16_bf16 v[160:175], a[4:7], v[108:111], v[160:175]
    ds_read_b64_tr_b16 v[124:125], v2 offset:39424
    ds_read_b64_tr_b16 v[126:127], v2 offset:40448
    v_mfma_f32_32x32x16_bf16 v[176:191], a[164:167], v[108:111], v[176:191]
    s_waitcnt lgkmcnt(6)
    v_mfma_f32_32x32x16_bf16 v[128:143], a[8:11], v[112:115], v[128:143]
    s_cmp_eq_u32 s53, 0
    s_cbranch_scc1 L_lax_V
    s_waitcnt vmcnt(8)
L_lax_V:
    s_waitcnt vmcnt(16)
    s_barrier
    ds_read_b64_tr_b16 v[96:97], v3 offset:0
    ds_read_b64_tr_b16 v[98:99], v3 offset:1024
    v_mfma_f32_32x32x16_bf16 v[144:159], a[168:171], v[112:115], v[144:159]
    s_add_u32 m0, s60, 16384
    s_nop 0
    buffer_load_dwordx4 v4, s[36:39], s44 offen lds
    s_add_u32 m0, s60, 20480
    s_add_u32 s44, s44, s46
    buffer_load_dwordx4 v4, s[40:43], s45 offen lds
    s_add_u32 s45, s45, s46
    s_cmp_eq_u32 s53, 0
    s_cbranch_scc1 L_ns_V
    s_cmp_lg_u32 s51, 0
    s_cbranch_scc1 L_ns2_V
    s_and_b32 s54, s53, 255
    s_lshl_b32 s54, s54, 3
    s_and_b32 s55, s2, 7
    s_add_u32 s54, s54, s55
    s_lshl_b32 s54, s54, 7
    s_add_u32 s54, s54, 95828992
    s_bfe_u32 s55, s53, 0x70008
    v_mov_b32 v10, s54
    v_mov_b32 v11, s55
    s_mov_b64 exec, 1
    buffer_atomic_add v11, v10, s[32:35], 0 offen
    s_mov_b64 exec, -1
L_ns2_V:
    s_mov_b32 s53, 0
L_ns_V:
    s_waitcnt lgkmcnt(6)
    v_mfma_f32_32x32x16_bf16 v[160:175], a[8:11], v[116:119], v[160:175]
    ds_read_b64_tr_b16 v[100:101], v3 offset:4096
    ds_read_b64_tr_b16 v[102:103], v3 offset:5120
    v_mfma_f32_32x32x16_bf16 v[176:191], a[168:171], v[116:119], v[176:191]
    s_waitcnt lgkmcnt(6)
    v_mfma_f32_32x32x16_bf16 v[128:143], a[12:15], v[120:123], v[128:143]
    ds_read_b64_tr_b16 v[104:105], v3 offset:512
    ds_read_b64_tr_b16 v[106:107], v3 offset:1536
    v_mfma_f32_32x32x16_bf16 v[144:159], a[172:175], v[120:123], v[144:159]
    s_waitcnt lgkmcnt(6)
    v_mfma_f32_32x32x16_bf16 v[160:175], a[12:15], v[124:127], v[160:175]
    ds_read_b64_tr_b16 v[108:109], v3 offset:4608
    ds_read_b64_tr_b16 v[110:111], v3 offset:5632
    v_mfma_f32_32x32x16_bf16 v[176:191], a[172:175], v[124:127], v[176:191]
    s_waitcnt lgkmcnt(6)
    v_mfma_f32_32x32x16_bf16 v[128:143], a[16:19], v[96:99], v[128:143]
    ds_read_b64_tr_b16 v[112:113], v3 offset:2048
    ds_read_b64_tr_b16 v[114:115], v3 offset:3072
    v_mfma_f32_32x32x16_bf16 v[144:159], a[176:179], v[96:99], v[144:159]
    s_waitcnt lgkmcnt(6)
    v_mfma_f32_32x32x16_bf16 v[160:175], a[16:19], v[100:103], v[160:175]
    ds_read_b64_tr_b16 v[116:117], v3 offset:6144
    ds_read_b64_tr_b16 v[118:119], v3 offset:7168
    v_mfma_f32_32x32x16_bf16 v[176:191], a[176:179], v[100:103], v[176:191]
    s_waitcnt lgkmcnt(6)
    v_mfma_f32_32x32x16_bf16 v[128:143], a[20:23], v[104:107], v[128:143]
    ds_read_b64_tr_b16 v[120:121], v3 offset:2560
    ds_read_b64_tr_b16 v[122:123], v3 offset:3584
    v_mfma_f32_32x32x16_bf16 v[144:159], a[180:183], v[104:107], v[144:159]
    s_waitcnt lgkmcnt(6)
    v_mfma_f32_32x32x16_bf16 v[160:175], a[20:23], v[108:111], v[160:175]
    ds_read_b64_tr_b16 v[124:125], v3 offset:6656
    ds_read_b64_tr_b16 v[126:127], v3 offset:7680
    v_mfma_f32_32x32x16_bf16 v[176:191], a[180:183], v[108:111], v[176:191]
    s_waitcnt lgkmcnt(6)
    v_mfma_f32_32x32x16_bf16 v[128:143], a[24:27], v[112:115], v[128:143]
    s_waitcnt vmcnt(16)
    s_barrier
    ds_read_b64_tr_b16 v[96:97], v3 offset:8192
    ds_read_b64_tr_b16 v[98:99], v3 offset:9216
    v_mfma_f32_32x32x16_bf16 v[144:159], a[184:187], v[112:115], v[144:159]
    s_add_u32 m0, s60, 24576
    s_nop 0
    buffer_load_dwordx4 v4, s[36:39], s44 offen lds
    s_add_u32 m0, s60, 28672
    s_add_u32 s44, s44, s46
    buffer_load_dwordx4 v4, s[40:43], s45 offen lds
    s_add_u32 s45, s45, s46
    s_waitcnt lgkmcnt(6)
    v_mfma_f32_32x32x16_bf16 v[160:175], a[24:27], v[116:119], v[160:175]
    ds_read_b64_tr_b16 v[100:101], v3 offset:12288
    ds_read_b64_tr_b16 v[102:103], v3 offset:13312
    v_mfma_f32_32x32x16_bf16 v[176:191], a[184:187], v[116:119], v[176:191]
    s_waitcnt lgkmcnt(6)
    v_mfma_f32_32x32x16_bf16 v[128:143], a[28:31], v[120:123], v[128:143]
    ds_read_b64_tr_b16 v[104:105], v3 offset:8704
    ds_read_b64_tr_b16 v[106:107], v3 offset:9728
    v_mfma_f32_32x32x16_bf16 v[144:159], a[188:191], v[120:123], v[144:159]
    s_waitcnt lgkmcnt(6)
    v_mfma_f32_32x32x16_bf16 v[160:175], a[28:31], v[124:127], v[160:175]
    ds_read_b64_tr_b16 v[108:109], v3 offset:12800
    ds_read_b64_tr_b16 v[110:111], v3 offset:13824
    v_mfma_f32_32x32x16_bf16 v[176:191], a[188:191], v[124:127], v[176:191]
    s_waitcnt lgkmcnt(6)
    v_mfma_f32_32x32x16_bf16 v[128:143], a[32:35], v[96:99], v[128:143]
    ds_read_b64_tr_b16 v[112:113], v3 offset:10240
    ds_read_b64_tr_b16 v[114:115], v3 offset:11264
    v_mfma_f32_32x32x16_bf16 v[144:159], a[192:195], v[96:99], v[144:159]
    s_waitcnt lgkmcnt(6)
    v_mfma_f32_32x32x16_bf16 v[160:175], a[32:35], v[100:103], v[160:175]
    ds_read_b64_tr_b16 v[116:117], v3 offset:14336
    ds_read_b64_tr_b16 v[118:119], v3 offset:15360
    v_mfma_f32_32x32x16_bf16 v[176:191], a[192:195], v[100:103], v[176:191]
    s_waitcnt lgkmcnt(6)
    v_mfma_f32_32x32x16_bf16 v[128:143], a[36:39], v[104:107], v[128:143]
    ds_read_b64_tr_b16 v[120:121], v3 offset:10752
    ds_read_b64_tr_b16 v[122:123], v3 offset:11776
    v_mfma_f32_32x32x16_bf16 v[144:159], a[196:199], v[104:107], v[144:159]
    s_waitcnt lgkmcnt(6)
    v_mfma_f32_32x32x16_bf16 v[160:175], a[36:39], v[108:111], v[160:175]
    ds_read_b64_tr_b16 v[124:125], v3 offset:14848
    ds_read_b64_tr_b16 v[126:127], v3 offset:15872
    v_mfma_f32_32x32x16_bf16 v[176:191], a[196:199], v[108:111], v[176:191]
    s_waitcnt lgkmcnt(6)
    v_mfma_f32_32x32x16_bf16 v[128:143], a[40:43], v[112:115], v[128:143]
    s_waitcnt vmcnt(16)
    s_barrier
    ds_read_b64_tr_b16 v[96:97], v3 offset:16384
    ds_read_b64_tr_b16 v[98:99], v3 offset:17408
    v_mfma_f32_32x32x16_bf16 v[144:159], a[200:203], v[112:115], v[144:159]
    s_add_u32 m0, s60, 32768
    s_nop 0
    buffer_load_dwordx4 v4, s[36:39], s44 offen lds
    s_add_u32 m0, s60, 36864
    s_add_u32 s44, s44, s46
    buffer_load_dwordx4 v4, s[40:43], s45 offen lds
    s_add_u32 s45, s45, s46
    s_waitcnt lgkmcnt(6)
    v_mfma_f32_32x32x16_bf16 v[160:175], a[40:43], v[116:119], v[160:175]
    ds_read_b64_tr_b16 v[100:101], v3 offset:20480
    ds_read_b64_tr_b16 v[102:103], v3 offset:21504
    v_mfma_f32_32x32x16_bf16 v[176:191], a[200:203], v[116:119], v[176:191]
    s_waitcnt lgkmcnt(6)
    v_mfma_f32_32x32x16_bf16 v[128:143], a[44:47], v[120:123], v[128:143]
    ds_read_b64_tr_b16 v[104:105], v3 offset:16896
    ds_read_b64_tr_b16 v[106:107], v3 offset:17920
    v_mfma_f32_32x32x16_bf16 v[144:159], a[204:207], v[120:123], v[144:159]
    s_waitcnt lgkmcnt(6)
    v_mfma_f32_32x32x16_bf16 v[160:175], a[44:47], v[124:127], v[160:175]
    ds_read_b64_tr_b16 v[108:109], v3 offset:20992
    ds_read_b64_tr_b16 v[110:111], v3 offset:22016
    v_mfma_f32_32x32x16_bf16 v[176:191], a[204:207], v[124:127], v[176:191]
    s_waitcnt lgkmcnt(6)
    v_mfma_f32_32x32x16_bf16 v[128:143], a[48:51], v[96:99], v[128:143]
    ds_read_b64_tr_b16 v[112:113], v3 offset:18432
    ds_read_b64_tr_b16 v[114:115], v3 offset:19456
    v_mfma_f32_32x32x16_bf16 v[144:159], a[208:211], v[96:99], v[144:159]
    s_waitcnt lgkmcnt(6)
    v_mfma_f32_32x32x16_bf16 v[160:175], a[48:51], v[100:103], v[160:175]
    ds_read_b64_tr_b16 v[116:117], v3 offset:22528
    ds_read_b64_tr_b16 v[118:119], v3 offset:23552
    v_mfma_f32_32x32x16_bf16 v[176:191], a[208:211], v[100:103], v[176:191]
    s_waitcnt lgkmcnt(6)
    v_mfma_f32_32x32x16_bf16 v[128:143], a[52:55], v[104:107], v[128:143]
    ds_read_b64_tr_b16 v[120:121], v3 offset:18944
    ds_read_b64_tr_b16 v[122:123], v3 offset:19968
    v_mfma_f32_32x32x16_bf16 v[144:159], a[212:215], v[104:107], v[144:159]
    s_waitcnt lgkmcnt(6)
    v_mfma_f32_32x32x16_bf16 v[160:175], a[52:55], v[108:111], v[160:175]
    ds_read_b64_tr_b16 v[124:125], v3 offset:23040
    ds_read_b64_tr_b16 v[126:127], v3 offset:24064
    v_mfma_f32_32x32x16_bf16 v[176:191], a[212:215], v[108:111], v[176:191]
    s_waitcnt lgkmcnt(6)
    v_mfma_f32_32x32x16_bf16 v[128:143], a[56:59], v[112:115], v[128:143]
    s_waitcnt vmcnt(12)
    s_barrier
    ds_read_b64_tr_b16 v[96:97], v3 offset:24576
    ds_read_b64_tr_b16 v[98:99], v3 offset:25600
    v_mfma_f32_32x32x16_bf16 v[144:159], a[216:219], v[112:115], v[144:159]
    s_add_u32 m0, s60, 40960
    s_nop 0
    buffer_load_dwordx4 v4, s[36:39], s44 offen lds
    s_add_u32 m0, s60, 45056
    s_add_u32 s44, s44, s46
    buffer_load_dwordx4 v4, s[40:43], s45 offen lds
    s_add_u32 s45, s45, s46
    s_waitcnt lgkmcnt(6)
    v_mfma_f32_32x32x16_bf16 v[160:175], a[56:59], v[116:119], v[160:175]
    ds_read_b64_tr_b16 v[100:101], v3 offset:28672
    ds_read_b64_tr_b16 v[102:103], v3 offset:29696
    v_mfma_f32_32x32x16_bf16 v[176:191], a[216:219], v[116:119], v[176:191]
    s_waitcnt lgkmcnt(6)
    v_mfma_f32_32x32x16_bf16 v[128:143], a[60:63], v[120:123], v[128:143]
    ds_read_b64_tr_b16 v[104:105], v3 offset:25088
    ds_read_b64_tr_b16 v[106:107], v3 offset:26112
    v_mfma_f32_32x32x16_bf16 v[144:159], a[220:223], v[120:123], v[144:159]
    s_waitcnt lgkmcnt(6)
    v_mfma_f32_32x32x16_bf16 v[160:175], a[60:63], v[124:127], v[160:175]
    ds_read_b64_tr_b16 v[108:109], v3 offset:29184
    ds_read_b64_tr_b16 v[110:111], v3 offset:30208
    v_mfma_f32_32x32x16_bf16 v[176:191], a[220:223], v[124:127], v[176:191]
    s_waitcnt lgkmcnt(6)
    v_mfma_f32_32x32x16_bf16 v[128:143], a[64:67], v[96:99], v[128:143]
    ds_read_b64_tr_b16 v[112:113], v3 offset:26624
    ds_read_b64_tr_b16 v[114:115], v3 offset:27648
    v_mfma_f32_32x32x16_bf16 v[144:159], a[224:227], v[96:99], v[144:159]
    s_waitcnt lgkmcnt(6)
    v_mfma_f32_32x32x16_bf16 v[160:175], a[64:67], v[100:103], v[160:175]
    ds_read_b64_tr_b16 v[116:117], v3 offset:30720
    ds_read_b64_tr_b16 v[118:119], v3 offset:31744
    v_mfma_f32_32x32x16_bf16 v[176:191], a[224:227], v[100:103], v[176:191]
    s_waitcnt lgkmcnt(6)
    v_mfma_f32_32x32x16_bf16 v[128:143], a[68:71], v[104:107], v[128:143]
    ds_read_b64_tr_b16 v[120:121], v3 offset:27136
    ds_read_b64_tr_b16 v[122:123], v3 offset:28160
    v_mfma_f32_32x32x16_bf16 v[144:159], a[228:231], v[104:107], v[144:159]
    s_waitcnt lgkmcnt(6)
    v_mfma_f32_32x32x16_bf16 v[160:175], a[68:71], v[108:111], v[160:175]
    ds_read_b64_tr_b16 v[124:125], v3 offset:31232
    ds_read_b64_tr_b16 v[126:127], v3 offset:32256
    v_mfma_f32_32x32x16_bf16 v[176:191], a[228:231], v[108:111], v[176:191]
    s_waitcnt lgkmcnt(6)
    v_mfma_f32_32x32x16_bf16 v[128:143], a[72:75], v[112:115], v[128:143]
    s_waitcnt vmcnt(12)
    s_barrier
    ds_read_b64_tr_b16 v[96:97], v3 offset:32768
    ds_read_b64_tr_b16 v[98:99], v3 offset:33792
    v_mfma_f32_32x32x16_bf16 v[144:159], a[232:235], v[112:115], v[144:159]
    s_add_u32 m0, s60, 49152
    s_nop 0
    buffer_load_dwordx4 v4, s[36:39], s44 offen lds
    s_add_u32 m0, s60, 53248
    s_add_u32 s44, s44, s46
    buffer_load_dwordx4 v4, s[40:43], s45 offen lds
    s_add_u32 s45, s45, s46
    s_waitcnt lgkmcnt(6)
    v_mfma_f32_32x32x16_bf16 v[160:175], a[72:75], v[116:119], v[160:175]
    ds_read_b64_tr_b16 v[100:101], v3 offset:36864
    ds_read_b64_tr_b16 v[102:103], v3 offset:37888
    v_mfma_f32_32x32x16_bf16 v[176:191], a[232:235], v[116:119], v[176:191]
    s_waitcnt lgkmcnt(6)
    v_mfma_f32_32x32x16_bf16 v[128:143], a[76:79], v[120:123], v[128:143]
    ds_read_b64_tr_b16 v[104:105], v3 offset:33280
    ds_read_b64_tr_b16 v[106:107], v3 offset:34304
    v_mfma_f32_32x32x16_bf16 v[144:159], a[236:239], v[120:123], v[144:159]
    s_waitcnt lgkmcnt(6)
    v_mfma_f32_32x32x16_bf16 v[160:175], a[76:79], v[124:127], v[160:175]
    ds_read_b64_tr_b16 v[108:109], v3 offset:37376
    ds_read_b64_tr_b16 v[110:111], v3 offset:38400
    v_mfma_f32_32x32x16_bf16 v[176:191], a[236:239], v[124:127], v[176:191]
    s_waitcnt lgkmcnt(6)
    v_mfma_f32_32x32x16_bf16 v[128:143], a[80:83], v[96:99], v[128:143]
    ds_read_b64_tr_b16 v[112:113], v3 offset:34816
    ds_read_b64_tr_b16 v[114:115], v3 offset:35840
    v_mfma_f32_32x32x16_bf16 v[144:159], a[240:243], v[96:99], v[144:159]
    s_waitcnt lgkmcnt(6)
    v_mfma_f32_32x32x16_bf16 v[160:175], a[80:83], v[100:103], v[160:175]
    ds_read_b64_tr_b16 v[116:117], v3 offset:38912
    ds_read_b64_tr_b16 v[118:119], v3 offset:39936
    v_mfma_f32_32x32x16_bf16 v[176:191], a[240:243], v[100:103], v[176:191]
    s_waitcnt lgkmcnt(6)
    v_mfma_f32_32x32x16_bf16 v[128:143], a[84:87], v[104:107], v[128:143]
    ds_read_b64_tr_b16 v[120:121], v3 offset:35328
    ds_read_b64_tr_b16 v[122:123], v3 offset:36352
    v_mfma_f32_32x32x16_bf16 v[144:159], a[244:247], v[104:107], v[144:159]
    s_waitcnt lgkmcnt(6)
    v_mfma_f32_32x32x16_bf16 v[160:175], a[84:87], v[108:111], v[160:175]
    ds_read_b64_tr_b16 v[124:125], v3 offset:39424
    ds_read_b64_tr_b16 v[126:127], v3 offset:40448
    v_mfma_f32_32x32x16_bf16 v[176:191], a[244:247], v[108:111], v[176:191]
    s_waitcnt lgkmcnt(6)
    v_mfma_f32_32x32x16_bf16 v[128:143], a[88:91], v[112:115], v[128:143]
    s_waitcnt vmcnt(12)
    s_barrier
    ds_read_b64_tr_b16 v[96:97], v2 offset:0
    ds_read_b64_tr_b16 v[98:99], v2 offset:1024
    v_mfma_f32_32x32x16_bf16 v[144:159], a[248:251], v[112:115], v[144:159]
    s_add_u32 m0, s60, 57344
    s_nop 0
    buffer_load_dwordx4 v4, s[36:39], s44 offen lds
    s_add_u32 m0, s60, 61440
    s_add_u32 s44, s44, s46
    buffer_load_dwordx4 v4, s[40:43], s45 offen lds
    s_add_u32 s45, s45, s46
    s_waitcnt lgkmcnt(6)
    v_mfma_f32_32x32x16_bf16 v[160:175], a[88:91], v[116:119], v[160:175]
    ds_read_b64_tr_b16 v[100:101], v2 offset:4096
    ds_read_b64_tr_b16 v[102:103], v2 offset:5120
    v_mfma_f32_32x32x16_bf16 v[176:191], a[248:251], v[116:119], v[176:191]
    s_waitcnt lgkmcnt(6)
    v_mfma_f32_32x32x16_bf16 v[128:143], a[92:95], v[120:123], v[128:143]
    ds_read_b64_tr_b16 v[104:105], v2 offset:512
    ds_read_b64_tr_b16 v[106:107], v2 offset:1536
    v_mfma_f32_32x32x16_bf16 v[144:159], a[252:255], v[120:123], v[144:159]
    s_waitcnt lgkmcnt(6)
    v_mfma_f32_32x32x16_bf16 v[160:175], a[92:95], v[124:127], v[160:175]
    ds_read_b64_tr_b16 v[108:109], v2 offset:4608
    ds_read_b64_tr_b16 v[110:111], v2 offset:5632
    v_mfma_f32_32x32x16_bf16 v[176:191], a[252:255], v[124:127], v[176:191]
    v_cvt_pk_bf16_f32 v64, v128, v129
    v_cvt_pk_bf16_f32 v65, v130, v131
    v_cvt_pk_bf16_f32 v66, v136, v137
    v_cvt_pk_bf16_f32 v67, v138, v139
    buffer_store_dwordx4 v[64:67], v7, s[32:35], s49 offen offset:0 sc1
    v_cvt_pk_bf16_f32 v68, v132, v133
    v_cvt_pk_bf16_f32 v69, v134, v135
    v_cvt_pk_bf16_f32 v70, v140, v141
    v_cvt_pk_bf16_f32 v71, v142, v143
    buffer_store_dwordx4 v[68:71], v7, s[32:35], s49 offen offset:512 sc1
    v_cvt_pk_bf16_f32 v72, v144, v145
    v_cvt_pk_bf16_f32 v73, v146, v147
    v_cvt_pk_bf16_f32 v74, v152, v153
    v_cvt_pk_bf16_f32 v75, v154, v155
    buffer_store_dwordx4 v[72:75], v7, s[32:35], s50 offen offset:0 sc1
    v_cvt_pk_bf16_f32 v76, v148, v149
    v_cvt_pk_bf16_f32 v77, v150, v151
    v_cvt_pk_bf16_f32 v78, v156, v157
    v_cvt_pk_bf16_f32 v79, v158, v159
    buffer_store_dwordx4 v[76:79], v7, s[32:35], s50 offen offset:512 sc1
    v_cvt_pk_bf16_f32 v80, v160, v161
    v_cvt_pk_bf16_f32 v81, v162, v163
    v_cvt_pk_bf16_f32 v82, v168, v169
    v_cvt_pk_bf16_f32 v83, v170, v171
    buffer_store_dwordx4 v[80:83], v7, s[32:35], s49 offen offset:2048 sc1
    v_cvt_pk_bf16_f32 v84, v164, v165
    v_cvt_pk_bf16_f32 v85, v166, v167
    v_cvt_pk_bf16_f32 v86, v172, v173
    v_cvt_pk_bf16_f32 v87, v174, v175
    buffer_store_dwordx4 v[84:87], v7, s[32:35], s49 offen offset:2560 sc1
    v_cvt_pk_bf16_f32 v88, v176, v177
    v_cvt_pk_bf16_f32 v89, v178, v179
    v_cvt_pk_bf16_f32 v90, v184, v185
    v_cvt_pk_bf16_f32 v91, v186, v187
    buffer_store_dwordx4 v[88:91], v7, s[32:35], s50 offen offset:2048 sc1
    v_cvt_pk_bf16_f32 v92, v180, v181
    v_cvt_pk_bf16_f32 v93, v182, v183
    v_cvt_pk_bf16_f32 v94, v188, v189
    v_cvt_pk_bf16_f32 v95, v190, v191
    buffer_store_dwordx4 v[92:95], v7, s[32:35], s50 offen offset:2560 sc1
    s_bfe_u32 s53, s47, 0x100008
    s_branch L_gx_next
L_gx_g:
    s_sub_u32 s54, s54, 192
    s_lshl_b32 s54, s54, 11
    s_mul_i32 s58, s56, 110592
    s_add_u32 s54, s54, s58
    s_add_u32 s49, s54, 71303168
    s_add_u32 s50, s49, 110592
    s_waitcnt lgkmcnt(6)
    v_mfma_f32_32x32x16_bf16 v[128:143], v[96:99], v[192:195], 0
    ds_read_b64_tr_b16 v[112:113], v2 offset:2048
    ds_read_b64_tr_b16 v[114:115], v2 offset:3072
    v_mfma_f32_32x32x16_bf16 v[144:159], v[96:99], a[96:99], 0
    s_waitcnt lgkmcnt(6)
    v_mfma_f32_32x32x16_bf16 v[160:175], v[100:103], v[192:195], 0
    ds_read_b64_tr_b16 v[116:117], v2 offset:6144
    ds_read_b64_tr_b16 v[118:119], v2 offset:7168
    v_mfma_f32_32x32x16_bf16 v[176:191], v[100:103], a[96:99], 0
    s_waitcnt lgkmcnt(6)
    v_mfma_f32_32x32x16_bf16 v[128:143], v[104:107], v[196:199], v[128:143]
    ds_read_b64_tr_b16 v[120:121], v2 offset:2560
    ds_read_b64_tr_b16 v[122:123], v2 offset:3584
    v_mfma_f32_32x32x16_bf16 v[144:159], v[104:107], a[100:103], v[144:159]
    s_waitcnt lgkmcnt(6)
    v_mfma_f32_32x32x16_bf16 v[160:175], v[108:111], v[196:199], v[160:175]
    ds_read_b64_tr_b16 v[124:125], v2 offset:6656
    ds_read_b64_tr_b16 v[126:127], v2 offset:7680
    v_mfma_f32_32x32x16_bf16 v[176:191], v[108:111], a[100:103], v[176:191]
    s_waitcnt lgkmcnt(6)
    v_mfma_f32_32x32x16_bf16 v[128:143], v[112:115], v[200:203], v[128:143]
    s_waitcnt vmcnt(16)
    s_barrier
    ds_read_b64_tr_b16 v[96:97], v2 offset:8192
    ds_read_b64_tr_b16 v[98:99], v2 offset:9216
    v_mfma_f32_32x32x16_bf16 v[144:159], v[112:115], a[104:107], v[144:159]
    s_add_u32 m0, s60, 65536
    s_nop 0
    buffer_load_dwordx4 v4, s[36:39], s44 offen lds
    s_add_u32 m0, s60, 69632
    s_add_u32 s44, s44, s46
    buffer_load_dwordx4 v4, s[40:43], s45 offen lds
    s_add_u32 s45, s45, s46
    s_waitcnt lgkmcnt(6)
    v_mfma_f32_32x32x16_bf16 v[160:175], v[116:119], v[200:203], v[160:175]
    ds_read_b64_tr_b16 v[100:101], v2 offset:12288
    ds_read_b64_tr_b16 v[102:103], v2 offset:13312
    v_mfma_f32_32x32x16_bf16 v[176:191], v[116:119], a[104:107], v[176:191]
    s_waitcnt lgkmcnt(6)
    v_mfma_f32_32x32x16_bf16 v[128:143], v[120:123], v[204:207], v[128:143]
    ds_read_b64_tr_b16 v[104:105], v2 offset:8704
    ds_read_b64_tr_b16 v[106:107], v2 offset:9728
    v_mfma_f32_32x32x16_bf16 v[144:159], v[120:123], a[108:111], v[144:159]
    s_waitcnt lgkmcnt(6)
    v_mfma_f32_32x32x16_bf16 v[160:175], v[124:127], v[204:207], v[160:175]
    ds_read_b64_tr_b16 v[108:109], v2 offset:12800
    ds_read_b64_tr_b16 v[110:111], v2 offset:13824
    v_mfma_f32_32x32x16_bf16 v[176:191], v[124:127], a[108:111], v[176:191]
    s_waitcnt lgkmcnt(6)
    v_mfma_f32_32x32x16_bf16 v[128:143], v[96:99], v[208:211], v[128:143]
    ds_read_b64_tr_b16 v[112:113], v2 offset:10240
    ds_read_b64_tr_b16 v[114:115], v2 offset:11264
    v_mfma_f32_32x32x16_bf16 v[144:159], v[96:99], a[112:115], v[144:159]
    s_waitcnt lgkmcnt(6)
    v_mfma_f32_32x32x16_bf16 v[160:175], v[100:103], v[208:211], v[160:175]
    ds_read_b64_tr_b16 v[116:117], v2 offset:14336
    ds_read_b64_tr_b16 v[118:119], v2 offset:15360
    v_mfma_f32_32x32x16_bf16 v[176:191], v[100:103], a[112:115], v[176:191]
    s_waitcnt lgkmcnt(6)
    v_mfma_f32_32x32x16_bf16 v[128:143], v[104:107], v[212:215], v[128:143]
    ds_read_b64_tr_b16 v[120:121], v2 offset:10752
    ds_read_b64_tr_b16 v[122:123], v2 offset:11776
    v_mfma_f32_32x32x16_bf16 v[144:159], v[104:107], a[116:119], v[144:159]
    s_waitcnt lgkmcnt(6)
    v_mfma_f32_32x32x16_bf16 v[160:175], v[108:111], v[212:215], v[160:175]
    ds_read_b64_tr_b16 v[124:125], v2 offset:14848
    ds_read_b64_tr_b16 v[126:127], v2 offset:15872
    v_mfma_f32_32x32x16_bf16 v[176:191], v[108:111], a[116:119], v[176:191]
    s_waitcnt lgkmcnt(6)
    v_mfma_f32_32x32x16_bf16 v[128:143], v[112:115], v[216:219], v[128:143]
    s_waitcnt vmcnt(16)
    s_barrier
    ds_read_b64_tr_b16 v[96:97], v2 offset:16384
    ds_read_b64_tr_b16 v[98:99], v2 offset:17408
    v_mfma_f32_32x32x16_bf16 v[144:159], v[112:115], a[120:123], v[144:159]
    s_add_u32 m0, s60, 73728
    s_nop 0
    buffer_load_dwordx4 v4, s[36:39], s44 offen lds
    s_add_u32 m0, s60, 77824
    s_add_u32 s44, s44, s46
    buffer_load_dwordx4 v4, s[40:43], s45 offen lds
    s_add_u32 s45, s45, s46
    s_waitcnt lgkmcnt(6)
    v_mfma_f32_32x32x16_bf16 v[160:175], v[116:119], v[216:219], v[160:175]
    ds_read_b64_tr_b16 v[100:101], v2 offset:20480
    ds_read_b64_tr_b16 v[102:103], v2 offset:21504
    v_mfma_f32_32x32x16_bf16 v[176:191], v[116:119], a[120:123], v[176:191]
    s_waitcnt lgkmcnt(6)
    v_mfma_f32_32x32x16_bf16 v[128:143], v[120:123], v[220:223], v[128:143]
    ds_read_b64_tr_b16 v[104:105], v2 offset:16896
    ds_read_b64_tr_b16 v[106:107], v2 offset:17920
    v_mfma_f32_32x32x16_bf16 v[144:159], v[120:123], a[124:127], v[144:159]
    s_waitcnt lgkmcnt(6)
    v_mfma_f32_32x32x16_bf16 v[160:175], v[124:127], v[220:223], v[160:175]
    ds_read_b64_tr_b16 v[108:109], v2 offset:20992
    ds_read_b64_tr_b16 v[110:111], v2 offset:22016
    v_mfma_f32_32x32x16_bf16 v[176:191], v[124:127], a[124:127], v[176:191]
    s_waitcnt lgkmcnt(6)
    v_mfma_f32_32x32x16_bf16 v[128:143], v[96:99], v[224:227], v[128:143]
    ds_read_b64_tr_b16 v[112:113], v2 offset:18432
    ds_read_b64_tr_b16 v[114:115], v2 offset:19456
    v_mfma_f32_32x32x16_bf16 v[144:159], v[96:99], a[128:131], v[144:159]
    s_waitcnt lgkmcnt(6)
    v_mfma_f32_32x32x16_bf16 v[160:175], v[100:103], v[224:227], v[160:175]
    ds_read_b64_tr_b16 v[116:117], v2 offset:22528
    ds_read_b64_tr_b16 v[118:119], v2 offset:23552
    v_mfma_f32_32x32x16_bf16 v[176:191], v[100:103], a[128:131], v[176:191]
    s_waitcnt lgkmcnt(6)
    v_mfma_f32_32x32x16_bf16 v[128:143], v[104:107], v[228:231], v[128:143]
    ds_read_b64_tr_b16 v[120:121], v2 offset:18944
    ds_read_b64_tr_b16 v[122:123], v2 offset:19968
    v_mfma_f32_32x32x16_bf16 v[144:159], v[104:107], a[132:135], v[144:159]
    s_waitcnt lgkmcnt(6)
    v_mfma_f32_32x32x16_bf16 v[160:175], v[108:111], v[228:231], v[160:175]
    ds_read_b64_tr_b16 v[124:125], v2 offset:23040
    ds_read_b64_tr_b16 v[126:127], v2 offset:24064
    v_mfma_f32_32x32x16_bf16 v[176:191], v[108:111], a[132:135], v[176:191]
    s_waitcnt lgkmcnt(6)
    v_mfma_f32_32x32x16_bf16 v[128:143], v[112:115], v[232:235], v[128:143]
    s_waitcnt vmcnt(16)
    s_barrier
    ds_read_b64_tr_b16 v[96:97], v2 offset:24576
    ds_read_b64_tr_b16 v[98:99], v2 offset:25600
    v_mfma_f32_32x32x16_bf16 v[144:159], v[112:115], a[136:139], v[144:159]
    s_bitcmp1_b32 s47, 23
    s_cselect_b32 s59, 255, s64
    s_and_b32 s54, s59, 255
    s_cmp_ge_u32 s54, 192
    s_cbranch_scc1 L_dg_G
    s_lshr_b32 s55, s54, 6
    s_cmp_eq_u32 s55, 1
    s_cselect_b32 s36, s12, s10
    s_cselect_b32 s37, s13, s11
    s_cmp_eq_u32 s55, 2
    s_cselect_b32 s36, s8, s36
    s_cselect_b32 s37, s9, s37
    s_mov_b32 s40, s36
    s_mov_b32 s41, s37
    s_mov_b32 s38, 5242880
    s_mov_b32 s42, 5242880
    s_and_b32 s54, s54, 63
    s_lshl_b32 s44, s54, 7
    s_add_u32 s45, s44, 64
    s_mov_b32 s46, 524288
    v_mov_b32 v4, v5
    s_branch L_dd_G
L_dg_G:
    s_mov_b32 s36, s20
    s_mov_b32 s37, s21
    s_mov_b32 s40, s22
    s_mov_b32 s41, s23
    s_cmp_eq_u32 s54, 255
    s_cselect_b32 s38, 0, 2211840
    s_mov_b32 s42, s38
    s_sub_u32 s54, s54, 192
    s_lshl_b32 s44, s54, 6
    s_mov_b32 s45, s44
    s_mov_b32 s46, 221184
    v_mov_b32 v4, v6
L_dd_G:
    s_add_u32 m0, s60, 0
    s_nop 0
    buffer_load_dwordx4 v4, s[36:39], s44 offen lds
    s_add_u32 m0, s60, 4096
    s_add_u32 s44, s44, s46
    buffer_load_dwordx4 v4, s[40:43], s45 offen lds
    s_add_u32 s45, s45, s46
    s_waitcnt lgkmcnt(6)
    v_mfma_f32_32x32x16_bf16 v[160:175], v[116:119], v[232:235], v[160:175]
    ds_read_b64_tr_b16 v[100:101], v2 offset:28672
    ds_read_b64_tr_b16 v[102:103], v2 offset:29696
    v_mfma_f32_32x32x16_bf16 v[176:191], v[116:119], a[136:139], v[176:191]
    s_waitcnt lgkmcnt(6)
    v_mfma_f32_32x32x16_bf16 v[128:143], v[120:123], v[236:239], v[128:143]
    ds_read_b64_tr_b16 v[104:105], v2 offset:25088
    ds_read_b64_tr_b16 v[106:107], v2 offset:26112
    v_mfma_f32_32x32x16_bf16 v[144:159], v[120:123], a[140:143], v[144:159]
    s_waitcnt lgkmcnt(6)
    v_mfma_f32_32x32x16_bf16 v[160:175], v[124:127], v[236:239], v[160:175]
    ds_read_b64_tr_b16 v[108:109], v2 offset:29184
    ds_read_b64_tr_b16 v[110:111], v2 offset:30208
    v_mfma_f32_32x32x16_bf16 v[176:191], v[124:127], a[140:143], v[176:191]
    s_waitcnt lgkmcnt(6)
    v_mfma_f32_32x32x16_bf16 v[128:143], v[96:99], v[240:243], v[128:143]
    ds_read_b64_tr_b16 v[112:113], v2 offset:26624
    ds_read_b64_tr_b16 v[114:115], v2 offset:27648
    v_mfma_f32_32x32x16_bf16 v[144:159], v[96:99], a[144:147], v[144:159]
    s_waitcnt lgkmcnt(6)
    v_mfma_f32_32x32x16_bf16 v[160:175], v[100:103], v[240:243], v[160:175]
    ds_read_b64_tr_b16 v[116:117], v2 offset:30720
    ds_read_b64_tr_b16 v[118:119], v2 offset:31744
    v_mfma_f32_32x32x16_bf16 v[176:191], v[100:103], a[144:147], v[176:191]
    s_waitcnt lgkmcnt(6)
    v_mfma_f32_32x32x16_bf16 v[128:143], v[104:107], v[244:247], v[128:143]
    ds_read_b64_tr_b16 v[120:121], v2 offset:27136
    ds_read_b64_tr_b16 v[122:123], v2 offset:28160
    v_mfma_f32_32x32x16_bf16 v[144:159], v[104:107], a[148:151], v[144:159]
    s_waitcnt lgkmcnt(6)
    v_mfma_f32_32x32x16_bf16 v[160:175], v[108:111], v[244:247], v[160:175]
    ds_read_b64_tr_b16 v[124:125], v2 offset:31232
    ds_read_b64_tr_b16 v[126:127], v2 offset:32256
    v_mfma_f32_32x32x16_bf16 v[176:191], v[108:111], a[148:151], v[176:191]
    s_waitcnt lgkmcnt(6)
    v_mfma_f32_32x32x16_bf16 v[128:143], v[112:115], v[248:251], v[128:143]
    s_waitcnt vmcnt(16)
    s_barrier
    ds_read_b64_tr_b16 v[96:97], v2 offset:32768
    ds_read_b64_tr_b16 v[98:99], v2 offset:33792
    v_mfma_f32_32x32x16_bf16 v[144:159], v[112:115], a[152:155], v[144:159]
    s_add_u32 m0, s60, 8192
    s_nop 0
    buffer_load_dwordx4 v4, s[36:39], s44 offen lds
    s_add_u32 m0, s60, 12288
    s_add_u32 s44, s44, s46
    buffer_load_dwordx4 v4, s[40:43], s45 offen lds
    s_add_u32 s45, s45, s46
    s_waitcnt lgkmcnt(6)
    v_mfma_f32_32x32x16_bf16 v[160:175], v[116:119], v[248:251], v[160:175]
    ds_read_b64_tr_b16 v[100:101], v2 offset:36864
    ds_read_b64_tr_b16 v[102:103], v2 offset:37888
    v_mfma_f32_32x32x16_bf16 v[176:191], v[116:119], a[152:155], v[176:191]
    s_waitcnt lgkmcnt(6)
    v_mfma_f32_32x32x16_bf16 v[128:143], v[120:123], v[252:255], v[128:143]
    ds_read_b64_tr_b16 v[104:105], v2 offset:33280
    ds_read_b64_tr_b16 v[106:107], v2 offset:34304
    v_mfma_f32_32x32x16_bf16 v[144:159], v[120:123], a[156:159], v[144:159]
    s_waitcnt lgkmcnt(6)
    v_mfma_f32_32x32x16_bf16 v[160:175], v[124:127], v[252:255], v[160:175]
    ds_read_b64_tr_b16 v[108:109], v2 offset:37376
    ds_read_b64_tr_b16 v[110:111], v2 offset:38400
    v_mfma_f32_32x32x16_bf16 v[176:191], v[124:127], a[156:159], v[176:191]
    s_waitcnt lgkmcnt(6)
    v_mfma_f32_32x32x16_bf16 v[128:143], v[96:99], a[0:3], v[128:143]
    ds_read_b64_tr_b16 v[112:113], v2 offset:34816
    ds_read_b64_tr_b16 v[114:115], v2 offset:35840
    v_mfma_f32_32x32x16_bf16 v[144:159], v[96:99], a[160:163], v[144:159]
    s_waitcnt lgkmcnt(6)
    v_mfma_f32_32x32x16_bf16 v[160:175], v[100:103], a[0:3], v[160:175]
    ds_read_b64_tr_b16 v[116:117], v2 offset:38912
    ds_read_b64_tr_b16 v[118:119], v2 offset:39936
    v_mfma_f32_32x32x16_bf16 v[176:191], v[100:103], a[160:163], v[176:191]
    s_waitcnt lgkmcnt(6)
    v_mfma_f32_32x32x16_bf16 v[128:143], v[104:107], a[4:7], v[128:143]
    ds_read_b64_tr_b16 v[120:121], v2 offset:35328
    ds_read_b64_tr_b16 v[122:123], v2 offset:36352
    v_mfma_f32_32x32x16_bf16 v[144:159], v[104:107], a[164:167], v[144:159]
    s_waitcnt lgkmcnt(6)
    v_mfma_f32_32x32x16_bf16 v[160:175], v[108:111], a[4:7], v[160:175]
    ds_read_b64_tr_b16 v[124:125], v2 offset:39424
    ds_read_b64_tr_b16 v[126:127], v2 offset:40448
    v_mfma_f32_32x32x16_bf16 v[176:191], v[108:111], a[164:167], v[176:191]
    s_waitcnt lgkmcnt(6)
    v_mfma_f32_32x32x16_bf16 v[128:143], v[112:115], a[8:11], v[128:143]
    s_cmp_eq_u32 s53, 0
    s_cbranch_scc1 L_lax_G
    s_waitcnt vmcnt(8)
L_lax_G:
    s_waitcnt vmcnt(16)
    s_barrier
    ds_read_b64_tr_b16 v[96:97], v3 offset:0
    ds_read_b64_tr_b16 v[98:99], v3 offset:1024
    v_mfma_f32_32x32x16_bf16 v[144:159], v[112:115], a[168:171], v[144:159]
    s_add_u32 m0, s60, 16384
    s_nop 0
    buffer_load_dwordx4 v4, s[36:39], s44 offen lds
    s_add_u32 m0, s60, 20480
    s_add_u32 s44, s44, s46
    buffer_load_dwordx4 v4, s[40:43], s45 offen lds
    s_add_u32 s45, s45, s46
    s_cmp_eq_u32 s53, 0
    s_cbranch_scc1 L_ns_G
    s_cmp_lg_u32 s51, 0
    s_cbranch_scc1 L_ns2_G
    s_and_b32 s54, s53, 255
    s_lshl_b32 s54, s54, 3
    s_and_b32 s55, s2, 7
    s_add_u32 s54, s54, s55
    s_lshl_b32 s54, s54, 7
    s_add_u32 s54, s54, 95828992
    s_bfe_u32 s55, s53, 0x70008
    v_mov_b32 v10, s54
    v_mov_b32 v11, s55
    s_mov_b64 exec, 1
    buffer_atomic_add v11, v10, s[32:35], 0 offen
    s_mov_b64 exec, -1
L_ns2_G:
    s_mov_b32 s53, 0
L_ns_G:
    s_waitcnt lgkmcnt(6)
    v_mfma_f32_32x32x16_bf16 v[160:175], v[116:119], a[8:11], v[160:175]
    ds_read_b64_tr_b16 v[100:101], v3 offset:4096
    ds_read_b64_tr_b16 v[102:103], v3 offset:5120
    v_mfma_f32_32x32x16_bf16 v[176:191], v[116:119], a[168:171], v[176:191]
    s_waitcnt lgkmcnt(6)
    v_mfma_f32_32x32x16_bf16 v[128:143], v[120:123], a[12:15], v[128:143]
    ds_read_b64_tr_b16 v[104:105], v3 offset:512
    ds_read_b64_tr_b16 v[106:107], v3 offset:1536
    v_mfma_f32_32x32x16_bf16 v[144:159], v[120:123], a[172:175], v[144:159]
    s_waitcnt lgkmcnt(6)
    v_mfma_f32_32x32x16_bf16 v[160:175], v[124:127], a[12:15], v[160:175]
    ds_read_b64_tr_b16 v[108:109], v3 offset:4608
    ds_read_b64_tr_b16 v[110:111], v3 offset:5632
    v_mfma_f32_32x32x16_bf16 v[176:191], v[124:127], a[172:175], v[176:191]
    s_waitcnt lgkmcnt(6)
    v_mfma_f32_32x32x16_bf16 v[128:143], v[96:99], a[16:19], v[128:143]
    ds_read_b64_tr_b16 v[112:113], v3 offset:2048
    ds_read_b64_tr_b16 v[114:115], v3 offset:3072
    v_mfma_f32_32x32x16_bf16 v[144:159], v[96:99], a[176:179], v[144:159]
    s_waitcnt lgkmcnt(6)
    v_mfma_f32_32x32x16_bf16 v[160:175], v[100:103], a[16:19], v[160:175]
    ds_read_b64_tr_b16 v[116:117], v3 offset:6144
    ds_read_b64_tr_b16 v[118:119], v3 offset:7168
    v_mfma_f32_32x32x16_bf16 v[176:191], v[100:103], a[176:179], v[176:191]
    s_waitcnt lgkmcnt(6)
    v_mfma_f32_32x32x16_bf16 v[128:143], v[104:107], a[20:23], v[128:143]
    ds_read_b64_tr_b16 v[120:121], v3 offset:2560
    ds_read_b64_tr_b16 v[122:123], v3 offset:3584
    v_mfma_f32_32x32x16_bf16 v[144:159], v[104:107], a[180:183], v[144:159]
    s_waitcnt lgkmcnt(6)
    v_mfma_f32_32x32x16_bf16 v[160:175], v[108:111], a[20:23], v[160:175]
    ds_read_b64_tr_b16 v[124:125], v3 offset:6656
    ds_read_b64_tr_b16 v[126:127], v3 offset:7680
    v_mfma_f32_32x32x16_bf16 v[176:191], v[108:111], a[180:183], v[176:191]
    s_waitcnt lgkmcnt(6)
    v_mfma_f32_32x32x16_bf16 v[128:143], v[112:115], a[24:27], v[128:143]
    s_waitcnt vmcnt(16)
    s_barrier
    ds_read_b64_tr_b16 v[96:97], v3 offset:8192
    ds_read_b64_tr_b16 v[98:99], v3 offset:9216
    v_mfma_f32_32x32x16_bf16 v[144:159], v[112:115], a[184:187], v[144:159]
    s_add_u32 m0, s60, 24576
    s_nop 0
    buffer_load_dwordx4 v4, s[36:39], s44 offen lds
    s_add_u32 m0, s60, 28672
    s_add_u32 s44, s44, s46
    buffer_load_dwordx4 v4, s[40:43], s45 offen lds
    s_add_u32 s45, s45, s46
    s_waitcnt lgkmcnt(6)
    v_mfma_f32_32x32x16_bf16 v[160:175], v[116:119], a[24:27], v[160:175]
    ds_read_b64_tr_b16 v[100:101], v3 offset:12288
    ds_read_b64_tr_b16 v[102:103], v3 offset:13312
    v_mfma_f32_32x32x16_bf16 v[176:191], v[116:119], a[184:187], v[176:191]
    s_waitcnt lgkmcnt(6)
    v_mfma_f32_32x32x16_bf16 v[128:143], v[120:123], a[28:31], v[128:143]
    ds_read_b64_tr_b16 v[104:105], v3 offset:8704
    ds_read_b64_tr_b16 v[106:107], v3 offset:9728
    v_mfma_f32_32x32x16_bf16 v[144:159], v[120:123], a[188:191], v[144:159]
    s_waitcnt lgkmcnt(6)
    v_mfma_f32_32x32x16_bf16 v[160:175], v[124:127], a[28:31], v[160:175]
    ds_read_b64_tr_b16 v[108:109], v3 offset:12800
    ds_read_b64_tr_b16 v[110:111], v3 offset:13824
    v_mfma_f32_32x32x16_bf16 v[176:191], v[124:127], a[188:191], v[176:191]
    s_waitcnt lgkmcnt(6)
    v_mfma_f32_32x32x16_bf16 v[128:143], v[96:99], a[32:35], v[128:143]
    ds_read_b64_tr_b16 v[112:113], v3 offset:10240
    ds_read_b64_tr_b16 v[114:115], v3 offset:11264
    v_mfma_f32_32x32x16_bf16 v[144:159], v[96:99], a[192:195], v[144:159]
    s_waitcnt lgkmcnt(6)
    v_mfma_f32_32x32x16_bf16 v[160:175], v[100:103], a[32:35], v[160:175]
    ds_read_b64_tr_b16 v[116:117], v3 offset:14336
    ds_read_b64_tr_b16 v[118:119], v3 offset:15360
    v_mfma_f32_32x32x16_bf16 v[176:191], v[100:103], a[192:195], v[176:191]
    s_waitcnt lgkmcnt(6)
    v_mfma_f32_32x32x16_bf16 v[128:143], v[104:107], a[36:39], v[128:143]
    ds_read_b64_tr_b16 v[120:121], v3 offset:10752
    ds_read_b64_tr_b16 v[122:123], v3 offset:11776
    v_mfma_f32_32x32x16_bf16 v[144:159], v[104:107], a[196:199], v[144:159]
    s_waitcnt lgkmcnt(6)
    v_mfma_f32_32x32x16_bf16 v[160:175], v[108:111], a[36:39], v[160:175]
    ds_read_b64_tr_b16 v[124:125], v3 offset:14848
    ds_read_b64_tr_b16 v[126:127], v3 offset:15872
    v_mfma_f32_32x32x16_bf16 v[176:191], v[108:111], a[196:199], v[176:191]
    s_waitcnt lgkmcnt(6)
    v_mfma_f32_32x32x16_bf16 v[128:143], v[112:115], a[40:43], v[128:143]
    s_waitcnt vmcnt(16)
    s_barrier
    ds_read_b64_tr_b16 v[96:97], v3 offset:16384
    ds_read_b64_tr_b16 v[98:99], v3 offset:17408
    v_mfma_f32_32x32x16_bf16 v[144:159], v[112:115], a[200:203], v[144:159]
    s_add_u32 m0, s60, 32768
    s_nop 0
    buffer_load_dwordx4 v4, s[36:39], s44 offen lds
    s_add_u32 m0, s60, 36864
    s_add_u32 s44, s44, s46
    buffer_load_dwordx4 v4, s[40:43], s45 offen lds
    s_add_u32 s45, s45, s46
    s_waitcnt lgkmcnt(6)
    v_mfma_f32_32x32x16_bf16 v[160:175], v[116:119], a[40:43], v[160:175]
    ds_read_b64_tr_b16 v[100:101], v3 offset:20480
    ds_read_b64_tr_b16 v[102:103], v3 offset:21504
    v_mfma_f32_32x32x16_bf16 v[176:191], v[116:119], a[200:203], v[176:191]
    s_waitcnt lgkmcnt(6)
    v_mfma_f32_32x32x16_bf16 v[128:143], v[120:123], a[44:47], v[128:143]
    ds_read_b64_tr_b16 v[104:105], v3 offset:16896
    ds_read_b64_tr_b16 v[106:107], v3 offset:17920
    v_mfma_f32_32x32x16_bf16 v[144:159], v[120:123], a[204:207], v[144:159]
    s_waitcnt lgkmcnt(6)
    v_mfma_f32_32x32x16_bf16 v[160:175], v[124:127], a[44:47], v[160:175]
    ds_read_b64_tr_b16 v[108:109], v3 offset:20992
    ds_read_b64_tr_b16 v[110:111], v3 offset:22016
    v_mfma_f32_32x32x16_bf16 v[176:191], v[124:127], a[204:207], v[176:191]
    s_waitcnt lgkmcnt(6)
    v_mfma_f32_32x32x16_bf16 v[128:143], v[96:99], a[48:51], v[128:143]
    ds_read_b64_tr_b16 v[112:113], v3 offset:18432
    ds_read_b64_tr_b16 v[114:115], v3 offset:19456
    v_mfma_f32_32x32x16_bf16 v[144:159], v[96:99], a[208:211], v[144:159]
    s_waitcnt lgkmcnt(6)
    v_mfma_f32_32x32x16_bf16 v[160:175], v[100:103], a[48:51], v[160:175]
    ds_read_b64_tr_b16 v[116:117], v3 offset:22528
    ds_read_b64_tr_b16 v[118:119], v3 offset:23552
    v_mfma_f32_32x32x16_bf16 v[176:191], v[100:103], a[208:211], v[176:191]
    s_waitcnt lgkmcnt(6)
    v_mfma_f32_32x32x16_bf16 v[128:143], v[104:107], a[52:55], v[128:143]
    ds_read_b64_tr_b16 v[120:121], v3 offset:18944
    ds_read_b64_tr_b16 v[122:123], v3 offset:19968
    v_mfma_f32_32x32x16_bf16 v[144:159], v[104:107], a[212:215], v[144:159]
    s_waitcnt lgkmcnt(6)
    v_mfma_f32_32x32x16_bf16 v[160:175], v[108:111], a[52:55], v[160:175]
    ds_read_b64_tr_b16 v[124:125], v3 offset:23040
    ds_read_b64_tr_b16 v[126:127], v3 offset:24064
    v_mfma_f32_32x32x16_bf16 v[176:191], v[108:111], a[212:215], v[176:191]
    s_waitcnt lgkmcnt(6)
    v_mfma_f32_32x32x16_bf16 v[128:143], v[112:115], a[56:59], v[128:143]
    s_waitcnt vmcnt(12)
    s_barrier
    ds_read_b64_tr_b16 v[96:97], v3 offset:24576
    ds_read_b64_tr_b16 v[98:99], v3 offset:25600
    v_mfma_f32_32x32x16_bf16 v[144:159], v[112:115], a[216:219], v[144:159]
    s_add_u32 m0, s60, 40960
    s_nop 0
    buffer_load_dwordx4 v4, s[36:39], s44 offen lds
    s_add_u32 m0, s60, 45056
    s_add_u32 s44, s44, s46
    buffer_load_dwordx4 v4, s[40:43], s45 offen lds
    s_add_u32 s45, s45, s46
    s_waitcnt lgkmcnt(6)
    v_mfma_f32_32x32x16_bf16 v[160:175], v[116:119], a[56:59], v[160:175]
    ds_read_b64_tr_b16 v[100:101], v3 offset:28672
    ds_read_b64_tr_b16 v[102:103], v3 offset:29696
    v_mfma_f32_32x32x16_bf16 v[176:191], v[116:119], a[216:219], v[176:191]
    s_waitcnt lgkmcnt(6)
    v_mfma_f32_32x32x16_bf16 v[128:143], v[120:123], a[60:63], v[128:143]
    ds_read_b64_tr_b16 v[104:105], v3 offset:25088
    ds_read_b64_tr_b16 v[106:107], v3 offset:26112
    v_mfma_f32_32x32x16_bf16 v[144:159], v[120:123], a[220:223], v[144:159]
    s_waitcnt lgkmcnt(6)
    v_mfma_f32_32x32x16_bf16 v[160:175], v[124:127], a[60:63], v[160:175]
    ds_read_b64_tr_b16 v[108:109], v3 offset:29184
    ds_read_b64_tr_b16 v[110:111], v3 offset:30208
    v_mfma_f32_32x32x16_bf16 v[176:191], v[124:127], a[220:223], v[176:191]
    s_waitcnt lgkmcnt(6)
    v_mfma_f32_32x32x16_bf16 v[128:143], v[96:99], a[64:67], v[128:143]
    ds_read_b64_tr_b16 v[112:113], v3 offset:26624
    ds_read_b64_tr_b16 v[114:115], v3 offset:27648
    v_mfma_f32_32x32x16_bf16 v[144:159], v[96:99], a[224:227], v[144:159]
    s_waitcnt lgkmcnt(6)
    v_mfma_f32_32x32x16_bf16 v[160:175], v[100:103], a[64:67], v[160:175]
    ds_read_b64_tr_b16 v[116:117], v3 offset:30720
    ds_read_b64_tr_b16 v[118:119], v3 offset:31744
    v_mfma_f32_32x32x16_bf16 v[176:191], v[100:103], a[224:227], v[176:191]
    s_waitcnt lgkmcnt(6)
    v_mfma_f32_32x32x16_bf16 v[128:143], v[104:107], a[68:71], v[128:143]
    ds_read_b64_tr_b16 v[120:121], v3 offset:27136
    ds_read_b64_tr_b16 v[122:123], v3 offset:28160
    v_mfma_f32_32x32x16_bf16 v[144:159], v[104:107], a[228:231], v[144:159]
    s_waitcnt lgkmcnt(6)
    v_mfma_f32_32x32x16_bf16 v[160:175], v[108:111], a[68:71], v[160:175]
    ds_read_b64_tr_b16 v[124:125], v3 offset:31232
    ds_read_b64_tr_b16 v[126:127], v3 offset:32256
    v_mfma_f32_32x32x16_bf16 v[176:191], v[108:111], a[228:231], v[176:191]
    s_waitcnt lgkmcnt(6)
    v_mfma_f32_32x32x16_bf16 v[128:143], v[112:115], a[72:75], v[128:143]
    s_waitcnt vmcnt(12)
    s_barrier
    ds_read_b64_tr_b16 v[96:97], v3 offset:32768
    ds_read_b64_tr_b16 v[98:99], v3 offset:33792
    v_mfma_f32_32x32x16_bf16 v[144:159], v[112:115], a[232:235], v[144:159]
    s_add_u32 m0, s60, 49152
    s_nop 0
    buffer_load_dwordx4 v4, s[36:39], s44 offen lds
    s_add_u32 m0, s60, 53248
    s_add_u32 s44, s44, s46
    buffer_load_dwordx4 v4, s[40:43], s45 offen lds
    s_add_u32 s45, s45, s46
    s_waitcnt lgkmcnt(6)
    v_mfma_f32_32x32x16_bf16 v[160:175], v[116:119], a[72:75], v[160:175]
    ds_read_b64_tr_b16 v[100:101], v3 offset:36864
    ds_read_b64_tr_b16 v[102:103], v3 offset:37888
    v_mfma_f32_32x32x16_bf16 v[176:191], v[116:119], a[232:235], v[176:191]
    s_waitcnt lgkmcnt(6)
    v_mfma_f32_32x32x16_bf16 v[128:143], v[120:123], a[76:79], v[128:143]
    ds_read_b64_tr_b16 v[104:105], v3 offset:33280
    ds_read_b64_tr_b16 v[106:107], v3 offset:34304
    v_mfma_f32_32x32x16_bf16 v[144:159], v[120:123], a[236:239], v[144:159]
    s_waitcnt lgkmcnt(6)
    v_mfma_f32_32x32x16_bf16 v[160:175], v[124:127], a[76:79], v[160:175]
    ds_read_b64_tr_b16 v[108:109], v3 offset:37376
    ds_read_b64_tr_b16 v[110:111], v3 offset:38400
    v_mfma_f32_32x32x16_bf16 v[176:191], v[124:127], a[236:239], v[176:191]
    s_waitcnt lgkmcnt(6)
    v_mfma_f32_32x32x16_bf16 v[128:143], v[96:99], a[80:83], v[128:143]
    ds_read_b64_tr_b16 v[112:113], v3 offset:34816
    ds_read_b64_tr_b16 v[114:115], v3 offset:35840
    v_mfma_f32_32x32x16_bf16 v[144:159], v[96:99], a[240:243], v[144:159]
    s_waitcnt lgkmcnt(6)
    v_mfma_f32_32x32x16_bf16 v[160:175], v[100:103], a[80:83], v[160:175]
    ds_read_b64_tr_b16 v[116:117], v3 offset:38912
    ds_read_b64_tr_b16 v[118:119], v3 offset:39936
    v_mfma_f32_32x32x16_bf16 v[176:191], v[100:103], a[240:243], v[176:191]
    s_waitcnt lgkmcnt(6)
    v_mfma_f32_32x32x16_bf16 v[128:143], v[104:107], a[84:87], v[128:143]
    ds_read_b64_tr_b16 v[120:121], v3 offset:35328
    ds_read_b64_tr_b16 v[122:123], v3 offset:36352
    v_mfma_f32_32x32x16_bf16 v[144:159], v[104:107], a[244:247], v[144:159]
    s_waitcnt lgkmcnt(6)
    v_mfma_f32_32x32x16_bf16 v[160:175], v[108:111], a[84:87], v[160:175]
    ds_read_b64_tr_b16 v[124:125], v3 offset:39424
    ds_read_b64_tr_b16 v[126:127], v3 offset:40448
    v_mfma_f32_32x32x16_bf16 v[176:191], v[108:111], a[244:247], v[176:191]
    s_waitcnt lgkmcnt(6)
    v_mfma_f32_32x32x16_bf16 v[128:143], v[112:115], a[88:91], v[128:143]
    s_waitcnt vmcnt(12)
    s_barrier
    ds_read_b64_tr_b16 v[96:97], v2 offset:0
    ds_read_b64_tr_b16 v[98:99], v2 offset:1024
    v_mfma_f32_32x32x16_bf16 v[144:159], v[112:115], a[248:251], v[144:159]
    s_add_u32 m0, s60, 57344
    s_nop 0
    buffer_load_dwordx4 v4, s[36:39], s44 offen lds
    s_add_u32 m0, s60, 61440
    s_add_u32 s44, s44, s46
    buffer_load_dwordx4 v4, s[40:43], s45 offen lds
    s_add_u32 s45, s45, s46
    s_waitcnt lgkmcnt(6)
    v_mfma_f32_32x32x16_bf16 v[160:175], v[116:119], a[88:91], v[160:175]
    ds_read_b64_tr_b16 v[100:101], v2 offset:4096
    ds_read_b64_tr_b16 v[102:103], v2 offset:5120
    v_mfma_f32_32x32x16_bf16 v[176:191], v[116:119], a[248:251], v[176:191]
    s_waitcnt lgkmcnt(6)
    v_mfma_f32_32x32x16_bf16 v[128:143], v[120:123], a[92:95], v[128:143]
    ds_read_b64_tr_b16 v[104:105], v2 offset:512
    ds_read_b64_tr_b16 v[106:107], v2 offset:1536
    v_mfma_f32_32x32x16_bf16 v[144:159], v[120:123], a[252:255], v[144:159]
    s_waitcnt lgkmcnt(6)
    v_mfma_f32_32x32x16_bf16 v[160:175], v[124:127], a[92:95], v[160:175]
    ds_read_b64_tr_b16 v[108:109], v2 offset:4608
    ds_read_b64_tr_b16 v[110:111], v2 offset:5632
    v_mfma_f32_32x32x16_bf16 v[176:191], v[124:127], a[252:255], v[176:191]
    s_mov_b32 s54, 0xbfb8aa3b
    v_mul_f32 v128, s54, v128
    v_mul_f32 v129, s54, v129
    v_mul_f32 v130, s54, v130
    v_mul_f32 v131, s54, v131
    v_mul_f32 v132, s54, v132
    v_mul_f32 v133, s54, v133
    v_mul_f32 v134, s54, v134
    v_mul_f32 v135, s54, v135
    v_mul_f32 v136, s54, v136
    v_mul_f32 v137, s54, v137
    v_mul_f32 v138, s54, v138
    v_mul_f32 v139, s54, v139
    v_mul_f32 v140, s54, v140
    v_mul_f32 v141, s54, v141
    v_mul_f32 v142, s54, v142
    v_mul_f32 v143, s54, v143
    v_exp_f32 v128, v128
    v_exp_f32 v129, v129
    v_exp_f32 v130, v130
    v_exp_f32 v131, v131
    v_exp_f32 v132, v132
    v_exp_f32 v133, v133
    v_exp_f32 v134, v134
    v_exp_f32 v135, v135
    v_exp_f32 v136, v136
    v_exp_f32 v137, v137
    v_exp_f32 v138, v138
    v_exp_f32 v139, v139
    v_exp_f32 v140, v140
    v_exp_f32 v141, v141
    v_exp_f32 v142, v142
    v_exp_f32 v143, v143
    v_add_f32 v128, 1.0, v128
    v_add_f32 v129, 1.0, v129
    v_add_f32 v130, 1.0, v130
    v_add_f32 v131, 1.0, v131
    v_add_f32 v132, 1.0, v132
    v_add_f32 v133, 1.0, v133
    v_add_f32 v134, 1.0, v134
    v_add_f32 v135, 1.0, v135
    v_add_f32 v136, 1.0, v136
    v_add_f32 v137, 1.0, v137
    v_add_f32 v138, 1.0, v138
    v_add_f32 v139, 1.0, v139
    v_add_f32 v140, 1.0, v140
    v_add_f32 v141, 1.0, v141
    v_add_f32 v142, 1.0, v142
    v_add_f32 v143, 1.0, v143
    v_rcp_f32 v128, v128
    v_rcp_f32 v129, v129
    v_rcp_f32 v130, v130
    v_rcp_f32 v131, v131
    v_rcp_f32 v132, v132
    v_rcp_f32 v133, v133
    v_rcp_f32 v134, v134
    v_rcp_f32 v135, v135
    v_rcp_f32 v136, v136
    v_rcp_f32 v137, v137
    v_rcp_f32 v138, v138
    v_rcp_f32 v139, v139
    v_rcp_f32 v140, v140
    v_rcp_f32 v141, v141
    v_rcp_f32 v142, v142
    v_rcp_f32 v143, v143
    v_pk_mul_f32 v[128:129], v[128:129], v[160:161]
    v_pk_mul_f32 v[130:131], v[130:131], v[162:163]
    v_pk_mul_f32 v[132:133], v[132:133], v[164:165]
    v_pk_mul_f32 v[134:135], v[134:135], v[166:167]
    v_pk_mul_f32 v[136:137], v[136:137], v[168:169]
    v_pk_mul_f32 v[138:139], v[138:139], v[170:171]
    v_pk_mul_f32 v[140:141], v[140:141], v[172:173]
    v_pk_mul_f32 v[142:143], v[142:143], v[174:175]
    v_cvt_pk_bf16_f32 v64, v128, v129
    v_cvt_pk_bf16_f32 v65, v130, v131
    v_cvt_pk_bf16_f32 v66, v136, v137
    v_cvt_pk_bf16_f32 v67, v138, v139
    buffer_store_dwordx4 v[64:67], v8, s[32:35], s49 offen offset:0 sc1
    v_cvt_pk_bf16_f32 v68, v132, v133
    v_cvt_pk_bf16_f32 v69, v134, v135
    v_cvt_pk_bf16_f32 v70, v140, v141
    v_cvt_pk_bf16_f32 v71, v142, v143
    buffer_store_dwordx4 v[68:71], v8, s[32:35], s49 offen offset:1024 sc1
    v_mul_f32 v144, s54, v144
    v_mul_f32 v145, s54, v145
    v_mul_f32 v146, s54, v146
    v_mul_f32 v147, s54, v147
    v_mul_f32 v148, s54, v148
    v_mul_f32 v149, s54, v149
    v_mul_f32 v150, s54, v150
    v_mul_f32 v151, s54, v151
    v_mul_f32 v152, s54, v152
    v_mul_f32 v153, s54, v153
    v_mul_f32 v154, s54, v154
    v_mul_f32 v155, s54, v155
    v_mul_f32 v156, s54, v156
    v_mul_f32 v157, s54, v157
    v_mul_f32 v158, s54, v158
    v_mul_f32 v159, s54, v159
    v_exp_f32 v144, v144
    v_exp_f32 v145, v145
    v_exp_f32 v146, v146
    v_exp_f32 v147, v147
    v_exp_f32 v148, v148
    v_exp_f32 v149, v149
    v_exp_f32 v150, v150
    v_exp_f32 v151, v151
    v_exp_f32 v152, v152
    v_exp_f32 v153, v153
    v_exp_f32 v154, v154
    v_exp_f32 v155, v155
    v_exp_f32 v156, v156
    v_exp_f32 v157, v157
    v_exp_f32 v158, v158
    v_exp_f32 v159, v159
    v_add_f32 v144, 1.0, v144
    v_add_f32 v145, 1.0, v145
    v_add_f32 v146, 1.0, v146
    v_add_f32 v147, 1.0, v147
    v_add_f32 v148, 1.0, v148
    v_add_f32 v149, 1.0, v149
    v_add_f32 v150, 1.0, v150
    v_add_f32 v151, 1.0, v151
    v_add_f32 v152, 1.0, v152
    v_add_f32 v153, 1.0, v153
    v_add_f32 v154, 1.0, v154
    v_add_f32 v155, 1.0, v155
    v_add_f32 v156, 1.0, v156
    v_add_f32 v157, 1.0, v157
    v_add_f32 v158, 1.0, v158
    v_add_f32 v159, 1.0, v159
    v_rcp_f32 v144, v144
    v_rcp_f32 v145, v145
    v_rcp_f32 v146, v146
    v_rcp_f32 v147, v147
    v_rcp_f32 v148, v148
    v_rcp_f32 v149, v149
    v_rcp_f32 v150, v150
    v_rcp_f32 v151, v151
    v_rcp_f32 v152, v152
    v_rcp_f32 v153, v153
    v_rcp_f32 v154, v154
    v_rcp_f32 v155, v155
    v_rcp_f32 v156, v156
    v_rcp_f32 v157, v157
    v_rcp_f32 v158, v158
    v_rcp_f32 v159, v159
    v_pk_mul_f32 v[144:145], v[144:145], v[176:177]
    v_pk_mul_f32 v[146:147], v[146:147], v[178:179]
    v_pk_mul_f32 v[148:149], v[148:149], v[180:181]
    v_pk_mul_f32 v[150:151], v[150:151], v[182:183]
    v_pk_mul_f32 v[152:153], v[152:153], v[184:185]
    v_pk_mul_f32 v[154:155], v[154:155], v[186:187]
    v_pk_mul_f32 v[156:157], v[156:157], v[188:189]
    v_pk_mul_f32 v[158:159], v[158:159], v[190:191]
    v_cvt_pk_bf16_f32 v72, v144, v145
    v_cvt_pk_bf16_f32 v73, v146, v147
    v_cvt_pk_bf16_f32 v74, v152, v153
    v_cvt_pk_bf16_f32 v75, v154, v155
    buffer_store_dwordx4 v[72:75], v8, s[32:35], s50 offen offset:0 sc1
    v_cvt_pk_bf16_f32 v76, v148, v149
    v_cvt_pk_bf16_f32 v77, v150, v151
    v_cvt_pk_bf16_f32 v78, v156, v157
    v_cvt_pk_bf16_f32 v79, v158, v159
    buffer_store_dwordx4 v[76:79], v8, s[32:35], s50 offen offset:1024 sc1
    s_bfe_u32 s53, s47, 0x100008
    s_branch L_gx_next
L_gx_eager:
    s_waitcnt vmcnt(0) lgkmcnt(0)
    s_mov_b32 s54, 248
    v_mov_b32 v11, s54
    s_cmp_lg_u32 s51, 0
    s_cbranch_scc1 L_polld1
L_poll1:
    global_load_dword v10, v11, s[28:29] sc1
    s_waitcnt vmcnt(0)
    v_cmp_gt_u32 vcc, 64, v10
    s_nop 0
    s_cbranch_vccz L_polld1
    s_sleep 16
    s_sub_u32 s99, s99, 1
    s_cbranch_scc0 L_poll1
    s_endpgm
L_polld1:
    s_barrier
    s_cmp_eq_u32 s53, 0
    s_cbranch_scc1 L_ns_eg
    s_cmp_lg_u32 s51, 0
    s_cbranch_scc1 L_ns2_eg
    s_and_b32 s54, s53, 255
    s_lshl_b32 s54, s54, 3
    s_and_b32 s55, s2, 7
    s_add_u32 s54, s54, s55
    s_lshl_b32 s54, s54, 7
    s_add_u32 s54, s54, 95828992
    s_bfe_u32 s55, s53, 0x70008
    v_mov_b32 v10, s54
    v_mov_b32 v11, s55
    s_mov_b64 exec, 1
    buffer_atomic_add v11, v10, s[32:35], 0 offen
    s_mov_b64 exec, -1
L_ns2_eg:
    s_mov_b32 s53, 0
L_ns_eg:
    s_and_b32 s54, s64, 255
    s_cmp_ge_u32 s54, 192
    s_cbranch_scc1 L_dg_eg
    s_lshr_b32 s55, s54, 6
    s_cmp_eq_u32 s55, 1
    s_cselect_b32 s36, s12, s10
    s_cselect_b32 s37, s13, s11
    s_cmp_eq_u32 s55, 2
    s_cselect_b32 s36, s8, s36
    s_cselect_b32 s37, s9, s37
    s_mov_b32 s40, s36
    s_mov_b32 s41, s37
    s_mov_b32 s38, 5242880
    s_mov_b32 s42, 5242880
    s_and_b32 s54, s54, 63
    s_lshl_b32 s44, s54, 7
    s_add_u32 s45, s44, 64
    s_mov_b32 s46, 524288
    v_mov_b32 v4, v5
    s_branch L_dd_eg
L_dg_eg:
    s_mov_b32 s36, s20
    s_mov_b32 s37, s21
    s_mov_b32 s40, s22
    s_mov_b32 s41, s23
    s_cmp_eq_u32 s54, 255
    s_cselect_b32 s38, 0, 2211840
    s_mov_b32 s42, s38
    s_sub_u32 s54, s54, 192
    s_lshl_b32 s44, s54, 6
    s_mov_b32 s45, s44
    s_mov_b32 s46, 221184
    v_mov_b32 v4, v6
L_dd_eg:
    s_lshr_b32 s54, s64, 24
    s_cmp_lg_u32 s54, s52
    s_mov_b32 s52, s54
    s_cbranch_scc1 L_gx_panel
    s_add_u32 m0, s60, 0
    s_nop 0
    buffer_load_dwordx4 v4, s[36:39], s44 offen lds
    s_add_u32 m0, s60, 4096
    s_add_u32 s44, s44, s46
    buffer_load_dwordx4 v4, s[40:43], s45 offen lds
    s_add_u32 s45, s45, s46
    s_add_u32 m0, s60, 8192
    s_nop 0
    buffer_load_dwordx4 v4, s[36:39], s44 offen lds
    s_add_u32 m0, s60, 12288
    s_add_u32 s44, s44, s46
    buffer_load_dwordx4 v4, s[40:43], s45 offen lds
    s_add_u32 s45, s45, s46
    s_branch L_gx_fill
L_gx_end:
    s_waitcnt vmcnt(0) lgkmcnt(0)
    s_barrier
    s_cmp_eq_u32 s53, 0
    s_cbranch_scc1 L_ns_end
    s_cmp_lg_u32 s51, 0
    s_cbranch_scc1 L_ns2_end
    s_and_b32 s54, s53, 255
    s_lshl_b32 s54, s54, 3
    s_and_b32 s55, s2, 7
    s_add_u32 s54, s54, s55
    s_lshl_b32 s54, s54, 7
    s_add_u32 s54, s54, 95828992
    s_bfe_u32 s55, s53, 0x70008
    v_mov_b32 v10, s54
    v_mov_b32 v11, s55
    s_mov_b64 exec, 1
    buffer_atomic_add v11, v10, s[32:35], 0 offen
    s_mov_b64 exec, -1
L_ns2_end:
    s_mov_b32 s53, 0
L_ns_end:
L_gx_done:
    s_bfe_u32 s54, s100, 0x80010
    s_cmp_eq_u32 s54, 2
    s_cbranch_scc1 L_exit
    s_cmp_eq_u32 s54, 1
    s_cbranch_scc1 L_fin
    s_and_b32 s53, s101, 255
    s_bfe_u32 s52, s101, 0x80008
    v_and_b32 v10, 63, v0
    v_lshlrev_b32 v2, 4, v10
    v_lshlrev_b32 v3, 3, v10
    v_and_b32 v11, 15, v10
    v_lshrrev_b32 v12, 4, v10
    v_lshrrev_b32 v13, 1, v12
    v_lshlrev_b32 v13, 10, v13
    v_and_b32 v14, 1, v12
    v_lshl_add_u32 v13, v14, 9, v13
    v_lshl_add_u32 v4, v11, 4, v13
    v_lshlrev_b32 v13, 2, v12
    v_cmp_gt_u32 s[60:61], v13, v11
    v_add_u32 v13, 1, v13
    v_cmp_gt_u32 s[62:63], v13, v11
    v_add_u32 v13, 1, v13
    v_cmp_gt_u32 s[64:65], v13, v11
    v_add_u32 v13, 1, v13
    v_cmp_gt_u32 s[66:67], v13, v11
    v_add_u32 v13, 1, v13
    v_lshrrev_b32 v13, 2, v11
    v_cmp_eq_u32 vcc, v13, v12
    v_and_b32 v13, 1, v11
    v_lshlrev_b32 v13, 4, v13
    v_mov_b32 v14, 0x3f80
    v_lshlrev_b32 v14, v13, v14
    v_cndmask_b32 v180, 0, v14, vcc
    v_cndmask_b32 v183, 0, v14, vcc
    v_mov_b32 v181, 0
    v_mov_b32 v182, 0
    v_mov_b32 v173, 0
    v_mov_b32 v174, 0
    v_mov_b32 v177, 0
    v_mov_b32 v178, 0
    v_mov_b32 v166, 0
    v_mov_b32 v167, 0
    v_mov_b32 v5, 0xf149f2ca
    s_mov_b32 s68, 0x3e0293ee
    s_mov_b32 s69, 0x3e0293ee
    s_and_b32 s57, s52, 0
    s_lshl_b32 s57, s57, 12
    v_mov_b32 v1, s57
    s_lshl_b32 s57, s53, 9
    s_lshl_b32 s58, s51, 7
    s_add_u32 s57, s57, s58
    s_add_u32 s57, s57, 95817728
    v_add_u32 v1, s57, v1
    s_add_u32 s57, s52, 56
    s_cmp_lt_u32 s57, 61
    s_cbranch_scc1 L_att_nopre
    s_lshl_b32 s57, s57, 5
    s_lshl_b32 s58, s53, 2
    s_add_u32 s57, s57, s58
    s_add_u32 s57, s57, s51
    s_lshl_b32 s57, s57, 13
    s_add_u32 s57, s57, 54525952
    s_add_u32 s58, s57, 4096
    v_mov_b64 v[16:17], -1
    v_mov_b64 v[18:19], -1
    buffer_store_dwordx4 v[16:19], v2, s[32:35], s57 offen offset:0 sc1
    buffer_store_dwordx4 v[16:19], v2, s[32:35], s57 offen offset:1024 sc1
    buffer_store_dwordx4 v[16:19], v2, s[32:35], s57 offen offset:2048 sc1
    buffer_store_dwordx4 v[16:19], v2, s[32:35], s57 offen offset:3072 sc1
    buffer_store_dwordx4 v[16:19], v2, s[32:35], s58 offen offset:0 sc1
    buffer_store_dwordx4 v[16:19], v2, s[32:35], s58 offen offset:1024 sc1
    buffer_store_dwordx4 v[16:19], v2, s[32:35], s58 offen offset:2048 sc1
    buffer_store_dwordx4 v[16:19], v2, s[32:35], s58 offen offset:3072 sc1
    s_waitcnt vmcnt(0)
L_att_nopre:
L_att_loop:
    s_lshr_b32 s57, s52, 3
    s_cmp_lg_u32 s51, 0
    s_cbranch_scc1 L_polld2
    s_lshl_b32 s3, s57, 10
    s_add_u32 s3, s3, 95830016
    v_and_b32 v11, 7, v0
    v_lshlrev_b32 v11, 7, v11
L_poll2:
    buffer_load_dword v10, v11, s[32:35], s3 offen sc1
    s_waitcnt vmcnt(0)
    v_add_u32_dpp v10, v10, v10 row_shr:1 row_mask:0xf bank_mask:0xf bound_ctrl:0
    s_nop 1
    v_add_u32_dpp v10, v10, v10 row_shr:2 row_mask:0xf bank_mask:0xf bound_ctrl:0
    s_nop 1
    v_add_u32_dpp v10, v10, v10 row_shr:4 row_mask:0xf bank_mask:0xf bound_ctrl:0
    s_nop 0
    v_readlane_b32 s98, v10, 7
    s_nop 0
    s_cmp_ge_u32 s98, 128
    s_cbranch_scc1 L_polld2
    s_sleep 16
    s_sub_u32 s99, s99, 1
    s_cbranch_scc0 L_poll2
    s_endpgm
L_polld2:
    s_barrier
    s_cmp_lg_u32 s51, 0
    s_cbranch_scc1 L_polld3
    s_lshl_b32 s3, s57, 10
    s_add_u32 s3, s3, 95838208
    v_and_b32 v11, 7, v0
    v_lshlrev_b32 v11, 7, v11
L_poll3:
    buffer_load_dword v10, v11, s[32:35], s3 offen sc1
    s_waitcnt vmcnt(0)
    v_add_u32_dpp v10, v10, v10 row_shr:1 row_mask:0xf bank_mask:0xf bound_ctrl:0
    s_nop 1
    v_add_u32_dpp v10, v10, v10 row_shr:2 row_mask:0xf bank_mask:0xf bound_ctrl:0
    s_nop 1
    v_add_u32_dpp v10, v10, v10 row_shr:4 row_mask:0xf bank_mask:0xf bound_ctrl:0
    s_nop 0
    v_readlane_b32 s98, v10, 7
    s_nop 0
    s_cmp_ge_u32 s98, 118
    s_cbranch_scc1 L_polld3
    s_sleep 16
    s_sub_u32 s99, s99, 1
    s_cbranch_scc0 L_poll3
    s_endpgm
L_polld3:
    s_barrier
    s_lshl_b32 s57, s53, 2
    s_add_u32 s57, s57, s51
    s_lshl_b32 s58, s52, 5
    s_add_u32 s58, s58, s57
    s_mul_i32 s54, s58, 24576
    s_add_u32 s54, s54, 4194304
    s_lshl_b32 s55, s58, 12
    s_add_u32 s55, s55, 79691776
    s_lshl_b32 s56, s58, 13
    s_add_u32 s56, s56, 54525952
    s_add_u32 s57, s54, 0
    buffer_load_dwordx4 v[48:51], v2, s[32:35], s57 offen offset:0 sc1
    buffer_load_dwordx4 v[52:55], v2, s[32:35], s57 offen offset:1024 sc1
    buffer_load_dwordx4 v[56:59], v2, s[32:35], s57 offen offset:2048 sc1
    buffer_load_dwordx4 v[60:63], v2, s[32:35], s57 offen offset:3072 sc1
    s_add_u32 s57, s54, 4096
    buffer_load_dwordx4 v[64:67], v2, s[32:35], s57 offen offset:0 sc1
    buffer_load_dwordx4 v[68:71], v2, s[32:35], s57 offen offset:1024 sc1
    buffer_load_dwordx4 v[72:75], v2, s[32:35], s57 offen offset:2048 sc1
    buffer_load_dwordx4 v[76:79], v2, s[32:35], s57 offen offset:3072 sc1
    s_add_u32 s57, s54, 16384
    buffer_load_dwordx4 v[16:19], v2, s[32:35], s57 offen offset:0 sc1
    buffer_load_dwordx4 v[20:23], v2, s[32:35], s57 offen offset:1024 sc1
    buffer_load_dwordx4 v[24:27], v2, s[32:35], s57 offen offset:2048 sc1
    buffer_load_dwordx4 v[28:31], v2, s[32:35], s57 offen offset:3072 sc1
    s_add_u32 s57, s54, 20480
    buffer_load_dwordx4 v[32:35], v2, s[32:35], s57 offen offset:0 sc1
    buffer_load_dwordx4 v[36:39], v2, s[32:35], s57 offen offset:1024 sc1
    buffer_load_dwordx4 v[40:43], v2, s[32:35], s57 offen offset:2048 sc1
    buffer_load_dwordx4 v[44:47], v2, s[32:35], s57 offen offset:3072 sc1
    s_add_u32 s57, s54, 8192
    buffer_load_dwordx4 v[80:83], v2, s[32:35], s57 offen offset:0 sc1
    buffer_load_dwordx4 v[84:87], v2, s[32:35], s57 offen offset:1024 sc1
    buffer_load_dwordx4 v[88:91], v2, s[32:35], s57 offen offset:2048 sc1
    buffer_load_dwordx4 v[92:95], v2, s[32:35], s57 offen offset:3072 sc1
    s_add_u32 s57, s54, 12288
    buffer_load_dwordx4 v[96:99], v2, s[32:35], s57 offen offset:0 sc1
    buffer_load_dwordx4 v[100:103], v2, s[32:35], s57 offen offset:1024 sc1
    buffer_load_dwordx4 v[104:107], v2, s[32:35], s57 offen offset:2048 sc1
    buffer_load_dwordx4 v[108:111], v2, s[32:35], s57 offen offset:3072 sc1
    s_waitcnt vmcnt(8)
    v_mfma_f32_16x16x32_bf16 v[144:147], v[48:51], v[16:19], 0
    v_mfma_f32_16x16x32_bf16 v[148:151], v[48:51], v[20:23], 0
    v_mfma_f32_16x16x32_bf16 v[152:155], v[52:55], v[20:23], 0
    v_mfma_f32_16x16x32_bf16 v[144:147], v[56:59], v[24:27], v[144:147]
    v_mfma_f32_16x16x32_bf16 v[148:151], v[56:59], v[28:31], v[148:151]
    v_mfma_f32_16x16x32_bf16 v[152:155], v[60:63], v[28:31], v[152:155]
    v_mfma_f32_16x16x32_bf16 v[144:147], v[64:67], v[32:35], v[144:147]
    v_mfma_f32_16x16x32_bf16 v[148:151], v[64:67], v[36:39], v[148:151]
    v_mfma_f32_16x16x32_bf16 v[152:155], v[68:71], v[36:39], v[152:155]
    v_mfma_f32_16x16x32_bf16 v[144:147], v[72:75], v[40:43], v[144:147]
    v_mfma_f32_16x16x32_bf16 v[148:151], v[72:75], v[44:47], v[148:151]
    v_mfma_f32_16x16x32_bf16 v[152:155], v[76:79], v[44:47], v[152:155]
    s_nop 0
    v_cndmask_b32 v144, v144, v5, s[60:61]
    v_cndmask_b32 v145, v145, v5, s[62:63]
    v_cndmask_b32 v146, v146, v5, s[64:65]
    v_cndmask_b32 v147, v147, v5, s[66:67]
    s_nop 2
    v_cndmask_b32 v152, v152, v5, s[60:61]
    v_cndmask_b32 v153, v153, v5, s[62:63]
    v_cndmask_b32 v154, v154, v5, s[64:65]
    v_cndmask_b32 v155, v155, v5, s[66:67]
    v_max3_f32 v8, v148, v149, v150
    v_max3_f32 v6, v144, v145, v146
    v_max3_f32 v8, v8, v151, v152
    v_max3_f32 v8, v8, v153, v154
    s_add_u32 s59, s52, 2
    s_cmp_ge_u32 s52, 60
    s_cbranch_scc1 L_att_tag
L_poll4:
    buffer_load_dword v10, v1, s[32:35], 0 offen sc1
    s_waitcnt vmcnt(0)
    v_cmp_gt_u32 vcc, s59, v10
    s_nop 0
    s_cbranch_vccz L_polld4
    s_sleep 2
    s_sub_u32 s99, s99, 1
    s_cbranch_scc0 L_poll4
    s_endpgm
L_polld4:
    buffer_load_dwordx4 v[112:115], v2, s[32:35], s55 offen offset:0 sc1
    buffer_load_dwordx4 v[116:119], v2, s[32:35], s55 offen offset:1024 sc1
    buffer_load_dwordx4 v[120:123], v2, s[32:35], s55 offen offset:2048 sc1
    buffer_load_dwordx4 v[124:127], v2, s[32:35], s55 offen offset:3072 sc1
L_att_go:
    s_waitcnt vmcnt(3)
    v_mfma_f32_16x16x16_bf16 v[184:187], v[114:115], v[180:181], 0
    v_mfma_f32_16x16x16_bf16 v[188:191], v[114:115], v[182:183], 0
    s_waitcnt vmcnt(2)
    v_mfma_f32_16x16x16_bf16 v[192:195], v[118:119], v[180:181], 0
    v_mfma_f32_16x16x16_bf16 v[196:199], v[118:119], v[182:183], 0
    s_waitcnt vmcnt(1)
    v_mfma_f32_16x16x16_bf16 v[200:203], v[122:123], v[180:181], 0
    v_mfma_f32_16x16x16_bf16 v[204:207], v[122:123], v[182:183], 0
    s_waitcnt vmcnt(0)
    v_mfma_f32_16x16x16_bf16 v[208:211], v[126:127], v[180:181], 0
    v_mfma_f32_16x16x16_bf16 v[212:215], v[126:127], v[182:183], 0
    v_cvt_pk_bf16_f32 v128, v184, v185
    v_cvt_pk_bf16_f32 v129, v186, v187
    v_cvt_pk_bf16_f32 v130, v188, v189
    v_cvt_pk_bf16_f32 v131, v190, v191
    v_cvt_pk_bf16_f32 v132, v192, v193
    v_cvt_pk_bf16_f32 v133, v194, v195
    v_cvt_pk_bf16_f32 v134, v196, v197
    v_cvt_pk_bf16_f32 v135, v198, v199
    v_cvt_pk_bf16_f32 v136, v200, v201
    v_cvt_pk_bf16_f32 v137, v202, v203
    v_cvt_pk_bf16_f32 v138, v204, v205
    v_cvt_pk_bf16_f32 v139, v206, v207
    v_cvt_pk_bf16_f32 v140, v208, v209
    v_cvt_pk_bf16_f32 v141, v210, v211
    v_cvt_pk_bf16_f32 v142, v212, v213
    v_cvt_pk_bf16_f32 v143, v214, v215
    v_mfma_f32_16x16x32_bf16 v[156:159], v[128:131], v[16:19], 0
    v_mfma_f32_16x16x32_bf16 v[160:163], v[128:131], v[20:23], 0
    v_mfma_f32_16x16x32_bf16 v[156:159], v[132:135], v[24:27], v[156:159]
    v_mfma_f32_16x16x32_bf16 v[160:163], v[132:135], v[28:31], v[160:163]
    v_mfma_f32_16x16x32_bf16 v[156:159], v[136:139], v[32:35], v[156:159]
    v_mfma_f32_16x16x32_bf16 v[160:163], v[136:139], v[36:39], v[160:163]
    v_mfma_f32_16x16x32_bf16 v[156:159], v[140:143], v[40:43], v[156:159]
    v_mfma_f32_16x16x32_bf16 v[160:163], v[140:143], v[44:47], v[160:163]
    s_nop 4
    v_max3_f32 v6, v6, v147, v156
    s_nop 1
    v_max3_f32 v8, v8, v155, v160
    v_max_f32 v6, v6, v157
    v_max_f32 v8, v8, v161
    v_mov_b32 v7, v6
    v_mov_b32 v9, v8
    s_nop 0
    v_permlane16_swap_b32 v6, v7
    v_permlane16_swap_b32 v8, v9
    v_max_f32 v6, v6, v7
    v_max_f32 v8, v8, v9
    v_mov_b32 v7, v6
    v_mov_b32 v9, v8
    s_nop 0
    v_permlane32_swap_b32 v6, v7
    v_permlane32_swap_b32 v8, v9
    v_max_f32 v6, v6, v7
    v_max_f32 v8, v8, v9
    v_mul_f32 v6, s68, v6
    v_mul_f32 v8, s68, v8
    v_pk_fma_f32 v[144:145], v[144:145], s[68:69], v[6:7] op_sel_hi:[1,0,0] neg_lo:[0,0,1] neg_hi:[0,0,1]
    v_pk_fma_f32 v[146:147], v[146:147], s[68:69], v[6:7] op_sel_hi:[1,0,0] neg_lo:[0,0,1] neg_hi:[0,0,1]
    v_pk_fma_f32 v[156:157], v[156:157], s[68:69], v[6:7] op_sel_hi:[1,0,0] neg_lo:[0,0,1] neg_hi:[0,0,1]
    v_pk_fma_f32 v[148:149], v[148:149], s[68:69], v[8:9] op_sel_hi:[1,0,0] neg_lo:[0,0,1] neg_hi:[0,0,1]
    v_pk_fma_f32 v[150:151], v[150:151], s[68:69], v[8:9] op_sel_hi:[1,0,0] neg_lo:[0,0,1] neg_hi:[0,0,1]
    v_pk_fma_f32 v[152:153], v[152:153], s[68:69], v[8:9] op_sel_hi:[1,0,0] neg_lo:[0,0,1] neg_hi:[0,0,1]
    v_pk_fma_f32 v[154:155], v[154:155], s[68:69], v[8:9] op_sel_hi:[1,0,0] neg_lo:[0,0,1] neg_hi:[0,0,1]
    v_pk_fma_f32 v[160:161], v[160:161], s[68:69], v[8:9] op_sel_hi:[1,0,0] neg_lo:[0,0,1] neg_hi:[0,0,1]
    v_exp_f32 v144, v144
    v_exp_f32 v145, v145
    v_exp_f32 v146, v146
    v_exp_f32 v147, v147
    v_exp_f32 v156, v156
    v_exp_f32 v157, v157
    v_exp_f32 v148, v148
    v_exp_f32 v149, v149
    v_exp_f32 v150, v150
    v_exp_f32 v151, v151
    v_exp_f32 v152, v152
    v_exp_f32 v153, v153
    v_exp_f32 v154, v154
    v_exp_f32 v155, v155
    v_exp_f32 v160, v160
    v_exp_f32 v161, v161
    v_cvt_pk_bf16_f32 v164, v144, v145
    v_cvt_pk_bf16_f32 v165, v146, v147
    v_cvt_pk_bf16_f32 v172, v156, v157
    v_cvt_pk_bf16_f32 v175, v156, v157
    v_cvt_pk_bf16_f32 v168, v148, v149
    v_cvt_pk_bf16_f32 v169, v150, v151
    v_cvt_pk_bf16_f32 v170, v152, v153
    v_cvt_pk_bf16_f32 v171, v154, v155
    v_cvt_pk_bf16_f32 v176, v160, v161
    v_cvt_pk_bf16_f32 v179, v160, v161
    v_mfma_f32_16x16x32_bf16 v[184:187], v[80:83], v[164:167], 0
    v_mfma_f32_16x16x32_bf16 v[216:219], v[80:83], v[168:171], 0
    v_pk_add_f32 v[144:145], v[144:145], v[146:147]
    v_mfma_f32_16x16x32_bf16 v[188:191], v[84:87], v[164:167], 0
    v_mfma_f32_16x16x32_bf16 v[220:223], v[84:87], v[168:171], 0
    v_pk_add_f32 v[148:149], v[148:149], v[150:151]
    v_mfma_f32_16x16x32_bf16 v[192:195], v[88:91], v[164:167], 0
    v_mfma_f32_16x16x32_bf16 v[224:227], v[88:91], v[168:171], 0
    v_pk_add_f32 v[152:153], v[152:153], v[154:155]
    v_mfma_f32_16x16x32_bf16 v[196:199], v[92:95], v[164:167], 0
    v_mfma_f32_16x16x32_bf16 v[228:231], v[92:95], v[168:171], 0
    v_pk_add_f32 v[144:145], v[144:145], v[156:157]
    v_mfma_f32_16x16x32_bf16 v[200:203], v[96:99], v[164:167], 0
    v_mfma_f32_16x16x32_bf16 v[232:235], v[96:99], v[168:171], 0
    v_pk_add_f32 v[148:149], v[148:149], v[160:161]
    v_mfma_f32_16x16x32_bf16 v[204:207], v[100:103], v[164:167], 0
    v_mfma_f32_16x16x32_bf16 v[236:239], v[100:103], v[168:171], 0
    v_add_f32 v6, v144, v145
    v_mfma_f32_16x16x32_bf16 v[208:211], v[104:107], v[164:167], 0
    v_mfma_f32_16x16x32_bf16 v[240:243], v[104:107], v[168:171], 0
    v_pk_add_f32 v[148:149], v[148:149], v[152:153]
    v_mfma_f32_16x16x32_bf16 v[212:215], v[108:111], v[164:167], 0
    v_mfma_f32_16x16x32_bf16 v[244:247], v[108:111], v[168:171], 0
    v_add_f32 v8, v148, v149
    v_mov_b32 v7, v6
    v_mov_b32 v9, v8
    s_nop 0
    v_permlane16_swap_b32 v6, v7
    v_permlane16_swap_b32 v8, v9
    v_add_f32 v6, v6, v7
    v_add_f32 v8, v8, v9
    v_mov_b32 v7, v6
    v_mov_b32 v9, v8
    s_nop 0
    v_permlane32_swap_b32 v6, v7
    v_permlane32_swap_b32 v8, v9
    v_add_f32 v6, v6, v7
    v_add_f32 v8, v8, v9
    v_rcp_f32 v6, v6
    v_rcp_f32 v8, v8
    v_mfma_f32_16x16x16_bf16 v[184:187], v[112:113], v[172:173], v[184:187]
    v_mfma_f32_16x16x16_bf16 v[216:219], v[112:113], v[176:177], v[216:219]
    v_mfma_f32_16x16x16_bf16 v[188:191], v[112:113], v[174:175], v[188:191]
    v_mfma_f32_16x16x16_bf16 v[220:223], v[112:113], v[178:179], v[220:223]
    v_mfma_f32_16x16x16_bf16 v[192:195], v[116:117], v[172:173], v[192:195]
    v_mfma_f32_16x16x16_bf16 v[224:227], v[116:117], v[176:177], v[224:227]
    v_mfma_f32_16x16x16_bf16 v[196:199], v[116:117], v[174:175], v[196:199]
    v_mfma_f32_16x16x16_bf16 v[228:231], v[116:117], v[178:179], v[228:231]
    v_mfma_f32_16x16x16_bf16 v[200:203], v[120:121], v[172:173], v[200:203]
    v_mfma_f32_16x16x16_bf16 v[232:235], v[120:121], v[176:177], v[232:235]
    v_mfma_f32_16x16x16_bf16 v[204:207], v[120:121], v[174:175], v[204:207]
    v_mfma_f32_16x16x16_bf16 v[236:239], v[120:121], v[178:179], v[236:239]
    v_mfma_f32_16x16x16_bf16 v[208:211], v[124:125], v[172:173], v[208:211]
    v_mfma_f32_16x16x16_bf16 v[240:243], v[124:125], v[176:177], v[240:243]
    v_mfma_f32_16x16x16_bf16 v[212:215], v[124:125], v[174:175], v[212:215]
    v_mfma_f32_16x16x16_bf16 v[244:247], v[124:125], v[178:179], v[244:247]
    s_add_u32 s57, s56, 4096
    v_pk_mul_f32 v[184:185], v[184:185], v[6:7] op_sel_hi:[1,0]
    v_pk_mul_f32 v[186:187], v[186:187], v[6:7] op_sel_hi:[1,0]
    v_pk_mul_f32 v[188:189], v[188:189], v[6:7] op_sel_hi:[1,0]
    v_pk_mul_f32 v[190:191], v[190:191], v[6:7] op_sel_hi:[1,0]
    v_cvt_pk_bf16_f32 v248, v184, v185
    v_cvt_pk_bf16_f32 v249, v186, v187
    v_cvt_pk_bf16_f32 v250, v188, v189
    v_cvt_pk_bf16_f32 v251, v190, v191
    v_min_u32 v248, -2, v248
    buffer_store_dwordx4 v[248:251], v4, s[32:35], s56 offen offset:0 sc1
    v_pk_mul_f32 v[216:217], v[216:217], v[8:9] op_sel_hi:[1,0]
    v_pk_mul_f32 v[218:219], v[218:219], v[8:9] op_sel_hi:[1,0]
    v_pk_mul_f32 v[220:221], v[220:221], v[8:9] op_sel_hi:[1,0]
    v_pk_mul_f32 v[222:223], v[222:223], v[8:9] op_sel_hi:[1,0]
    v_cvt_pk_bf16_f32 v252, v216, v217
    v_cvt_pk_bf16_f32 v253, v218, v219
    v_cvt_pk_bf16_f32 v254, v220, v221
    v_cvt_pk_bf16_f32 v255, v222, v223
    v_min_u32 v252, -2, v252
    buffer_store_dwordx4 v[252:255], v4, s[32:35], s56 offen offset:256 sc1
    v_pk_mul_f32 v[192:193], v[192:193], v[6:7] op_sel_hi:[1,0]
    v_pk_mul_f32 v[194:195], v[194:195], v[6:7] op_sel_hi:[1,0]
    v_pk_mul_f32 v[196:197], v[196:197], v[6:7] op_sel_hi:[1,0]
    v_pk_mul_f32 v[198:199], v[198:199], v[6:7] op_sel_hi:[1,0]
    v_cvt_pk_bf16_f32 v248, v192, v193
    v_cvt_pk_bf16_f32 v249, v194, v195
    v_cvt_pk_bf16_f32 v250, v196, v197
    v_cvt_pk_bf16_f32 v251, v198, v199
    v_min_u32 v248, -2, v248
    buffer_store_dwordx4 v[248:251], v4, s[32:35], s56 offen offset:2048 sc1
    v_pk_mul_f32 v[224:225], v[224:225], v[8:9] op_sel_hi:[1,0]
    v_pk_mul_f32 v[226:227], v[226:227], v[8:9] op_sel_hi:[1,0]
    v_pk_mul_f32 v[228:229], v[228:229], v[8:9] op_sel_hi:[1,0]
    v_pk_mul_f32 v[230:231], v[230:231], v[8:9] op_sel_hi:[1,0]
    v_cvt_pk_bf16_f32 v252, v224, v225
    v_cvt_pk_bf16_f32 v253, v226, v227
    v_cvt_pk_bf16_f32 v254, v228, v229
    v_cvt_pk_bf16_f32 v255, v230, v231
    v_min_u32 v252, -2, v252
    buffer_store_dwordx4 v[252:255], v4, s[32:35], s56 offen offset:2304 sc1
    v_pk_mul_f32 v[200:201], v[200:201], v[6:7] op_sel_hi:[1,0]
    v_pk_mul_f32 v[202:203], v[202:203], v[6:7] op_sel_hi:[1,0]
    v_pk_mul_f32 v[204:205], v[204:205], v[6:7] op_sel_hi:[1,0]
    v_pk_mul_f32 v[206:207], v[206:207], v[6:7] op_sel_hi:[1,0]
    v_cvt_pk_bf16_f32 v248, v200, v201
    v_cvt_pk_bf16_f32 v249, v202, v203
    v_cvt_pk_bf16_f32 v250, v204, v205
    v_cvt_pk_bf16_f32 v251, v206, v207
    v_min_u32 v248, -2, v248
    buffer_store_dwordx4 v[248:251], v4, s[32:35], s57 offen offset:0 sc1
    v_pk_mul_f32 v[232:233], v[232:233], v[8:9] op_sel_hi:[1,0]
    v_pk_mul_f32 v[234:235], v[234:235], v[8:9] op_sel_hi:[1,0]
    v_pk_mul_f32 v[236:237], v[236:237], v[8:9] op_sel_hi:[1,0]
    v_pk_mul_f32 v[238:239], v[238:239], v[8:9] op_sel_hi:[1,0]
    v_cvt_pk_bf16_f32 v252, v232, v233
    v_cvt_pk_bf16_f32 v253, v234, v235
    v_cvt_pk_bf16_f32 v254, v236, v237
    v_cvt_pk_bf16_f32 v255, v238, v239
    v_min_u32 v252, -2, v252
    buffer_store_dwordx4 v[252:255], v4, s[32:35], s57 offen offset:256 sc1
    v_pk_mul_f32 v[208:209], v[208:209], v[6:7] op_sel_hi:[1,0]
    v_pk_mul_f32 v[210:211], v[210:211], v[6:7] op_sel_hi:[1,0]
    v_pk_mul_f32 v[212:213], v[212:213], v[6:7] op_sel_hi:[1,0]
    v_pk_mul_f32 v[214:215], v[214:215], v[6:7] op_sel_hi:[1,0]
    v_cvt_pk_bf16_f32 v248, v208, v209
    v_cvt_pk_bf16_f32 v249, v210, v211
    v_cvt_pk_bf16_f32 v250, v212, v213
    v_cvt_pk_bf16_f32 v251, v214, v215
    v_min_u32 v248, -2, v248
    buffer_store_dwordx4 v[248:251], v4, s[32:35], s57 offen offset:2048 sc1
    v_pk_mul_f32 v[240:241], v[240:241], v[8:9] op_sel_hi:[1,0]
    v_pk_mul_f32 v[242:243], v[242:243], v[8:9] op_sel_hi:[1,0]
    v_pk_mul_f32 v[244:245], v[244:245], v[8:9] op_sel_hi:[1,0]
    v_pk_mul_f32 v[246:247], v[246:247], v[8:9] op_sel_hi:[1,0]
    v_cvt_pk_bf16_f32 v252, v240, v241
    v_cvt_pk_bf16_f32 v253, v242, v243
    v_cvt_pk_bf16_f32 v254, v244, v245
    v_cvt_pk_bf16_f32 v255, v246, v247
    v_min_u32 v252, -2, v252
    buffer_store_dwordx4 v[252:255], v4, s[32:35], s57 offen offset:2304 sc1
    s_lshl_b32 s57, s52, 5
    s_lshl_b32 s58, s53, 2
    s_add_u32 s57, s57, s58
    s_add_u32 s57, s57, s51
    s_lshl_b32 s57, s57, 7
    s_add_u32 s57, s57, 95944704
    v_mov_b32 v10, 1
    v_mov_b32 v11, 0
    s_mov_b64 exec, 1
    s_waitcnt vmcnt(0)
    buffer_store_dword v10, v11, s[32:35], s57 offen sc1
    s_mov_b64 exec, -1
    s_add_u32 s52, s52, 8
    s_cmp_lt_u32 s52, 64
    s_cbranch_scc1 L_att_loop
    s_waitcnt vmcnt(0)
    s_endpgm
L_att_tag:
    s_sub_u32 s59, s52, 1
L_poll5:
    buffer_load_dword v10, v1, s[32:35], 0 offen sc1
    s_waitcnt vmcnt(0)
    v_cmp_gt_u32 vcc, s59, v10
    s_nop 0
    s_cbranch_vccz L_polld5
    s_sleep 8
    s_sub_u32 s99, s99, 1
    s_cbranch_scc0 L_poll5
    s_endpgm
L_polld5:
L_att_tagl:
    buffer_load_dwordx4 v[112:115], v2, s[32:35], s55 offen offset:0 sc1
    buffer_load_dwordx4 v[116:119], v2, s[32:35], s55 offen offset:1024 sc1
    buffer_load_dwordx4 v[120:123], v2, s[32:35], s55 offen offset:2048 sc1
    buffer_load_dwordx4 v[124:127], v2, s[32:35], s55 offen offset:3072 sc1
    s_waitcnt vmcnt(0)
    v_max3_u32 v10, v112, v116, v120
    v_max_u32 v10, v10, v124
    v_cmp_eq_u32 vcc, -1, v10
    s_nop 0
    s_cbranch_vccz L_att_go
    s_sub_u32 s99, s99, 1
    s_cbranch_scc0 L_att_tagl
    s_endpgm
L_fin:
    s_and_b32 s52, s101, 255
    s_bfe_u32 s53, s101, 0x70009
    s_bfe_u32 s62, s101, 0x10008
    v_and_b32 v10, 63, v0
    v_lshlrev_b32 v7, 4, v10
    v_lshrrev_b32 v11, 2, v10
    v_mul_u32_u24 v11, 1280, v11
    v_and_b32 v12, 3, v10
    v_lshl_add_u32 v4, v12, 4, v11
    s_lshl_b32 s55, s51, 15
    v_lshrrev_b32 v13, 4, v10
    v_bfe_u32 v11, v10, 2, 2
    v_lshl_add_u32 v11, v13, 2, v11
    v_lshlrev_b32 v11, 6, v11
    v_lshl_add_u32 v11, v12, 3, v11
    v_add_u32 v3, s55, v11
    v_and_b32 v14, 15, v10
    s_lshl_b32 s57, s62, 4
    v_add_u32 v14, s57, v14
    v_lshlrev_b32 v11, 9, v13
    v_lshl_add_u32 v2, v14, 4, v11
    v_mul_u32_u24 v11, 1280, v14
    v_lshl_add_u32 v11, v13, 3, v11
    s_lshl_b32 s54, s52, 6
    s_and_b32 s57, s51, 1
    s_lshl_b32 s58, s57, 5
    s_add_u32 s58, s58, s54
    v_add_u32 v5, s58, v11
    s_lshl_b32 s57, s51, 11
    v_add_u32 v6, s57, v7
    s_mov_b32 s56, 0
    s_mov_b32 s36, s24
    s_mov_b32 s37, s25
    s_mov_b32 s38, 2211840
    s_mov_b32 s39, 0x20000
    s_mul_i32 s58, s51, 573440
    s_add_u32 s58, s58, s54
    s_add_u32 m0, s55, 0
    s_nop 0
    buffer_load_dwordx4 v4, s[36:39], s58 offen lds
    s_add_u32 s58, s58, 20480
    s_add_u32 m0, s55, 1024
    s_nop 0
    buffer_load_dwordx4 v4, s[36:39], s58 offen lds
    s_add_u32 s58, s58, 20480
    s_add_u32 m0, s55, 2048
    s_nop 0
    buffer_load_dwordx4 v4, s[36:39], s58 offen lds
    s_add_u32 s58, s58, 20480
    s_add_u32 m0, s55, 3072
    s_nop 0
    buffer_load_dwordx4 v4, s[36:39], s58 offen lds
    s_add_u32 s58, s58, 20480
    s_add_u32 m0, s55, 4096
    s_nop 0
    buffer_load_dwordx4 v4, s[36:39], s58 offen lds
    s_add_u32 s58, s58, 20480
    s_add_u32 m0, s55, 5120
    s_nop 0
    buffer_load_dwordx4 v4, s[36:39], s58 offen lds
    s_add_u32 s58, s58, 20480
    s_add_u32 m0, s55, 6144
    s_nop 0
    buffer_load_dwordx4 v4, s[36:39], s58 offen lds
    s_add_u32 s58, s58, 20480
    s_add_u32 m0, s55, 7168
    s_nop 0
    buffer_load_dwordx4 v4, s[36:39], s58 offen lds
    s_add_u32 s58, s58, 20480
    s_add_u32 m0, s55, 8192
    s_nop 0
    buffer_load_dwordx4 v4, s[36:39], s58 offen lds
    s_add_u32 s58, s58, 20480
    s_add_u32 m0, s55, 9216
    s_nop 0
    buffer_load_dwordx4 v4, s[36:39], s58 offen lds
    s_add_u32 s58, s58, 20480
    s_add_u32 m0, s55, 10240
    s_nop 0
    buffer_load_dwordx4 v4, s[36:39], s58 offen lds
    s_add_u32 s58, s58, 20480
    s_add_u32 m0, s55, 11264
    s_nop 0
    buffer_load_dwordx4 v4, s[36:39], s58 offen lds
    s_add_u32 s58, s58, 20480
    s_add_u32 m0, s55, 12288
    s_nop 0
    buffer_load_dwordx4 v4, s[36:39], s58 offen lds
    s_add_u32 s58, s58, 20480
    s_add_u32 m0, s55, 13312
    s_nop 0
    buffer_load_dwordx4 v4, s[36:39], s58 offen lds
    s_add_u32 s58, s58, 20480
    s_add_u32 m0, s55, 14336
    s_nop 0
    buffer_load_dwordx4 v4, s[36:39], s58 offen lds
    s_add_u32 s58, s58, 20480
    s_add_u32 m0, s55, 15360
    s_nop 0
    buffer_load_dwordx4 v4, s[36:39], s58 offen lds
    s_add_u32 s58, s58, 20480
    s_add_u32 m0, s55, 16384
    s_nop 0
    buffer_load_dwordx4 v4, s[36:39], s58 offen lds
    s_add_u32 s58, s58, 20480
    s_add_u32 m0, s55, 17408
    s_nop 0
    buffer_load_dwordx4 v4, s[36:39], s58 offen lds
    s_add_u32 s58, s58, 20480
    s_add_u32 m0, s55, 18432
    s_nop 0
    buffer_load_dwordx4 v4, s[36:39], s58 offen lds
    s_add_u32 s58, s58, 20480
    s_add_u32 m0, s55, 19456
    s_nop 0
    buffer_load_dwordx4 v4, s[36:39], s58 offen lds
    s_add_u32 s58, s58, 20480
    s_add_u32 m0, s55, 20480
    s_nop 0
    buffer_load_dwordx4 v4, s[36:39], s58 offen lds
    s_add_u32 s58, s58, 20480
    s_add_u32 m0, s55, 21504
    s_nop 0
    buffer_load_dwordx4 v4, s[36:39], s58 offen lds
    s_add_u32 s58, s58, 20480
    s_add_u32 m0, s55, 22528
    s_nop 0
    buffer_load_dwordx4 v4, s[36:39], s58 offen lds
    s_add_u32 s58, s58, 20480
    s_add_u32 m0, s55, 23552
    s_nop 0
    buffer_load_dwordx4 v4, s[36:39], s58 offen lds
    s_add_u32 s58, s58, 20480
    s_add_u32 m0, s55, 24576
    s_nop 0
    buffer_load_dwordx4 v4, s[36:39], s58 offen lds
    s_add_u32 s58, s58, 20480
    s_add_u32 m0, s55, 25600
    s_nop 0
    buffer_load_dwordx4 v4, s[36:39], s58 offen lds
    s_add_u32 s58, s58, 20480
    s_add_u32 m0, s55, 26624
    s_nop 0
    buffer_load_dwordx4 v4, s[36:39], s58 offen lds
    s_add_u32 s58, s58, 20480
    s_add_u32 m0, s55, 27648
    s_nop 0
    buffer_load_dwordx4 v4, s[36:39], s58 offen lds
    s_add_u32 s58, s58, 20480
    s_mov_b32 s36, s14
    s_mov_b32 s37, s15
    s_mov_b32 s38, 5242880
    s_mov_b32 s39, 0x20000
    s_mul_i32 s58, s51, 1310720
    s_add_u32 s58, s58, s54
    s_add_u32 m0, s55, 28672
    s_nop 0
    buffer_load_dwordx4 v4, s[36:39], s58 offen lds
    s_add_u32 s58, s58, 20480
    s_add_u32 m0, s55, 29696
    s_nop 0
    buffer_load_dwordx4 v4, s[36:39], s58 offen lds
    s_add_u32 s58, s58, 20480
    s_add_u32 m0, s55, 30720
    s_nop 0
    buffer_load_dwordx4 v4, s[36:39], s58 offen lds
    s_add_u32 s58, s58, 20480
    s_add_u32 m0, s55, 31744
    s_nop 0
    buffer_load_dwordx4 v4, s[36:39], s58 offen lds
    s_add_u32 s58, s58, 20480
    s_waitcnt vmcnt(28)
    ds_read_b64_tr_b16 v[144:145], v3 offset:0
    ds_read_b64_tr_b16 v[146:147], v3 offset:1024
    ds_read_b64_tr_b16 v[148:149], v3 offset:32
    ds_read_b64_tr_b16 v[150:151], v3 offset:1056
    ds_read_b64_tr_b16 v[152:153], v3 offset:2048
    ds_read_b64_tr_b16 v[154:155], v3 offset:3072
    ds_read_b64_tr_b16 v[156:157], v3 offset:2080
    ds_read_b64_tr_b16 v[158:159], v3 offset:3104
    s_waitcnt lgkmcnt(0)
    s_add_u32 m0, s55, 0
    s_nop 0
    buffer_load_dwordx4 v4, s[36:39], s58 offen lds
    s_add_u32 s58, s58, 20480
    s_add_u32 m0, s55, 1024
    s_nop 0
    buffer_load_dwordx4 v4, s[36:39], s58 offen lds
    s_add_u32 s58, s58, 20480
    s_add_u32 m0, s55, 2048
    s_nop 0
    buffer_load_dwordx4 v4, s[36:39], s58 offen lds
    s_add_u32 s58, s58, 20480
    s_add_u32 m0, s55, 3072
    s_nop 0
    buffer_load_dwordx4 v4, s[36:39], s58 offen lds
    s_add_u32 s58, s58, 20480
    s_waitcnt vmcnt(28)
    ds_read_b64_tr_b16 v[160:161], v3 offset:4096
    ds_read_b64_tr_b16 v[162:163], v3 offset:5120
    ds_read_b64_tr_b16 v[164:165], v3 offset:4128
    ds_read_b64_tr_b16 v[166:167], v3 offset:5152
    ds_read_b64_tr_b16 v[168:169], v3 offset:6144
    ds_read_b64_tr_b16 v[170:171], v3 offset:7168
    ds_read_b64_tr_b16 v[172:173], v3 offset:6176
    ds_read_b64_tr_b16 v[174:175], v3 offset:7200
    s_waitcnt lgkmcnt(0)
    s_add_u32 m0, s55, 4096
    s_nop 0
    buffer_load_dwordx4 v4, s[36:39], s58 offen lds
    s_add_u32 s58, s58, 20480
    s_add_u32 m0, s55, 5120
    s_nop 0
    buffer_load_dwordx4 v4, s[36:39], s58 offen lds
    s_add_u32 s58, s58, 20480
    s_add_u32 m0, s55, 6144
    s_nop 0
    buffer_load_dwordx4 v4, s[36:39], s58 offen lds
    s_add_u32 s58, s58, 20480
    s_add_u32 m0, s55, 7168
    s_nop 0
    buffer_load_dwordx4 v4, s[36:39], s58 offen lds
    s_add_u32 s58, s58, 20480
    s_waitcnt vmcnt(28)
    ds_read_b64_tr_b16 v[176:177], v3 offset:8192
    ds_read_b64_tr_b16 v[178:179], v3 offset:9216
    ds_read_b64_tr_b16 v[180:181], v3 offset:8224
    ds_read_b64_tr_b16 v[182:183], v3 offset:9248
    ds_read_b64_tr_b16 v[184:185], v3 offset:10240
    ds_read_b64_tr_b16 v[186:187], v3 offset:11264
    ds_read_b64_tr_b16 v[188:189], v3 offset:10272
    ds_read_b64_tr_b16 v[190:191], v3 offset:11296
    s_waitcnt lgkmcnt(0)
    s_add_u32 m0, s55, 8192
    s_nop 0
    buffer_load_dwordx4 v4, s[36:39], s58 offen lds
    s_add_u32 s58, s58, 20480
    s_add_u32 m0, s55, 9216
    s_nop 0
    buffer_load_dwordx4 v4, s[36:39], s58 offen lds
    s_add_u32 s58, s58, 20480
    s_add_u32 m0, s55, 10240
    s_nop 0
    buffer_load_dwordx4 v4, s[36:39], s58 offen lds
    s_add_u32 s58, s58, 20480
    s_add_u32 m0, s55, 11264
    s_nop 0
    buffer_load_dwordx4 v4, s[36:39], s58 offen lds
    s_add_u32 s58, s58, 20480
    s_waitcnt vmcnt(28)
    ds_read_b64_tr_b16 v[192:193], v3 offset:12288
    ds_read_b64_tr_b16 v[194:195], v3 offset:13312
    ds_read_b64_tr_b16 v[196:197], v3 offset:12320
    ds_read_b64_tr_b16 v[198:199], v3 offset:13344
    ds_read_b64_tr_b16 v[200:201], v3 offset:14336
    ds_read_b64_tr_b16 v[202:203], v3 offset:15360
    ds_read_b64_tr_b16 v[204:205], v3 offset:14368
    ds_read_b64_tr_b16 v[206:207], v3 offset:15392
    s_waitcnt lgkmcnt(0)
    s_add_u32 m0, s55, 12288
    s_nop 0
    buffer_load_dwordx4 v4, s[36:39], s58 offen lds
    s_add_u32 s58, s58, 20480
    s_add_u32 m0, s55, 13312
    s_nop 0
    buffer_load_dwordx4 v4, s[36:39], s58 offen lds
    s_add_u32 s58, s58, 20480
    s_add_u32 m0, s55, 14336
    s_nop 0
    buffer_load_dwordx4 v4, s[36:39], s58 offen lds
    s_add_u32 s58, s58, 20480
    s_add_u32 m0, s55, 15360
    s_nop 0
    buffer_load_dwordx4 v4, s[36:39], s58 offen lds
    s_add_u32 s58, s58, 20480
    s_waitcnt vmcnt(28)
    ds_read_b64_tr_b16 v[208:209], v3 offset:16384
    ds_read_b64_tr_b16 v[210:211], v3 offset:17408
    ds_read_b64_tr_b16 v[212:213], v3 offset:16416
    ds_read_b64_tr_b16 v[214:215], v3 offset:17440
    ds_read_b64_tr_b16 v[216:217], v3 offset:18432
    ds_read_b64_tr_b16 v[218:219], v3 offset:19456
    ds_read_b64_tr_b16 v[220:221], v3 offset:18464
    ds_read_b64_tr_b16 v[222:223], v3 offset:19488
    s_waitcnt lgkmcnt(0)
    s_add_u32 m0, s55, 16384
    s_nop 0
    buffer_load_dwordx4 v4, s[36:39], s58 offen lds
    s_add_u32 s58, s58, 20480
    s_add_u32 m0, s55, 17408
    s_nop 0
    buffer_load_dwordx4 v4, s[36:39], s58 offen lds
    s_add_u32 s58, s58, 20480
    s_add_u32 m0, s55, 18432
    s_nop 0
    buffer_load_dwordx4 v4, s[36:39], s58 offen lds
    s_add_u32 s58, s58, 20480
    s_add_u32 m0, s55, 19456
    s_nop 0
    buffer_load_dwordx4 v4, s[36:39], s58 offen lds
    s_add_u32 s58, s58, 20480
    s_waitcnt vmcnt(28)
    ds_read_b64_tr_b16 v[224:225], v3 offset:20480
    ds_read_b64_tr_b16 v[226:227], v3 offset:21504
    ds_read_b64_tr_b16 v[228:229], v3 offset:20512
    ds_read_b64_tr_b16 v[230:231], v3 offset:21536
    ds_read_b64_tr_b16 v[232:233], v3 offset:22528
    ds_read_b64_tr_b16 v[234:235], v3 offset:23552
    ds_read_b64_tr_b16 v[236:237], v3 offset:22560
    ds_read_b64_tr_b16 v[238:239], v3 offset:23584
    s_waitcnt lgkmcnt(0)
    s_add_u32 m0, s55, 20480
    s_nop 0
    buffer_load_dwordx4 v4, s[36:39], s58 offen lds
    s_add_u32 s58, s58, 20480
    s_add_u32 m0, s55, 21504
    s_nop 0
    buffer_load_dwordx4 v4, s[36:39], s58 offen lds
    s_add_u32 s58, s58, 20480
    s_add_u32 m0, s55, 22528
    s_nop 0
    buffer_load_dwordx4 v4, s[36:39], s58 offen lds
    s_add_u32 s58, s58, 20480
    s_add_u32 m0, s55, 23552
    s_nop 0
    buffer_load_dwordx4 v4, s[36:39], s58 offen lds
    s_add_u32 s58, s58, 20480
    s_waitcnt vmcnt(28)
    ds_read_b64_tr_b16 v[240:241], v3 offset:24576
    ds_read_b64_tr_b16 v[242:243], v3 offset:25600
    ds_read_b64_tr_b16 v[244:245], v3 offset:24608
    ds_read_b64_tr_b16 v[246:247], v3 offset:25632
    ds_read_b64_tr_b16 v[248:249], v3 offset:26624
    ds_read_b64_tr_b16 v[250:251], v3 offset:27648
    ds_read_b64_tr_b16 v[252:253], v3 offset:26656
    ds_read_b64_tr_b16 v[254:255], v3 offset:27680
    s_waitcnt lgkmcnt(0)
    s_add_u32 m0, s55, 24576
    s_nop 0
    buffer_load_dwordx4 v4, s[36:39], s58 offen lds
    s_add_u32 s58, s58, 20480
    s_add_u32 m0, s55, 25600
    s_nop 0
    buffer_load_dwordx4 v4, s[36:39], s58 offen lds
    s_add_u32 s58, s58, 20480
    s_add_u32 m0, s55, 26624
    s_nop 0
    buffer_load_dwordx4 v4, s[36:39], s58 offen lds
    s_add_u32 s58, s58, 20480
    s_add_u32 m0, s55, 27648
    s_nop 0
    buffer_load_dwordx4 v4, s[36:39], s58 offen lds
    s_add_u32 s58, s58, 20480
    s_waitcnt vmcnt(28)
    ds_read_b64_tr_b16 a[0:1], v3 offset:28672
    ds_read_b64_tr_b16 a[2:3], v3 offset:29696
    ds_read_b64_tr_b16 a[4:5], v3 offset:28704
    ds_read_b64_tr_b16 a[6:7], v3 offset:29728
    ds_read_b64_tr_b16 a[8:9], v3 offset:30720
    ds_read_b64_tr_b16 a[10:11], v3 offset:31744
    ds_read_b64_tr_b16 a[12:13], v3 offset:30752
    ds_read_b64_tr_b16 a[14:15], v3 offset:31776
    s_waitcnt lgkmcnt(0)
    s_add_u32 m0, s55, 28672
    s_nop 0
    buffer_load_dwordx4 v4, s[36:39], s58 offen lds
    s_add_u32 s58, s58, 20480
    s_add_u32 m0, s55, 29696
    s_nop 0
    buffer_load_dwordx4 v4, s[36:39], s58 offen lds
    s_add_u32 s58, s58, 20480
    s_add_u32 m0, s55, 30720
    s_nop 0
    buffer_load_dwordx4 v4, s[36:39], s58 offen lds
    s_add_u32 s58, s58, 20480
    s_add_u32 m0, s55, 31744
    s_nop 0
    buffer_load_dwordx4 v4, s[36:39], s58 offen lds
    s_add_u32 s58, s58, 20480
    s_waitcnt vmcnt(28)
    ds_read_b64_tr_b16 a[16:17], v3 offset:0
    ds_read_b64_tr_b16 a[18:19], v3 offset:1024
    ds_read_b64_tr_b16 a[20:21], v3 offset:32
    ds_read_b64_tr_b16 a[22:23], v3 offset:1056
    ds_read_b64_tr_b16 a[24:25], v3 offset:2048
    ds_read_b64_tr_b16 a[26:27], v3 offset:3072
    ds_read_b64_tr_b16 a[28:29], v3 offset:2080
    ds_read_b64_tr_b16 a[30:31], v3 offset:3104
    s_waitcnt lgkmcnt(0)
    s_add_u32 m0, s55, 0
    s_nop 0
    buffer_load_dwordx4 v4, s[36:39], s58 offen lds
    s_add_u32 s58, s58, 20480
    s_add_u32 m0, s55, 1024
    s_nop 0
    buffer_load_dwordx4 v4, s[36:39], s58 offen lds
    s_add_u32 s58, s58, 20480
    s_add_u32 m0, s55, 2048
    s_nop 0
    buffer_load_dwordx4 v4, s[36:39], s58 offen lds
    s_add_u32 s58, s58, 20480
    s_add_u32 m0, s55, 3072
    s_nop 0
    buffer_load_dwordx4 v4, s[36:39], s58 offen lds
    s_add_u32 s58, s58, 20480
    s_waitcnt vmcnt(28)
    ds_read_b64_tr_b16 a[32:33], v3 offset:4096
    ds_read_b64_tr_b16 a[34:35], v3 offset:5120
    ds_read_b64_tr_b16 a[36:37], v3 offset:4128
    ds_read_b64_tr_b16 a[38:39], v3 offset:5152
    ds_read_b64_tr_b16 a[40:41], v3 offset:6144
    ds_read_b64_tr_b16 a[42:43], v3 offset:7168
    ds_read_b64_tr_b16 a[44:45], v3 offset:6176
    ds_read_b64_tr_b16 a[46:47], v3 offset:7200
    s_waitcnt lgkmcnt(0)
    s_add_u32 m0, s55, 4096
    s_nop 0
    buffer_load_dwordx4 v4, s[36:39], s58 offen lds
    s_add_u32 s58, s58, 20480
    s_add_u32 m0, s55, 5120
    s_nop 0
    buffer_load_dwordx4 v4, s[36:39], s58 offen lds
    s_add_u32 s58, s58, 20480
    s_add_u32 m0, s55, 6144
    s_nop 0
    buffer_load_dwordx4 v4, s[36:39], s58 offen lds
    s_add_u32 s58, s58, 20480
    s_add_u32 m0, s55, 7168
    s_nop 0
    buffer_load_dwordx4 v4, s[36:39], s58 offen lds
    s_add_u32 s58, s58, 20480
    s_waitcnt vmcnt(28)
    ds_read_b64_tr_b16 a[48:49], v3 offset:8192
    ds_read_b64_tr_b16 a[50:51], v3 offset:9216
    ds_read_b64_tr_b16 a[52:53], v3 offset:8224
    ds_read_b64_tr_b16 a[54:55], v3 offset:9248
    ds_read_b64_tr_b16 a[56:57], v3 offset:10240
    ds_read_b64_tr_b16 a[58:59], v3 offset:11264
    ds_read_b64_tr_b16 a[60:61], v3 offset:10272
    ds_read_b64_tr_b16 a[62:63], v3 offset:11296
    s_waitcnt lgkmcnt(0)
    s_add_u32 m0, s55, 8192
    s_nop 0
    buffer_load_dwordx4 v4, s[36:39], s58 offen lds
    s_add_u32 s58, s58, 20480
    s_add_u32 m0, s55, 9216
    s_nop 0
    buffer_load_dwordx4 v4, s[36:39], s58 offen lds
    s_add_u32 s58, s58, 20480
    s_add_u32 m0, s55, 10240
    s_nop 0
    buffer_load_dwordx4 v4, s[36:39], s58 offen lds
    s_add_u32 s58, s58, 20480
    s_add_u32 m0, s55, 11264
    s_nop 0
    buffer_load_dwordx4 v4, s[36:39], s58 offen lds
    s_add_u32 s58, s58, 20480
    s_waitcnt vmcnt(28)
    ds_read_b64_tr_b16 a[64:65], v3 offset:12288
    ds_read_b64_tr_b16 a[66:67], v3 offset:13312
    ds_read_b64_tr_b16 a[68:69], v3 offset:12320
    ds_read_b64_tr_b16 a[70:71], v3 offset:13344
    ds_read_b64_tr_b16 a[72:73], v3 offset:14336
    ds_read_b64_tr_b16 a[74:75], v3 offset:15360
    ds_read_b64_tr_b16 a[76:77], v3 offset:14368
    ds_read_b64_tr_b16 a[78:79], v3 offset:15392
    s_waitcnt lgkmcnt(0)
    s_add_u32 m0, s55, 12288
    s_nop 0
    buffer_load_dwordx4 v4, s[36:39], s58 offen lds
    s_add_u32 s58, s58, 20480
    s_add_u32 m0, s55, 13312
    s_nop 0
    buffer_load_dwordx4 v4, s[36:39], s58 offen lds
    s_add_u32 s58, s58, 20480
    s_add_u32 m0, s55, 14336
    s_nop 0
    buffer_load_dwordx4 v4, s[36:39], s58 offen lds
    s_add_u32 s58, s58, 20480
    s_add_u32 m0, s55, 15360
    s_nop 0
    buffer_load_dwordx4 v4, s[36:39], s58 offen lds
    s_add_u32 s58, s58, 20480
    s_waitcnt vmcnt(28)
    ds_read_b64_tr_b16 a[80:81], v3 offset:16384
    ds_read_b64_tr_b16 a[82:83], v3 offset:17408
    ds_read_b64_tr_b16 a[84:85], v3 offset:16416
    ds_read_b64_tr_b16 a[86:87], v3 offset:17440
    ds_read_b64_tr_b16 a[88:89], v3 offset:18432
    ds_read_b64_tr_b16 a[90:91], v3 offset:19456
    ds_read_b64_tr_b16 a[92:93], v3 offset:18464
    ds_read_b64_tr_b16 a[94:95], v3 offset:19488
    s_waitcnt lgkmcnt(0)
    s_add_u32 m0, s55, 16384
    s_nop 0
    buffer_load_dwordx4 v4, s[36:39], s58 offen lds
    s_add_u32 s58, s58, 20480
    s_add_u32 m0, s55, 17408
    s_nop 0
    buffer_load_dwordx4 v4, s[36:39], s58 offen lds
    s_add_u32 s58, s58, 20480
    s_add_u32 m0, s55, 18432
    s_nop 0
    buffer_load_dwordx4 v4, s[36:39], s58 offen lds
    s_add_u32 s58, s58, 20480
    s_add_u32 m0, s55, 19456
    s_nop 0
    buffer_load_dwordx4 v4, s[36:39], s58 offen lds
    s_add_u32 s58, s58, 20480
    s_waitcnt vmcnt(28)
    ds_read_b64_tr_b16 a[96:97], v3 offset:20480
    ds_read_b64_tr_b16 a[98:99], v3 offset:21504
    ds_read_b64_tr_b16 a[100:101], v3 offset:20512
    ds_read_b64_tr_b16 a[102:103], v3 offset:21536
    ds_read_b64_tr_b16 a[104:105], v3 offset:22528
    ds_read_b64_tr_b16 a[106:107], v3 offset:23552
    ds_read_b64_tr_b16 a[108:109], v3 offset:22560
    ds_read_b64_tr_b16 a[110:111], v3 offset:23584
    s_waitcnt lgkmcnt(0)
    s_add_u32 m0, s55, 20480
    s_nop 0
    buffer_load_dwordx4 v4, s[36:39], s58 offen lds
    s_add_u32 s58, s58, 20480
    s_add_u32 m0, s55, 21504
    s_nop 0
    buffer_load_dwordx4 v4, s[36:39], s58 offen lds
    s_add_u32 s58, s58, 20480
    s_add_u32 m0, s55, 22528
    s_nop 0
    buffer_load_dwordx4 v4, s[36:39], s58 offen lds
    s_add_u32 s58, s58, 20480
    s_add_u32 m0, s55, 23552
    s_nop 0
    buffer_load_dwordx4 v4, s[36:39], s58 offen lds
    s_add_u32 s58, s58, 20480
    s_waitcnt vmcnt(28)
    ds_read_b64_tr_b16 a[112:113], v3 offset:24576
    ds_read_b64_tr_b16 a[114:115], v3 offset:25600
    ds_read_b64_tr_b16 a[116:117], v3 offset:24608
    ds_read_b64_tr_b16 a[118:119], v3 offset:25632
    ds_read_b64_tr_b16 a[120:121], v3 offset:26624
    ds_read_b64_tr_b16 a[122:123], v3 offset:27648
    ds_read_b64_tr_b16 a[124:125], v3 offset:26656
    ds_read_b64_tr_b16 a[126:127], v3 offset:27680
    s_waitcnt lgkmcnt(0)
    s_add_u32 m0, s55, 24576
    s_nop 0
    buffer_load_dwordx4 v4, s[36:39], s58 offen lds
    s_add_u32 s58, s58, 20480
    s_add_u32 m0, s55, 25600
    s_nop 0
    buffer_load_dwordx4 v4, s[36:39], s58 offen lds
    s_add_u32 s58, s58, 20480
    s_add_u32 m0, s55, 26624
    s_nop 0
    buffer_load_dwordx4 v4, s[36:39], s58 offen lds
    s_add_u32 s58, s58, 20480
    s_add_u32 m0, s55, 27648
    s_nop 0
    buffer_load_dwordx4 v4, s[36:39], s58 offen lds
    s_add_u32 s58, s58, 20480
    s_waitcnt vmcnt(28)
    ds_read_b64_tr_b16 a[128:129], v3 offset:28672
    ds_read_b64_tr_b16 a[130:131], v3 offset:29696
    ds_read_b64_tr_b16 a[132:133], v3 offset:28704
    ds_read_b64_tr_b16 a[134:135], v3 offset:29728
    ds_read_b64_tr_b16 a[136:137], v3 offset:30720
    ds_read_b64_tr_b16 a[138:139], v3 offset:31744
    ds_read_b64_tr_b16 a[140:141], v3 offset:30752
    ds_read_b64_tr_b16 a[142:143], v3 offset:31776
    s_waitcnt lgkmcnt(0)
    s_waitcnt vmcnt(24)
    ds_read_b64_tr_b16 a[144:145], v3 offset:0
    ds_read_b64_tr_b16 a[146:147], v3 offset:1024
    ds_read_b64_tr_b16 a[148:149], v3 offset:32
    ds_read_b64_tr_b16 a[150:151], v3 offset:1056
    ds_read_b64_tr_b16 a[152:153], v3 offset:2048
    ds_read_b64_tr_b16 a[154:155], v3 offset:3072
    ds_read_b64_tr_b16 a[156:157], v3 offset:2080
    ds_read_b64_tr_b16 a[158:159], v3 offset:3104
    s_waitcnt lgkmcnt(0)
    s_waitcnt vmcnt(20)
    ds_read_b64_tr_b16 a[160:161], v3 offset:4096
    ds_read_b64_tr_b16 a[162:163], v3 offset:5120
    ds_read_b64_tr_b16 a[164:165], v3 offset:4128
    ds_read_b64_tr_b16 a[166:167], v3 offset:5152
    ds_read_b64_tr_b16 a[168:169], v3 offset:6144
    ds_read_b64_tr_b16 a[170:171], v3 offset:7168
    ds_read_b64_tr_b16 a[172:173], v3 offset:6176
    ds_read_b64_tr_b16 a[174:175], v3 offset:7200
    s_waitcnt lgkmcnt(0)
    s_waitcnt vmcnt(16)
    ds_read_b64_tr_b16 a[176:177], v3 offset:8192
    ds_read_b64_tr_b16 a[178:179], v3 offset:9216
    ds_read_b64_tr_b16 a[180:181], v3 offset:8224
    ds_read_b64_tr_b16 a[182:183], v3 offset:9248
    ds_read_b64_tr_b16 a[184:185], v3 offset:10240
    ds_read_b64_tr_b16 a[186:187], v3 offset:11264
    ds_read_b64_tr_b16 a[188:189], v3 offset:10272
    ds_read_b64_tr_b16 a[190:191], v3 offset:11296
    s_waitcnt lgkmcnt(0)
    s_waitcnt vmcnt(12)
    ds_read_b64_tr_b16 a[192:193], v3 offset:12288
    ds_read_b64_tr_b16 a[194:195], v3 offset:13312
    ds_read_b64_tr_b16 a[196:197], v3 offset:12320
    ds_read_b64_tr_b16 a[198:199], v3 offset:13344
    ds_read_b64_tr_b16 a[200:201], v3 offset:14336
    ds_read_b64_tr_b16 a[202:203], v3 offset:15360
    ds_read_b64_tr_b16 a[204:205], v3 offset:14368
    ds_read_b64_tr_b16 a[206:207], v3 offset:15392
    s_waitcnt lgkmcnt(0)
    s_waitcnt vmcnt(8)
    ds_read_b64_tr_b16 a[208:209], v3 offset:16384
    ds_read_b64_tr_b16 a[210:211], v3 offset:17408
    ds_read_b64_tr_b16 a[212:213], v3 offset:16416
    ds_read_b64_tr_b16 a[214:215], v3 offset:17440
    ds_read_b64_tr_b16 a[216:217], v3 offset:18432
    ds_read_b64_tr_b16 a[218:219], v3 offset:19456
    ds_read_b64_tr_b16 a[220:221], v3 offset:18464
    ds_read_b64_tr_b16 a[222:223], v3 offset:19488
    s_waitcnt lgkmcnt(0)
    s_waitcnt vmcnt(4)
    ds_read_b64_tr_b16 a[224:225], v3 offset:20480
    ds_read_b64_tr_b16 a[226:227], v3 offset:21504
    ds_read_b64_tr_b16 a[228:229], v3 offset:20512
    ds_read_b64_tr_b16 a[230:231], v3 offset:21536
    ds_read_b64_tr_b16 a[232:233], v3 offset:22528
    ds_read_b64_tr_b16 a[234:235], v3 offset:23552
    ds_read_b64_tr_b16 a[236:237], v3 offset:22560
    ds_read_b64_tr_b16 a[238:239], v3 offset:23584
    s_waitcnt lgkmcnt(0)
    s_waitcnt vmcnt(0)
    ds_read_b64_tr_b16 a[240:241], v3 offset:24576
    ds_read_b64_tr_b16 a[242:243], v3 offset:25600
    ds_read_b64_tr_b16 a[244:245], v3 offset:24608
    ds_read_b64_tr_b16 a[246:247], v3 offset:25632
    ds_read_b64_tr_b16 a[248:249], v3 offset:26624
    ds_read_b64_tr_b16 a[250:251], v3 offset:27648
    ds_read_b64_tr_b16 a[252:253], v3 offset:26656
    ds_read_b64_tr_b16 a[254:255], v3 offset:27680
    s_waitcnt lgkmcnt(0)
    s_mov_b32 s36, s4
    s_mov_b32 s37, s5
    s_mov_b32 s38, 2621440
    s_mov_b32 s39, 0x20000
    s_mov_b32 s40, s26
    s_mov_b32 s41, s27
    s_mov_b32 s42, 2621440
    s_mov_b32 s43, 0x20000
    s_barrier
    s_mov_b32 s63, s53
    s_lshr_b32 s57, s63, 3
    s_cmp_lg_u32 s51, 0
    s_cbranch_scc1 L_polld6
    s_lshl_b32 s3, s57, 10
    s_add_u32 s3, s3, 95838208
    v_and_b32 v11, 7, v0
    v_lshlrev_b32 v11, 7, v11
L_poll6:
    buffer_load_dword v10, v11, s[32:35], s3 offen sc1
    s_waitcnt vmcnt(0)
    v_add_u32_dpp v10, v10, v10 row_shr:1 row_mask:0xf bank_mask:0xf bound_ctrl:0
    s_nop 1
    v_add_u32_dpp v10, v10, v10 row_shr:2 row_mask:0xf bank_mask:0xf bound_ctrl:0
    s_nop 1
    v_add_u32_dpp v10, v10, v10 row_shr:4 row_mask:0xf bank_mask:0xf bound_ctrl:0
    s_nop 0
    v_readlane_b32 s98, v10, 7
    s_nop 0
    s_cmp_ge_u32 s98, 118
    s_cbranch_scc1 L_polld6
    s_sleep 16
    s_sub_u32 s99, s99, 1
    s_cbranch_scc0 L_poll6
    s_endpgm
L_polld6:
    s_barrier
    s_mul_i32 s57, s63, 110592
    s_mul_i32 s58, s51, 28672
    s_add_u32 s57, s57, s58
    s_add_u32 s57, s57, 71303168
    s_mov_b32 s60, s57
    s_mul_i32 s58, s63, 40960
    buffer_load_dwordx2 v[124:125], v5, s[36:39], s58 offen
    buffer_load_dwordx4 v[16:19], v2, s[32:35], s57 offen offset:0 sc1
    buffer_load_dwordx4 v[20:23], v2, s[32:35], s57 offen offset:2048 sc1
    s_add_u32 s57, s57, 4096
    buffer_load_dwordx4 v[24:27], v2, s[32:35], s57 offen offset:0 sc1
    buffer_load_dwordx4 v[28:31], v2, s[32:35], s57 offen offset:2048 sc1
    s_add_u32 s57, s57, 4096
    buffer_load_dwordx4 v[32:35], v2, s[32:35], s57 offen offset:0 sc1
    buffer_load_dwordx4 v[36:39], v2, s[32:35], s57 offen offset:2048 sc1
    s_add_u32 s57, s57, 4096
    buffer_load_dwordx4 v[40:43], v2, s[32:35], s57 offen offset:0 sc1
    buffer_load_dwordx4 v[44:47], v2, s[32:35], s57 offen offset:2048 sc1
    s_add_u32 s57, s57, 4096
    buffer_load_dwordx4 v[48:51], v2, s[32:35], s57 offen offset:0 sc1
    buffer_load_dwordx4 v[52:55], v2, s[32:35], s57 offen offset:2048 sc1
    s_add_u32 s57, s57, 4096
    buffer_load_dwordx4 v[56:59], v2, s[32:35], s57 offen offset:0 sc1
    buffer_load_dwordx4 v[60:63], v2, s[32:35], s57 offen offset:2048 sc1
    s_add_u32 s57, s57, 4096
    s_cmp_eq_u32 s51, 3
    s_cselect_b32 s57, s60, s57
    buffer_load_dwordx4 v[64:67], v2, s[32:35], s57 offen offset:0 sc1
    buffer_load_dwordx4 v[68:71], v2, s[32:35], s57 offen offset:2048 sc1
    s_waitcnt vmcnt(13)
    v_mfma_f32_16x16x32_bf16 v[136:139], v[144:147], v[16:19], 0
    v_mfma_f32_16x16x32_bf16 v[140:143], v[148:151], v[16:19], 0
    s_waitcnt vmcnt(12)
    v_mfma_f32_16x16x32_bf16 v[136:139], v[152:155], v[20:23], v[136:139]
    v_mfma_f32_16x16x32_bf16 v[140:143], v[156:159], v[20:23], v[140:143]
    s_waitcnt vmcnt(11)
    v_mfma_f32_16x16x32_bf16 v[136:139], v[160:163], v[24:27], v[136:139]
    v_mfma_f32_16x16x32_bf16 v[140:143], v[164:167], v[24:27], v[140:143]
    s_waitcnt vmcnt(10)
    v_mfma_f32_16x16x32_bf16 v[136:139], v[168:171], v[28:31], v[136:139]
    v_mfma_f32_16x16x32_bf16 v[140:143], v[172:175], v[28:31], v[140:143]
    s_waitcnt vmcnt(9)
    v_mfma_f32_16x16x32_bf16 v[136:139], v[176:179], v[32:35], v[136:139]
    v_mfma_f32_16x16x32_bf16 v[140:143], v[180:183], v[32:35], v[140:143]
    s_waitcnt vmcnt(8)
    v_mfma_f32_16x16x32_bf16 v[136:139], v[184:187], v[36:39], v[136:139]
    v_mfma_f32_16x16x32_bf16 v[140:143], v[188:191], v[36:39], v[140:143]
    s_waitcnt vmcnt(7)
    v_mfma_f32_16x16x32_bf16 v[136:139], v[192:195], v[40:43], v[136:139]
    v_mfma_f32_16x16x32_bf16 v[140:143], v[196:199], v[40:43], v[140:143]
    s_waitcnt vmcnt(6)
    v_mfma_f32_16x16x32_bf16 v[136:139], v[200:203], v[44:47], v[136:139]
    v_mfma_f32_16x16x32_bf16 v[140:143], v[204:207], v[44:47], v[140:143]
    s_waitcnt vmcnt(5)
    v_mfma_f32_16x16x32_bf16 v[136:139], v[208:211], v[48:51], v[136:139]
    v_mfma_f32_16x16x32_bf16 v[140:143], v[212:215], v[48:51], v[140:143]
    s_waitcnt vmcnt(4)
    v_mfma_f32_16x16x32_bf16 v[136:139], v[216:219], v[52:55], v[136:139]
    v_mfma_f32_16x16x32_bf16 v[140:143], v[220:223], v[52:55], v[140:143]
    s_waitcnt vmcnt(3)
    v_mfma_f32_16x16x32_bf16 v[136:139], v[224:227], v[56:59], v[136:139]
    v_mfma_f32_16x16x32_bf16 v[140:143], v[228:231], v[56:59], v[140:143]
    s_waitcnt vmcnt(2)
    v_mfma_f32_16x16x32_bf16 v[136:139], v[232:235], v[60:63], v[136:139]
    v_mfma_f32_16x16x32_bf16 v[140:143], v[236:239], v[60:63], v[140:143]
    s_waitcnt vmcnt(1)
    v_mfma_f32_16x16x32_bf16 v[136:139], v[240:243], v[64:67], v[136:139]
    v_mfma_f32_16x16x32_bf16 v[140:143], v[244:247], v[64:67], v[140:143]
    s_waitcnt vmcnt(0)
    v_mfma_f32_16x16x32_bf16 v[136:139], v[248:251], v[68:71], v[136:139]
    v_mfma_f32_16x16x32_bf16 v[140:143], v[252:255], v[68:71], v[140:143]
L_fin_loop:
    s_nop 7
    v_mov_b64 v[128:129], v[136:137]
    v_mov_b64 v[130:131], v[138:139]
    v_mov_b64 v[132:133], v[140:141]
    v_mov_b64 v[134:135], v[142:143]
    s_mul_i32 s59, s53, 40960
    v_mov_b64 v[8:9], v[124:125]
    s_add_u32 s63, s53, 3
    s_cmp_ge_u32 s63, 64
    s_cbranch_scc1 L_fin_noh
    s_lshr_b32 s57, s63, 3
    s_cmp_lg_u32 s51, 0
    s_cbranch_scc1 L_polld7
    s_lshl_b32 s3, s57, 10
    s_add_u32 s3, s3, 95838208
    v_and_b32 v11, 7, v0
    v_lshlrev_b32 v11, 7, v11
L_poll7:
    buffer_load_dword v10, v11, s[32:35], s3 offen sc1
    s_waitcnt vmcnt(0)
    v_add_u32_dpp v10, v10, v10 row_shr:1 row_mask:0xf bank_mask:0xf bound_ctrl:0
    s_nop 1
    v_add_u32_dpp v10, v10, v10 row_shr:2 row_mask:0xf bank_mask:0xf bound_ctrl:0
    s_nop 1
    v_add_u32_dpp v10, v10, v10 row_shr:4 row_mask:0xf bank_mask:0xf bound_ctrl:0
    s_nop 0
    v_readlane_b32 s98, v10, 7
    s_nop 0
    s_cmp_ge_u32 s98, 118
    s_cbranch_scc1 L_polld7
    s_sleep 16
    s_sub_u32 s99, s99, 1
    s_cbranch_scc0 L_poll7
    s_endpgm
L_polld7:
    s_barrier
    s_mul_i32 s57, s63, 110592
    s_mul_i32 s58, s51, 28672
    s_add_u32 s57, s57, s58
    s_add_u32 s57, s57, 71303168
    s_mov_b32 s60, s57
    s_mul_i32 s58, s63, 40960
    buffer_load_dwordx2 v[124:125], v5, s[36:39], s58 offen
    buffer_load_dwordx4 v[16:19], v2, s[32:35], s57 offen offset:0 sc1
    buffer_load_dwordx4 v[20:23], v2, s[32:35], s57 offen offset:2048 sc1
    s_add_u32 s57, s57, 4096
    buffer_load_dwordx4 v[24:27], v2, s[32:35], s57 offen offset:0 sc1
    buffer_load_dwordx4 v[28:31], v2, s[32:35], s57 offen offset:2048 sc1
    s_add_u32 s57, s57, 4096
    buffer_load_dwordx4 v[32:35], v2, s[32:35], s57 offen offset:0 sc1
    buffer_load_dwordx4 v[36:39], v2, s[32:35], s57 offen offset:2048 sc1
    s_add_u32 s57, s57, 4096
    buffer_load_dwordx4 v[40:43], v2, s[32:35], s57 offen offset:0 sc1
    buffer_load_dwordx4 v[44:47], v2, s[32:35], s57 offen offset:2048 sc1
    s_add_u32 s57, s57, 4096
    buffer_load_dwordx4 v[48:51], v2, s[32:35], s57 offen offset:0 sc1
    buffer_load_dwordx4 v[52:55], v2, s[32:35], s57 offen offset:2048 sc1
    s_add_u32 s57, s57, 4096
    buffer_load_dwordx4 v[56:59], v2, s[32:35], s57 offen offset:0 sc1
    buffer_load_dwordx4 v[60:63], v2, s[32:35], s57 offen offset:2048 sc1
    s_add_u32 s57, s57, 4096
    s_cmp_eq_u32 s51, 3
    s_cselect_b32 s57, s60, s57
    buffer_load_dwordx4 v[64:67], v2, s[32:35], s57 offen offset:0 sc1
    buffer_load_dwordx4 v[68:71], v2, s[32:35], s57 offen offset:2048 sc1
    s_waitcnt vmcnt(13)
    v_mfma_f32_16x16x32_bf16 v[136:139], v[144:147], v[16:19], 0
    v_mfma_f32_16x16x32_bf16 v[140:143], v[148:151], v[16:19], 0
    s_waitcnt vmcnt(12)
    v_mfma_f32_16x16x32_bf16 v[136:139], v[152:155], v[20:23], v[136:139]
    v_mfma_f32_16x16x32_bf16 v[140:143], v[156:159], v[20:23], v[140:143]
    s_waitcnt vmcnt(11)
    v_mfma_f32_16x16x32_bf16 v[136:139], v[160:163], v[24:27], v[136:139]
    v_mfma_f32_16x16x32_bf16 v[140:143], v[164:167], v[24:27], v[140:143]
    s_waitcnt vmcnt(10)
    v_mfma_f32_16x16x32_bf16 v[136:139], v[168:171], v[28:31], v[136:139]
    v_mfma_f32_16x16x32_bf16 v[140:143], v[172:175], v[28:31], v[140:143]
    s_waitcnt vmcnt(9)
    v_mfma_f32_16x16x32_bf16 v[136:139], v[176:179], v[32:35], v[136:139]
    v_mfma_f32_16x16x32_bf16 v[140:143], v[180:183], v[32:35], v[140:143]
    s_waitcnt vmcnt(8)
    v_mfma_f32_16x16x32_bf16 v[136:139], v[184:187], v[36:39], v[136:139]
    v_mfma_f32_16x16x32_bf16 v[140:143], v[188:191], v[36:39], v[140:143]
    s_waitcnt vmcnt(7)
    v_mfma_f32_16x16x32_bf16 v[136:139], v[192:195], v[40:43], v[136:139]
    v_mfma_f32_16x16x32_bf16 v[140:143], v[196:199], v[40:43], v[140:143]
    s_waitcnt vmcnt(6)
    v_mfma_f32_16x16x32_bf16 v[136:139], v[200:203], v[44:47], v[136:139]
    v_mfma_f32_16x16x32_bf16 v[140:143], v[204:207], v[44:47], v[140:143]
    s_waitcnt vmcnt(5)
    v_mfma_f32_16x16x32_bf16 v[136:139], v[208:211], v[48:51], v[136:139]
    v_mfma_f32_16x16x32_bf16 v[140:143], v[212:215], v[48:51], v[140:143]
    s_waitcnt vmcnt(4)
    v_mfma_f32_16x16x32_bf16 v[136:139], v[216:219], v[52:55], v[136:139]
    v_mfma_f32_16x16x32_bf16 v[140:143], v[220:223], v[52:55], v[140:143]
    s_waitcnt vmcnt(3)
    v_mfma_f32_16x16x32_bf16 v[136:139], v[224:227], v[56:59], v[136:139]
    v_mfma_f32_16x16x32_bf16 v[140:143], v[228:231], v[56:59], v[140:143]
    s_waitcnt vmcnt(2)
    v_mfma_f32_16x16x32_bf16 v[136:139], v[232:235], v[60:63], v[136:139]
    v_mfma_f32_16x16x32_bf16 v[140:143], v[236:239], v[60:63], v[140:143]
    s_waitcnt vmcnt(1)
    v_mfma_f32_16x16x32_bf16 v[136:139], v[240:243], v[64:67], v[136:139]
    v_mfma_f32_16x16x32_bf16 v[140:143], v[244:247], v[64:67], v[140:143]
    s_waitcnt vmcnt(0)
    v_mfma_f32_16x16x32_bf16 v[136:139], v[248:251], v[68:71], v[136:139]
    v_mfma_f32_16x16x32_bf16 v[140:143], v[252:255], v[68:71], v[140:143]
L_fin_noh:
    s_cmp_ge_u32 s53, 61
    s_cbranch_scc1 L_fin_tag
    s_lshl_b32 s57, s53, 12
    s_lshl_b32 s58, s51, 10
    s_add_u32 s57, s57, s58
    s_add_u32 s57, s57, 95944704
    v_and_b32 v11, 7, v0
    v_lshlrev_b32 v11, 7, v11
L_poll8:
    buffer_load_dword v10, v11, s[32:35], s57 offen sc1
    s_waitcnt vmcnt(0)
    v_cmp_gt_u32 vcc, 1, v10
    s_nop 0
    s_cbranch_vccz L_polld8
    s_sleep 2
    s_sub_u32 s99, s99, 1
    s_cbranch_scc0 L_poll8
    s_endpgm
L_polld8:
L_fin_go:
    s_lshl_b32 s57, s53, 18
    s_lshl_b32 s58, s51, 16
    s_add_u32 s57, s57, s58
    s_add_u32 s57, s57, 54525952
    buffer_load_dwordx4 v[16:19], v2, s[32:35], s57 offen offset:0 sc1
    buffer_load_dwordx4 v[20:23], v2, s[32:35], s57 offen offset:2048 sc1
    s_add_u32 s57, s57, 4096
    buffer_load_dwordx4 v[24:27], v2, s[32:35], s57 offen offset:0 sc1
    buffer_load_dwordx4 v[28:31], v2, s[32:35], s57 offen offset:2048 sc1
    s_add_u32 s57, s57, 4096
    buffer_load_dwordx4 v[32:35], v2, s[32:35], s57 offen offset:0 sc1
    buffer_load_dwordx4 v[36:39], v2, s[32:35], s57 offen offset:2048 sc1
    s_add_u32 s57, s57, 4096
    buffer_load_dwordx4 v[40:43], v2, s[32:35], s57 offen offset:0 sc1
    buffer_load_dwordx4 v[44:47], v2, s[32:35], s57 offen offset:2048 sc1
    s_add_u32 s57, s57, 4096
    buffer_load_dwordx4 v[48:51], v2, s[32:35], s57 offen offset:0 sc1
    buffer_load_dwordx4 v[52:55], v2, s[32:35], s57 offen offset:2048 sc1
    s_add_u32 s57, s57, 4096
    buffer_load_dwordx4 v[56:59], v2, s[32:35], s57 offen offset:0 sc1
    buffer_load_dwordx4 v[60:63], v2, s[32:35], s57 offen offset:2048 sc1
    s_add_u32 s57, s57, 4096
    buffer_load_dwordx4 v[64:67], v2, s[32:35], s57 offen offset:0 sc1
    buffer_load_dwordx4 v[68:71], v2, s[32:35], s57 offen offset:2048 sc1
    s_add_u32 s57, s57, 4096
    buffer_load_dwordx4 v[72:75], v2, s[32:35], s57 offen offset:0 sc1
    buffer_load_dwordx4 v[76:79], v2, s[32:35], s57 offen offset:2048 sc1
    s_add_u32 s57, s57, 4096
    buffer_load_dwordx4 v[80:83], v2, s[32:35], s57 offen offset:0 sc1
    buffer_load_dwordx4 v[84:87], v2, s[32:35], s57 offen offset:2048 sc1
    s_add_u32 s57, s57, 4096
    buffer_load_dwordx4 v[88:91], v2, s[32:35], s57 offen offset:0 sc1
    buffer_load_dwordx4 v[92:95], v2, s[32:35], s57 offen offset:2048 sc1
    s_add_u32 s57, s57, 4096
    buffer_load_dwordx4 v[96:99], v2, s[32:35], s57 offen offset:0 sc1
    buffer_load_dwordx4 v[100:103], v2, s[32:35], s57 offen offset:2048 sc1
    s_add_u32 s57, s57, 4096
    buffer_load_dwordx4 v[104:107], v2, s[32:35], s57 offen offset:0 sc1
    buffer_load_dwordx4 v[108:111], v2, s[32:35], s57 offen offset:2048 sc1
    s_add_u32 s57, s57, 4096
    buffer_load_dwordx4 v[112:115], v2, s[32:35], s57 offen offset:0 sc1
    buffer_load_dwordx4 v[116:119], v2, s[32:35], s57 offen offset:2048 sc1
    s_add_u32 s57, s57, 4096
    buffer_load_dwordx4 v[120:123], v2, s[32:35], s57 offen offset:0 sc1
    s_waitcnt vmcnt(26)
    v_mfma_f32_16x16x32_bf16 v[128:131], a[0:3], v[16:19], v[128:131]
    v_mfma_f32_16x16x32_bf16 v[132:135], a[4:7], v[16:19], v[132:135]
    v_mov_b32 v1, v16
    buffer_load_dwordx4 v[16:19], v2, s[32:35], s57 offen offset:2048 sc1
    s_waitcnt vmcnt(26)
    v_mfma_f32_16x16x32_bf16 v[128:131], a[8:11], v[20:23], v[128:131]
    v_mfma_f32_16x16x32_bf16 v[132:135], a[12:15], v[20:23], v[132:135]
    v_max_u32 v1, v1, v20
    s_add_u32 s57, s57, 4096
    buffer_load_dwordx4 v[20:23], v2, s[32:35], s57 offen offset:0 sc1
    s_waitcnt vmcnt(26)
    v_mfma_f32_16x16x32_bf16 v[128:131], a[16:19], v[24:27], v[128:131]
    v_mfma_f32_16x16x32_bf16 v[132:135], a[20:23], v[24:27], v[132:135]
    v_max_u32 v1, v1, v24
    buffer_load_dwordx4 v[24:27], v2, s[32:35], s57 offen offset:2048 sc1
    s_waitcnt vmcnt(26)
    v_mfma_f32_16x16x32_bf16 v[128:131], a[24:27], v[28:31], v[128:131]
    v_mfma_f32_16x16x32_bf16 v[132:135], a[28:31], v[28:31], v[132:135]
    v_max_u32 v1, v1, v28
    s_add_u32 s57, s57, 4096
    buffer_load_dwordx4 v[28:31], v2, s[32:35], s57 offen offset:0 sc1
    s_waitcnt vmcnt(26)
    v_mfma_f32_16x16x32_bf16 v[128:131], a[32:35], v[32:35], v[128:131]
    v_mfma_f32_16x16x32_bf16 v[132:135], a[36:39], v[32:35], v[132:135]
    v_max_u32 v1, v1, v32
    buffer_load_dwordx4 v[32:35], v2, s[32:35], s57 offen offset:2048 sc1
    s_waitcnt vmcnt(26)
    v_mfma_f32_16x16x32_bf16 v[128:131], a[40:43], v[36:39], v[128:131]
    v_mfma_f32_16x16x32_bf16 v[132:135], a[44:47], v[36:39], v[132:135]
    v_max_u32 v1, v1, v36
    s_waitcnt vmcnt(25)
    v_mfma_f32_16x16x32_bf16 v[128:131], a[48:51], v[40:43], v[128:131]
    v_mfma_f32_16x16x32_bf16 v[132:135], a[52:55], v[40:43], v[132:135]
    v_max_u32 v1, v1, v40
    s_waitcnt vmcnt(24)
    v_mfma_f32_16x16x32_bf16 v[128:131], a[56:59], v[44:47], v[128:131]
    v_mfma_f32_16x16x32_bf16 v[132:135], a[60:63], v[44:47], v[132:135]
    v_max_u32 v1, v1, v44
    s_waitcnt vmcnt(23)
    v_mfma_f32_16x16x32_bf16 v[128:131], a[64:67], v[48:51], v[128:131]
    v_mfma_f32_16x16x32_bf16 v[132:135], a[68:71], v[48:51], v[132:135]
    v_max_u32 v1, v1, v48
    s_waitcnt vmcnt(22)
    v_mfma_f32_16x16x32_bf16 v[128:131], a[72:75], v[52:55], v[128:131]
    v_mfma_f32_16x16x32_bf16 v[132:135], a[76:79], v[52:55], v[132:135]
    v_max_u32 v1, v1, v52
    s_waitcnt vmcnt(21)
    v_mfma_f32_16x16x32_bf16 v[128:131], a[80:83], v[56:59], v[128:131]
    v_mfma_f32_16x16x32_bf16 v[132:135], a[84:87], v[56:59], v[132:135]
    v_max_u32 v1, v1, v56
    s_waitcnt vmcnt(20)
    v_mfma_f32_16x16x32_bf16 v[128:131], a[88:91], v[60:63], v[128:131]
    v_mfma_f32_16x16x32_bf16 v[132:135], a[92:95], v[60:63], v[132:135]
    v_max_u32 v1, v1, v60
    s_waitcnt vmcnt(19)
    v_mfma_f32_16x16x32_bf16 v[128:131], a[96:99], v[64:67], v[128:131]
    v_mfma_f32_16x16x32_bf16 v[132:135], a[100:103], v[64:67], v[132:135]
    v_max_u32 v1, v1, v64
    s_waitcnt vmcnt(18)
    v_mfma_f32_16x16x32_bf16 v[128:131], a[104:107], v[68:71], v[128:131]
    v_mfma_f32_16x16x32_bf16 v[132:135], a[108:111], v[68:71], v[132:135]
    v_max_u32 v1, v1, v68
    s_waitcnt vmcnt(17)
    v_mfma_f32_16x16x32_bf16 v[128:131], a[112:115], v[72:75], v[128:131]
    v_mfma_f32_16x16x32_bf16 v[132:135], a[116:119], v[72:75], v[132:135]
    v_max_u32 v1, v1, v72
    s_waitcnt vmcnt(16)
    v_mfma_f32_16x16x32_bf16 v[128:131], a[120:123], v[76:79], v[128:131]
    v_mfma_f32_16x16x32_bf16 v[132:135], a[124:127], v[76:79], v[132:135]
    v_max_u32 v1, v1, v76
    s_waitcnt vmcnt(15)
    v_mfma_f32_16x16x32_bf16 v[128:131], a[128:131], v[80:83], v[128:131]
    v_mfma_f32_16x16x32_bf16 v[132:135], a[132:135], v[80:83], v[132:135]
    v_max_u32 v1, v1, v80
    s_waitcnt vmcnt(14)
    v_mfma_f32_16x16x32_bf16 v[128:131], a[136:139], v[84:87], v[128:131]
    v_mfma_f32_16x16x32_bf16 v[132:135], a[140:143], v[84:87], v[132:135]
    v_max_u32 v1, v1, v84
    s_waitcnt vmcnt(13)
    v_mfma_f32_16x16x32_bf16 v[128:131], a[144:147], v[88:91], v[128:131]
    v_mfma_f32_16x16x32_bf16 v[132:135], a[148:151], v[88:91], v[132:135]
    v_max_u32 v1, v1, v88
    s_waitcnt vmcnt(12)
    v_mfma_f32_16x16x32_bf16 v[128:131], a[152:155], v[92:95], v[128:131]
    v_mfma_f32_16x16x32_bf16 v[132:135], a[156:159], v[92:95], v[132:135]
    v_max_u32 v1, v1, v92
    s_waitcnt vmcnt(11)
    v_mfma_f32_16x16x32_bf16 v[128:131], a[160:163], v[96:99], v[128:131]
    v_mfma_f32_16x16x32_bf16 v[132:135], a[164:167], v[96:99], v[132:135]
    v_max_u32 v1, v1, v96
    s_waitcnt vmcnt(10)
    v_mfma_f32_16x16x32_bf16 v[128:131], a[168:171], v[100:103], v[128:131]
    v_mfma_f32_16x16x32_bf16 v[132:135], a[172:175], v[100:103], v[132:135]
    v_max_u32 v1, v1, v100
    s_waitcnt vmcnt(9)
    v_mfma_f32_16x16x32_bf16 v[128:131], a[176:179], v[104:107], v[128:131]
    v_mfma_f32_16x16x32_bf16 v[132:135], a[180:183], v[104:107], v[132:135]
    v_max_u32 v1, v1, v104
    s_waitcnt vmcnt(8)
    v_mfma_f32_16x16x32_bf16 v[128:131], a[184:187], v[108:111], v[128:131]
    v_mfma_f32_16x16x32_bf16 v[132:135], a[188:191], v[108:111], v[132:135]
    v_max_u32 v1, v1, v108
    s_waitcnt vmcnt(7)
    v_mfma_f32_16x16x32_bf16 v[128:131], a[192:195], v[112:115], v[128:131]
    v_mfma_f32_16x16x32_bf16 v[132:135], a[196:199], v[112:115], v[132:135]
    v_max_u32 v1, v1, v112
    s_waitcnt vmcnt(6)
    v_mfma_f32_16x16x32_bf16 v[128:131], a[200:203], v[116:119], v[128:131]
    v_mfma_f32_16x16x32_bf16 v[132:135], a[204:207], v[116:119], v[132:135]
    v_max_u32 v1, v1, v116
    s_waitcnt vmcnt(5)
    v_mfma_f32_16x16x32_bf16 v[128:131], a[208:211], v[120:123], v[128:131]
    v_mfma_f32_16x16x32_bf16 v[132:135], a[212:215], v[120:123], v[132:135]
    v_max_u32 v1, v1, v120
    s_waitcnt vmcnt(4)
    v_mfma_f32_16x16x32_bf16 v[128:131], a[216:219], v[16:19], v[128:131]
    v_mfma_f32_16x16x32_bf16 v[132:135], a[220:223], v[16:19], v[132:135]
    v_max_u32 v1, v1, v16
    s_waitcnt vmcnt(3)
    v_mfma_f32_16x16x32_bf16 v[128:131], a[224:227], v[20:23], v[128:131]
    v_mfma_f32_16x16x32_bf16 v[132:135], a[228:231], v[20:23], v[132:135]
    v_max_u32 v1, v1, v20
    s_waitcnt vmcnt(2)
    v_mfma_f32_16x16x32_bf16 v[128:131], a[232:235], v[24:27], v[128:131]
    v_mfma_f32_16x16x32_bf16 v[132:135], a[236:239], v[24:27], v[132:135]
    v_max_u32 v1, v1, v24
    s_waitcnt vmcnt(1)
    v_mfma_f32_16x16x32_bf16 v[128:131], a[240:243], v[28:31], v[128:131]
    v_mfma_f32_16x16x32_bf16 v[132:135], a[244:247], v[28:31], v[132:135]
    v_max_u32 v1, v1, v28
    s_waitcnt vmcnt(0)
    v_mfma_f32_16x16x32_bf16 v[128:131], a[248:251], v[32:35], v[128:131]
    v_mfma_f32_16x16x32_bf16 v[132:135], a[252:255], v[32:35], v[132:135]
    v_max_u32 v1, v1, v32
    s_cmp_lt_u32 s53, 61
    s_cbranch_scc1 L_fin_ok
    v_cmp_eq_u32 vcc, -1, v1
    s_nop 0
    s_cbranch_vccnz L_fin_redo
L_fin_ok:
    v_add_u32 v11, s56, v6
    s_lshl_b32 s58, s51, 10
    s_add_u32 s58, s58, s56
    v_add_u32 v10, s58, v7
    s_xor_b32 s56, s56, 8192
    ds_write_b128 v11, v[128:131] offset:0
    ds_write_b128 v11, v[132:135] offset:1024
    s_waitcnt lgkmcnt(0)
    s_barrier
    s_cmp_ge_u32 s51, 2
    s_cbranch_scc1 L_fin_nost
    ds_read_b128 v[16:19], v10 offset:0
    ds_read_b128 v[20:23], v10 offset:2048
    ds_read_b128 v[24:27], v10 offset:4096
    ds_read_b128 v[28:31], v10 offset:6144
    s_mov_b32 s58, 0xffff0000
    v_lshlrev_b32 v12, 16, v8
    v_and_b32 v13, s58, v8
    v_lshlrev_b32 v14, 16, v9
    v_and_b32 v15, s58, v9
    s_waitcnt lgkmcnt(3)
    v_pk_add_f32 v[12:13], v[12:13], v[16:17]
    v_pk_add_f32 v[14:15], v[14:15], v[18:19]
    s_waitcnt lgkmcnt(2)
    v_pk_add_f32 v[12:13], v[12:13], v[20:21]
    v_pk_add_f32 v[14:15], v[14:15], v[22:23]
    s_waitcnt lgkmcnt(1)
    v_pk_add_f32 v[12:13], v[12:13], v[24:25]
    v_pk_add_f32 v[14:15], v[14:15], v[26:27]
    s_waitcnt lgkmcnt(0)
    v_pk_add_f32 v[12:13], v[12:13], v[28:29]
    v_pk_add_f32 v[14:15], v[14:15], v[30:31]
    v_cvt_pk_bf16_f32 v12, v12, v13
    v_cvt_pk_bf16_f32 v13, v14, v15
    buffer_store_dwordx2 v[12:13], v5, s[40:43], s59 offen
L_fin_nost:
    s_add_u32 s53, s53, 3
    s_cmp_lt_u32 s53, 64
    s_cbranch_scc1 L_fin_loop
L_exit:
    s_endpgm
L_fin_redo:
    s_sub_u32 s99, s99, 1
    s_cbranch_scc1 L_exit
    s_nop 7
    v_mov_b64 v[128:129], v[136:137]
    v_mov_b64 v[130:131], v[138:139]
    v_mov_b64 v[132:133], v[140:141]
    v_mov_b64 v[134:135], v[142:143]
    s_mul_i32 s59, s53, 40960
    v_mov_b64 v[8:9], v[124:125]
L_fin_tag:
    s_lshl_b32 s57, s51, 16
    s_lshl_b32 s58, s62, 8
    s_add_u32 s57, s57, s58
    s_lshl_b32 s58, s53, 18
    s_add_u32 s57, s57, s58
    s_add_u32 s57, s57, 54532096
    v_and_b32 v11, 7, v0
    v_lshlrev_b32 v11, 13, v11
L_fin_tagl:
    buffer_load_dword v10, v11, s[32:35], s57 offen sc1
    s_waitcnt vmcnt(0)
    v_cmp_eq_u32 vcc, -1, v10
    s_nop 0
    s_cbranch_vccz L_fin_go
    s_sleep 2
    s_sub_u32 s99, s99, 1
    s_cbranch_scc0 L_fin_tagl
    s_endpgm
L_probe:
    s_cmp_lg_u32 s51, 0
    s_cbranch_scc1 L_exit
    s_mov_b64 exec, 1
    v_mov_b32 v10, 92280832
    v_mov_b32 v11, 92289024
    v_mov_b32 v12, 0
    s_mov_b32 s54, -1
    s_mov_b32 s55, -1
    s_mov_b32 s56, 16
L_probe_loop:
    s_memtime s[58:59]
    s_waitcnt lgkmcnt(0)
    buffer_store_dword v12, v10, s[32:35], 0 offen sc1
    s_waitcnt vmcnt(0)
    s_memtime s[60:61]
    s_waitcnt lgkmcnt(0)
    s_sub_u32 s57, s60, s58
    s_min_u32 s54, s54, s57
    s_memtime s[58:59]
    s_waitcnt lgkmcnt(0)
    buffer_store_dword v12, v11, s[32:35], 0 offen sc1
    s_waitcnt vmcnt(0)
    s_memtime s[60:61]
    s_waitcnt lgkmcnt(0)
    s_sub_u32 s57, s60, s58
    s_min_u32 s55, s55, s57
    s_sub_u32 s56, s56, 1
    s_cmp_lg_u32 s56, 0
    s_cbranch_scc1 L_probe_loop
    s_cmp_lt_u32 s55, s54
    s_cselect_b32 s57, 2, 1
    v_mov_b32 v12, s57
    v_mov_b32 v10, 244
    global_store_dword v10, v12, s[28:29] sc1
    v_mov_b32 v12, s54
    v_mov_b32 v13, s55
    s_lshl_b32 s55, s55, 16
    s_or_b32 s54, s54, s55
    s_waitcnt vmcnt(0)
    s_endpgm
L_chain:
    s_lshr_b32 s3, s41, 3
    s_add_u32 s3, s3, 1
    s_lshr_b32 s70, s10, 8
    s_sub_u32 s3, s3, s70
    s_and_b32 s3, s3, 3
    s_and_b32 s41, s41, 7
    s_lshl_b32 s41, s41, 2
    s_or_b32 s41, s41, s3
    v_and_b32 v16, 63, v0
    v_lshlrev_b32 v26, 4, v0
    v_lshrrev_b32 v17, 6, v0
    v_lshlrev_b32 v8, 4, v16
    v_readfirstlane_b32 s42, v17
    s_mov_b32 s65, 2000000
    v_lshrrev_b32 v17, 4, v16
    v_bfe_u32 v18, v16, 1, 3
    v_xor_b32 v18, v18, v17
    v_lshlrev_b32 v18, 5, v18
    v_and_b32 v19, 1, v16
    v_lshl_add_u32 v18, v19, 4, v18
    v_and_b32 v19, 1, v17
    v_lshl_add_u32 v18, v19, 13, v18
    v_lshrrev_b32 v19, 1, v17
    v_lshl_add_u32 v68, v19, 17, v18
    v_lshl_add_u32 v70, v19, 16, v18
    v_xor_b32 v69, 128, v68
    v_xor_b32 v71, 128, v70
    s_lshl_b32 s70, s41, 8
    s_mul_i32 s71, s40, 2621440
    s_add_u32 s75, s70, s71
    s_xor_b32 s71, s40, 1
    s_mul_i32 s71, s71, 2621440
    s_add_u32 s76, s70, s71
    s_mul_i32 s77, s42, 34816
    s_add_u32 s77, s77, 24576
    s_lshr_b32 s82, s10, 8
    s_add_u32 s82, s82, s41
    s_and_b32 s82, s82, 3
    s_add_u32 s70, s42, 0
    s_mul_i32 s71, s70, 52
    s_lshr_b32 s71, s71, 8
    s_mul_i32 s72, s71, 5
    s_sub_u32 s70, s70, s72
    s_mul_i32 s71, s71, 80
    s_lshr_b32 s72, s70, 1
    s_lshl_b32 s72, s72, 5
    s_add_u32 s71, s71, s72
    s_and_b32 s72, s70, 1
    s_lshl_b32 s72, s72, 3
    s_add_u32 s71, s71, s72
    s_lshl_b32 s78, s71, 13
    s_add_u32 s70, s42, 4
    s_mul_i32 s71, s70, 52
    s_lshr_b32 s71, s71, 8
    s_mul_i32 s72, s71, 5
    s_sub_u32 s70, s70, s72
    s_mul_i32 s71, s71, 80
    s_lshr_b32 s72, s70, 1
    s_lshl_b32 s72, s72, 5
    s_add_u32 s71, s71, s72
    s_and_b32 s72, s70, 1
    s_lshl_b32 s72, s72, 3
    s_add_u32 s71, s71, s72
    s_lshl_b32 s83, s71, 13
    s_add_u32 s70, s42, 8
    s_mul_i32 s71, s70, 52
    s_lshr_b32 s71, s71, 8
    s_mul_i32 s72, s71, 5
    s_sub_u32 s70, s70, s72
    s_mul_i32 s71, s71, 80
    s_lshr_b32 s72, s70, 1
    s_lshl_b32 s72, s72, 5
    s_add_u32 s71, s71, s72
    s_and_b32 s72, s70, 1
    s_lshl_b32 s72, s72, 3
    s_add_u32 s71, s71, s72
    s_lshl_b32 s84, s71, 13
    s_add_u32 s70, s42, 12
    s_mul_i32 s71, s70, 52
    s_lshr_b32 s71, s71, 8
    s_mul_i32 s72, s71, 5
    s_sub_u32 s70, s70, s72
    s_mul_i32 s71, s71, 80
    s_lshr_b32 s72, s70, 1
    s_lshl_b32 s72, s72, 5
    s_add_u32 s71, s71, s72
    s_and_b32 s72, s70, 1
    s_lshl_b32 s72, s72, 3
    s_add_u32 s71, s71, s72
    s_lshl_b32 s85, s71, 13
    s_add_u32 s70, s42, 16
    s_mul_i32 s71, s70, 52
    s_lshr_b32 s71, s71, 8
    s_mul_i32 s72, s71, 5
    s_sub_u32 s70, s70, s72
    s_mul_i32 s71, s71, 80
    s_lshr_b32 s72, s70, 1
    s_lshl_b32 s72, s72, 5
    s_add_u32 s71, s71, s72
    s_and_b32 s72, s70, 1
    s_lshl_b32 s72, s72, 3
    s_add_u32 s71, s71, s72
    s_lshl_b32 s3, s71, 13
    s_lshl_b32 s71, s40, 5
    s_add_u32 s71, s71, s41
    s_lshl_b32 s68, s71, 7
    s_add_u32 s68, s68, 95817728
    s_cmp_lg_u32 s42, 3
    s_cbranch_scc1 L_ch_nofl
    s_mov_b64 exec, 1
    s_getreg_b32 s70, hwreg(HW_REG_XCC_ID)
    s_and_b32 s70, s70, 15
    v_mov_b32 v32, s70
    s_lshl_b32 s72, s71, 2
    s_add_u32 s72, s72, 95813632
    v_mov_b32 v33, 0
    buffer_store_dword v32, v33, s[32:35], s72 offen sc1
    buffer_store_dword v33, v33, s[32:35], s68 offen sc1
    s_lshl_b32 s72, s71, 12
    s_add_u32 s72, s72, 95944704
    s_mov_b64 exec, 0xffffffff
    v_mov_b32 v33, 0
    v_lshlrev_b32 v32, 7, v16
    buffer_store_dword v33, v32, s[32:35], s72 offen sc1
    s_mov_b64 exec, 1
    s_lshl_b32 s71, s71, 8
    s_add_u32 s71, s71, 95830016
    buffer_store_dword v33, v33, s[32:35], s71 offen sc1
    buffer_store_dword v33, v33, s[32:35], s71 offen offset:128 sc1
    s_mov_b64 exec, -1
L_ch_nofl:
    s_mov_b32 s36, s10
    s_mov_b32 s37, s11
    s_mov_b32 s38, 5242880
    s_mov_b32 s39, 0x20000
    s_add_u32 s79, s78, 0
    s_add_u32 m0, s77, 0
    s_add_u32 s79, s79, s75
    buffer_load_dwordx4 v68, s[36:39], s79 offen lds
    s_add_u32 s79, s78, 16384
    s_add_u32 m0, s77, 1024
    s_add_u32 s79, s79, s75
    buffer_load_dwordx4 v68, s[36:39], s79 offen lds
    s_add_u32 s79, s78, 32768
    s_add_u32 m0, s77, 2048
    s_add_u32 s79, s79, s75
    buffer_load_dwordx4 v69, s[36:39], s79 offen lds
    s_add_u32 s79, s78, 49152
    s_add_u32 m0, s77, 3072
    s_add_u32 s79, s79, s75
    buffer_load_dwordx4 v69, s[36:39], s79 offen lds
    s_cmp_eq_u32 s42, 0
    s_cselect_b64 s[80:81], -1, 0
    v_cndmask_b32 v73, v68, v70, s[80:81]
    s_add_u32 s79, s83, 0
    s_add_u32 m0, s77, 4096
    s_add_u32 s79, s79, s75
    buffer_load_dwordx4 v73, s[36:39], s79 offen lds
    s_add_u32 s79, s83, 16384
    s_add_u32 m0, s77, 5120
    s_add_u32 s79, s79, s75
    buffer_load_dwordx4 v73, s[36:39], s79 offen lds
    v_cndmask_b32 v73, v69, v71, s[80:81]
    s_add_u32 s79, s83, 32768
    s_add_u32 m0, s77, 6144
    s_add_u32 s79, s79, s75
    buffer_load_dwordx4 v73, s[36:39], s79 offen lds
    s_add_u32 s79, s83, 49152
    s_add_u32 m0, s77, 7168
    s_add_u32 s79, s79, s75
    buffer_load_dwordx4 v73, s[36:39], s79 offen lds
    s_cmp_eq_u32 s42, 1
    s_cselect_b64 s[80:81], -1, 0
    v_cndmask_b32 v73, v68, v70, s[80:81]
    s_add_u32 s79, s84, 0
    s_add_u32 m0, s77, 8192
    s_add_u32 s79, s79, s75
    buffer_load_dwordx4 v73, s[36:39], s79 offen lds
    s_add_u32 s79, s84, 16384
    s_add_u32 m0, s77, 9216
    s_add_u32 s79, s79, s75
    buffer_load_dwordx4 v73, s[36:39], s79 offen lds
    v_cndmask_b32 v73, v69, v71, s[80:81]
    s_add_u32 s79, s84, 32768
    s_add_u32 m0, s77, 10240
    s_add_u32 s79, s79, s75
    buffer_load_dwordx4 v73, s[36:39], s79 offen lds
    s_add_u32 s79, s84, 49152
    s_add_u32 m0, s77, 11264
    s_add_u32 s79, s79, s75
    buffer_load_dwordx4 v73, s[36:39], s79 offen lds
    s_cmp_eq_u32 s42, 2
    s_cselect_b64 s[80:81], -1, 0
    v_cndmask_b32 v73, v68, v70, s[80:81]
    s_add_u32 s79, s85, 0
    s_add_u32 m0, s77, 12288
    s_add_u32 s79, s79, s75
    buffer_load_dwordx4 v73, s[36:39], s79 offen lds
    s_add_u32 s79, s85, 16384
    s_add_u32 m0, s77, 13312
    s_add_u32 s79, s79, s75
    buffer_load_dwordx4 v73, s[36:39], s79 offen lds
    v_cndmask_b32 v73, v69, v71, s[80:81]
    s_add_u32 s79, s85, 32768
    s_add_u32 m0, s77, 14336
    s_add_u32 s79, s79, s75
    buffer_load_dwordx4 v73, s[36:39], s79 offen lds
    s_add_u32 s79, s85, 49152
    s_add_u32 m0, s77, 15360
    s_add_u32 s79, s79, s75
    buffer_load_dwordx4 v73, s[36:39], s79 offen lds
    s_cmp_eq_u32 s42, 3
    s_cselect_b64 s[80:81], -1, 0
    v_cndmask_b32 v73, v68, v70, s[80:81]
    s_add_u32 s79, s3, 0
    s_add_u32 m0, s77, 16384
    s_add_u32 s79, s79, s75
    buffer_load_dwordx4 v73, s[36:39], s79 offen lds
    s_add_u32 s79, s3, 16384
    s_add_u32 m0, s77, 17408
    s_add_u32 s79, s79, s75
    buffer_load_dwordx4 v73, s[36:39], s79 offen lds
    v_cndmask_b32 v73, v69, v71, s[80:81]
    s_add_u32 s79, s3, 32768
    s_add_u32 m0, s77, 18432
    s_add_u32 s79, s79, s75
    buffer_load_dwordx4 v73, s[36:39], s79 offen lds
    s_add_u32 s79, s3, 49152
    s_add_u32 m0, s77, 19456
    s_add_u32 s79, s79, s75
    buffer_load_dwordx4 v73, s[36:39], s79 offen lds
    s_add_u32 s79, s78, 0
    s_add_u32 m0, s77, 20480
    s_add_u32 s79, s79, s76
    buffer_load_dwordx4 v68, s[36:39], s79 offen lds
    s_add_u32 s79, s78, 16384
    s_add_u32 m0, s77, 21504
    s_add_u32 s79, s79, s76
    buffer_load_dwordx4 v68, s[36:39], s79 offen lds
    s_add_u32 s79, s78, 32768
    s_add_u32 m0, s77, 22528
    s_add_u32 s79, s79, s76
    buffer_load_dwordx4 v69, s[36:39], s79 offen lds
    s_add_u32 s79, s78, 49152
    s_add_u32 m0, s77, 23552
    s_add_u32 s79, s79, s76
    buffer_load_dwordx4 v69, s[36:39], s79 offen lds
    s_cmp_eq_u32 s42, 0
    s_cselect_b64 s[80:81], -1, 0
    v_cndmask_b32 v73, v68, v70, s[80:81]
    s_add_u32 s79, s83, 0
    s_add_u32 m0, s77, 24576
    s_add_u32 s79, s79, s76
    buffer_load_dwordx4 v73, s[36:39], s79 offen lds
    s_add_u32 s79, s83, 16384
    s_add_u32 m0, s77, 25600
    s_add_u32 s79, s79, s76
    buffer_load_dwordx4 v73, s[36:39], s79 offen lds
    v_cndmask_b32 v73, v69, v71, s[80:81]
    s_add_u32 s79, s83, 32768
    s_add_u32 m0, s77, 26624
    s_add_u32 s79, s79, s76
    buffer_load_dwordx4 v73, s[36:39], s79 offen lds
    s_add_u32 s79, s83, 49152
    s_add_u32 m0, s77, 27648
    s_add_u32 s79, s79, s76
    buffer_load_dwordx4 v73, s[36:39], s79 offen lds
    s_cmp_eq_u32 s42, 1
    s_cselect_b64 s[80:81], -1, 0
    v_cndmask_b32 v73, v68, v70, s[80:81]
    s_add_u32 s79, s84, 0
    s_add_u32 m0, s77, 28672
    s_add_u32 s79, s79, s76
    buffer_load_dwordx4 v73, s[36:39], s79 offen lds
    s_add_u32 s79, s84, 16384
    s_add_u32 m0, s77, 29696
    s_add_u32 s79, s79, s76
    buffer_load_dwordx4 v73, s[36:39], s79 offen lds
    v_cndmask_b32 v73, v69, v71, s[80:81]
    s_add_u32 s79, s84, 32768
    s_add_u32 m0, s77, 30720
    s_add_u32 s79, s79, s76
    buffer_load_dwordx4 v73, s[36:39], s79 offen lds
    s_add_u32 s79, s84, 49152
    s_add_u32 m0, s77, 31744
    s_add_u32 s79, s79, s76
    buffer_load_dwordx4 v73, s[36:39], s79 offen lds
    v_and_b32 v17, 15, v16
    v_lshrrev_b32 v18, 4, v16
    s_mul_i32 s70, s40, 163840
    s_add_u32 s70, s70, 95420416
    s_lshl_b32 s72, s41, 7
    s_add_u32 s72, s72, s70
    s_lshl_b32 s71, s42, 15
    s_add_u32 s71, s71, s72
    v_lshrrev_b32 v19, 3, v17
    v_lshl_add_u32 v19, v19, 2, v18
    v_lshlrev_b32 v19, 12, v19
    v_and_b32 v20, 7, v16
    v_lshl_add_u32 v19, v20, 4, v19
    v_add_u32 v0, s71, v19
    s_lshl_b32 s71, s42, 13
    s_add_u32 s71, s71, s72
    s_add_u32 s71, s71, 131072
    v_lshrrev_b32 v19, 1, v18
    v_lshlrev_b32 v19, 12, v19
    v_and_b32 v20, 1, v18
    v_lshl_add_u32 v19, v20, 6, v19
    v_and_b32 v20, 3, v16
    v_lshl_add_u32 v19, v20, 4, v19
    v_add_u32 v1, s71, v19
    s_lshr_b32 s71, s41, 2
    s_add_u32 s71, s71, 32
    s_and_b32 s72, s41, 3
    s_cmp_eq_u32 s72, 0
    s_cselect_b32 s71, s71, 99
    s_cmp_eq_u32 s42, 1
    s_cselect_b32 s53, s71, 99
    s_cmp_eq_u32 s42, 0
    s_cselect_b32 s53, s41, s53
    s_lshl_b32 s66, s53, 12
    s_add_u32 s66, s66, s70
    v_bfe_u32 v23, v16, 2, 1
    v_and_b32 v24, 1, v18
    v_lshrrev_b32 v25, 5, v16
    s_cmp_ge_u32 s53, 32
    s_cbranch_scc1 L_ch_odd
    s_lshr_b32 s71, s53, 3
    s_mul_i32 s71, s71, 5
    s_bfe_u32 s72, s53, 0x10002
    s_add_u32 s71, s71, s72
    v_lshl_add_u32 v22, v23, 1, s71
    s_and_b32 s72, s53, 3
    v_mov_b32 v21, s72
    v_lshlrev_b32 v20, 2, v24
    s_branch L_ch_oddd
L_ch_odd:
    s_bfe_u32 s71, s53, 0x20001
    s_mul_i32 s71, s71, 5
    s_add_u32 s71, s71, 4
    v_mov_b32 v22, s71
    s_and_b32 s72, s53, 1
    s_lshl_b32 s72, s72, 1
    v_add_u32 v21, s72, v24
    v_lshlrev_b32 v20, 2, v23
L_ch_oddd:
    v_lshl_add_u32 v20, v25, 1, v20
    v_lshlrev_b32 v19, 8, v22
    v_lshl_add_u32 v19, v21, 6, v19
    v_and_b32 v23, 3, v16
    v_lshl_add_u32 v19, v23, 4, v19
    v_lshl_add_u32 v2, v20, 1, v19
    v_mul_u32_u24 v19, 52, v22
    v_lshrrev_b32 v19, 8, v19
    v_mul_u32_u24 v25, 5, v19
    v_sub_u32 v22, v22, v25
    v_mul_u32_u24 v19, 80, v19
    v_lshrrev_b32 v25, 1, v22
    v_lshl_add_u32 v19, v25, 5, v19
    v_and_b32 v25, 1, v22
    v_lshl_add_u32 v19, v25, 3, v19
    v_add_u32 v19, v19, v20
    v_cmp_eq_u32 vcc, 4, v22
    v_mov_b32 v25, 8
    s_nop 0
    v_cndmask_b32 v25, 16, v25, vcc
    v_bfe_u32 v23, v16, 1, 1
    v_mad_u32_u24 v19, v23, v25, v19
    s_mul_i32 s71, s40, 320
    v_add_u32 v19, s71, v19
    v_and_b32 v23, 1, v16
    v_lshl_add_u32 v21, v21, 1, v23
    v_mul_u32_u24 v21, 640, v21
    v_add_lshl_u32 v34, v19, v21, 1
    s_mul_i32 s71, s42, 1280
    v_add_u32 v3, s71, v8
    s_add_u32 s71, s71, 1024
    v_lshl_add_u32 v4, v16, 2, s71
    v_and_b32 v20, 3, v16
    s_lshl_b32 s71, s42, 8
    v_lshl_add_u32 v19, v17, 3, s71
    v_lshlrev_b32 v21, 6, v18
    v_xor_b32 v19, v19, v21
    v_lshl_add_u32 v19, v18, 10, v19
    v_add_u32 v6, 12288, v19
    v_bfe_u32 v21, v16, 2, 2
    v_lshl_add_u32 v19, v18, 2, v21
    v_lshlrev_b32 v19, 3, v19
    v_lshlrev_b32 v21, 6, v20
    v_xor_b32 v19, v19, v21
    v_lshl_add_u32 v19, v20, 10, v19
    v_add_u32 v7, 12288, v19
    s_lshr_b32 s71, s42, 1
    s_lshl_b32 s71, s71, 10
    s_and_b32 s72, s42, 1
    s_lshl_b32 s72, s72, 5
    s_add_u32 s71, s71, s72
    s_add_u32 s48, s71, 10240
    v_add_u32 v9, s77, v8
    v_mov_b32 v10, 0x4444
    v_mov_b32 v19, 0xeeee
    v_and_b32 v21, 2, v16
    v_cmp_ne_u32 vcc, 0, v21
    s_nop 1
    v_cndmask_b32 v10, v10, v19, vcc
    v_bfe_u32 v21, v16, 2, 2
    v_and_b32 v19, 1, v18
    v_lshl_add_u32 v25, v19, 3, v21
    v_lshlrev_b32 v23, 8, v25
    v_lshl_add_u32 v23, v20, 3, v23
    v_lshl_add_u32 v19, v19, 2, v21
    s_lshl_b32 s71, s42, 1
    v_xor_b32 v19, s71, v19
    v_lshl_add_u32 v23, v19, 5, v23
    v_lshrrev_b32 v19, 1, v18
    v_mul_u32_u24 v19, 34816, v19
    v_add_u32 v23, v23, v19
    v_add_u32 v23, 24576, v23
    v_xor_b32 v24, 32, v23
    v_add_u32 v74, 69632, v23
    v_add_u32 v75, 69632, v24
    v_lshl_add_u32 v19, v18, 3, v21
    v_mul_u32_u24 v19, 160, v19
    v_lshl_add_u32 v19, v20, 3, v19
    v_add_u32 v22, s77, v19
    v_mul_u32_u24 v19, 26, v16
    v_lshrrev_b32 v19, 8, v19
    v_mul_u32_u24 v21, 10, v19
    v_sub_u32 v21, v16, v21
    v_lshrrev_b32 v25, 1, v19
    v_lshlrev_b32 v25, 5, v25
    v_and_b32 v19, 1, v19
    v_add_u32 v25, v25, v19
    v_mul_u32_u24 v25, 1280, v25
    v_lshl_add_u32 v72, v21, 4, v25
    s_mul_i32 s86, s41, 163840
    s_mul_i32 s71, s40, 640
    s_add_u32 s86, s86, s71
    s_mul_i32 s71, s42, 160
    s_add_u32 s86, s86, s71
    s_mov_b32 s56, 0x000f000f
    s_mov_b32 s57, 0x000f000f
    s_mov_b32 s58, 0x00ff00ff
    s_mov_b32 s59, 0
    s_mov_b32 s60, 0x33333333
    s_mov_b32 s61, 0x33333333
    s_mov_b32 s54, 0x3e0293ee
    s_mov_b32 s55, 0x3e0293ee
    s_mov_b32 s74, -1
    s_mov_b32 s43, 0
    s_mov_b32 s51, 0
    s_lshl_b32 s44, s40, 15
    s_add_u32 s44, s44, 95748096
    s_lshl_b32 s47, s40, 14
    s_add_u32 s47, s47, 92274688
    s_xor_b32 s45, s47, 16384
    v_mov_b32 v28, -1
    v_mov_b32 v29, -1
    v_mov_b32 v30, -1
    v_mov_b32 v31, -1
    s_min_u32 s70, s41, 3
    s_lshl_b32 s70, s70, 13
    s_add_u32 s70, s70, s44
    s_lshl_b32 s71, s41, 16
    s_lshl_b32 s72, s40, 14
    s_add_u32 s71, s71, s72
    s_add_u32 s71, s71, 92274688
    v_min_u32 v27, 1008, v26
    v_add_u32 v27, 4096, v27
    s_add_u32 s72, s70, 0
    s_xor_b32 s72, s72, 0
    buffer_store_dwordx4 v[28:31], v26, s[32:35], s72 offen sc1
    buffer_store_dwordx4 v[28:31], v27, s[32:35], s72 offen sc1
    s_add_u32 s72, s71, 0
    s_xor_b32 s72, s72, 0
    buffer_store_dwordx4 v[28:31], v26, s[32:35], s72 offen sc1
    buffer_store_dwordx4 v[28:31], v27, s[32:35], s72 offen sc1
    s_add_u32 s72, s71, 8192
    s_xor_b32 s72, s72, 0
    buffer_store_dwordx4 v[28:31], v26, s[32:35], s72 offen sc1
    buffer_store_dwordx4 v[28:31], v27, s[32:35], s72 offen sc1
    s_add_u32 s72, s71, 32768
    s_xor_b32 s72, s72, 0
    buffer_store_dwordx4 v[28:31], v26, s[32:35], s72 offen sc1
    buffer_store_dwordx4 v[28:31], v27, s[32:35], s72 offen sc1
    s_add_u32 s72, s71, 40960
    s_xor_b32 s72, s72, 0
    buffer_store_dwordx4 v[28:31], v26, s[32:35], s72 offen sc1
    buffer_store_dwordx4 v[28:31], v27, s[32:35], s72 offen sc1
    s_lshl_b32 s72, s40, 5
    s_add_u32 s72, s72, s41
    s_lshl_b32 s72, s72, 12
    s_add_u32 s72, s72, 87556096
    buffer_store_dwordx4 v[28:31], v26, s[32:35], s72 offen sc1
    s_add_u32 s72, s72, 262144
    buffer_store_dwordx4 v[28:31], v26, s[32:35], s72 offen sc1
    buffer_store_dwordx4 v[28:31], v0, s[32:35], 0 offen sc1
    s_mov_b64 exec, s[56:57]
    buffer_store_dwordx4 v[28:31], v1, s[32:35], 0 offen sc1
    s_mov_b64 exec, -1
    s_waitcnt vmcnt(42)
    s_barrier
    ds_read_b64_tr_b16 a[160:161], v23 offset:0
    ds_read_b64_tr_b16 a[162:163], v23 offset:1024
    ds_read_b64_tr_b16 a[164:165], v74 offset:0
    ds_read_b64_tr_b16 a[166:167], v74 offset:1024
    ds_read_b64_tr_b16 a[168:169], v24 offset:0
    ds_read_b64_tr_b16 a[170:171], v24 offset:1024
    ds_read_b64_tr_b16 a[172:173], v75 offset:0
    ds_read_b64_tr_b16 a[174:175], v75 offset:1024
    s_waitcnt lgkmcnt(0)
    s_cmp_lg_u32 s42, 0
    s_cbranch_scc1 L_ch_arr0
    v_mov_b32 v32, 248
    v_mov_b32 v33, 1
    s_mov_b64 exec, 1
    global_atomic_add v32, v33, s[28:29]
    s_mov_b64 exec, -1
L_ch_arr0:
    s_waitcnt vmcnt(38)
    s_barrier
    s_cmp_eq_u32 s42, 2
    s_cselect_b64 s[80:81], -1, 0
    v_cndmask_b32 v73, v68, v70, s[80:81]
    s_add_u32 s79, s85, 0
    s_add_u32 m0, s77, 0
    s_add_u32 s79, s79, s76
    buffer_load_dwordx4 v73, s[36:39], s79 offen lds
    s_add_u32 s79, s85, 16384
    s_add_u32 m0, s77, 1024
    s_add_u32 s79, s79, s76
    buffer_load_dwordx4 v73, s[36:39], s79 offen lds
    v_cndmask_b32 v73, v69, v71, s[80:81]
    s_add_u32 s79, s85, 32768
    s_add_u32 m0, s77, 2048
    s_add_u32 s79, s79, s76
    buffer_load_dwordx4 v73, s[36:39], s79 offen lds
    s_add_u32 s79, s85, 49152
    s_add_u32 m0, s77, 3072
    s_add_u32 s79, s79, s76
    buffer_load_dwordx4 v73, s[36:39], s79 offen lds
    ds_read_b64_tr_b16 a[176:177], v23 offset:4096
    ds_read_b64_tr_b16 a[178:179], v23 offset:5120
    ds_read_b64_tr_b16 a[180:181], v74 offset:4096
    ds_read_b64_tr_b16 a[182:183], v74 offset:5120
    ds_read_b64_tr_b16 a[184:185], v24 offset:4096
    ds_read_b64_tr_b16 a[186:187], v24 offset:5120
    ds_read_b64_tr_b16 a[188:189], v75 offset:4096
    ds_read_b64_tr_b16 a[190:191], v75 offset:5120
    s_waitcnt lgkmcnt(0)
    s_waitcnt vmcnt(38)
    s_barrier
    s_cmp_eq_u32 s42, 3
    s_cselect_b64 s[80:81], -1, 0
    v_cndmask_b32 v73, v68, v70, s[80:81]
    s_add_u32 s79, s3, 0
    s_add_u32 m0, s77, 4096
    s_add_u32 s79, s79, s76
    buffer_load_dwordx4 v73, s[36:39], s79 offen lds
    s_add_u32 s79, s3, 16384
    s_add_u32 m0, s77, 5120
    s_add_u32 s79, s79, s76
    buffer_load_dwordx4 v73, s[36:39], s79 offen lds
    v_cndmask_b32 v73, v69, v71, s[80:81]
    s_add_u32 s79, s3, 32768
    s_add_u32 m0, s77, 6144
    s_add_u32 s79, s79, s76
    buffer_load_dwordx4 v73, s[36:39], s79 offen lds
    s_add_u32 s79, s3, 49152
    s_add_u32 m0, s77, 7168
    s_add_u32 s79, s79, s76
    buffer_load_dwordx4 v73, s[36:39], s79 offen lds
    ds_read_b64_tr_b16 a[192:193], v23 offset:8192
    ds_read_b64_tr_b16 a[194:195], v23 offset:9216
    ds_read_b64_tr_b16 a[196:197], v74 offset:8192
    ds_read_b64_tr_b16 a[198:199], v74 offset:9216
    ds_read_b64_tr_b16 a[200:201], v24 offset:8192
    ds_read_b64_tr_b16 a[202:203], v24 offset:9216
    ds_read_b64_tr_b16 a[204:205], v75 offset:8192
    ds_read_b64_tr_b16 a[206:207], v75 offset:9216
    s_waitcnt lgkmcnt(0)
    s_waitcnt vmcnt(38)
    s_barrier
    s_mov_b32 s36, s12
    s_mov_b32 s37, s13
    s_mov_b32 s38, 5242880
    s_mov_b32 s39, 0x20000
    s_cmp_eq_u32 s42, 2
    s_cselect_b64 s[80:81], -1, 0
    v_cndmask_b32 v73, v68, v70, s[80:81]
    s_add_u32 s79, s85, 0
    s_add_u32 m0, s77, 8192
    s_add_u32 s79, s79, s76
    buffer_load_dwordx4 v73, s[36:39], s79 offen lds
    s_add_u32 s79, s85, 16384
    s_add_u32 m0, s77, 9216
    s_add_u32 s79, s79, s76
    buffer_load_dwordx4 v73, s[36:39], s79 offen lds
    v_cndmask_b32 v73, v69, v71, s[80:81]
    s_add_u32 s79, s85, 32768
    s_add_u32 m0, s77, 10240
    s_add_u32 s79, s79, s76
    buffer_load_dwordx4 v73, s[36:39], s79 offen lds
    s_add_u32 s79, s85, 49152
    s_add_u32 m0, s77, 11264
    s_add_u32 s79, s79, s76
    buffer_load_dwordx4 v73, s[36:39], s79 offen lds
    ds_read_b64_tr_b16 a[208:209], v23 offset:12288
    ds_read_b64_tr_b16 a[210:211], v23 offset:13312
    ds_read_b64_tr_b16 a[212:213], v74 offset:12288
    ds_read_b64_tr_b16 a[214:215], v74 offset:13312
    ds_read_b64_tr_b16 a[216:217], v24 offset:12288
    ds_read_b64_tr_b16 a[218:219], v24 offset:13312
    ds_read_b64_tr_b16 a[220:221], v75 offset:12288
    ds_read_b64_tr_b16 a[222:223], v75 offset:13312
    s_waitcnt lgkmcnt(0)
    s_waitcnt vmcnt(38)
    s_barrier
    s_cmp_eq_u32 s42, 3
    s_cselect_b64 s[80:81], -1, 0
    v_cndmask_b32 v73, v68, v70, s[80:81]
    s_add_u32 s79, s3, 0
    s_add_u32 m0, s77, 12288
    s_add_u32 s79, s79, s76
    buffer_load_dwordx4 v73, s[36:39], s79 offen lds
    s_add_u32 s79, s3, 16384
    s_add_u32 m0, s77, 13312
    s_add_u32 s79, s79, s76
    buffer_load_dwordx4 v73, s[36:39], s79 offen lds
    v_cndmask_b32 v73, v69, v71, s[80:81]
    s_add_u32 s79, s3, 32768
    s_add_u32 m0, s77, 14336
    s_add_u32 s79, s79, s76
    buffer_load_dwordx4 v73, s[36:39], s79 offen lds
    s_add_u32 s79, s3, 49152
    s_add_u32 m0, s77, 15360
    s_add_u32 s79, s79, s76
    buffer_load_dwordx4 v73, s[36:39], s79 offen lds
    ds_read_b64_tr_b16 a[224:225], v23 offset:16384
    ds_read_b64_tr_b16 a[226:227], v23 offset:17408
    ds_read_b64_tr_b16 a[228:229], v74 offset:16384
    ds_read_b64_tr_b16 a[230:231], v74 offset:17408
    ds_read_b64_tr_b16 a[232:233], v24 offset:16384
    ds_read_b64_tr_b16 a[234:235], v24 offset:17408
    ds_read_b64_tr_b16 a[236:237], v75 offset:16384
    ds_read_b64_tr_b16 a[238:239], v75 offset:17408
    s_waitcnt lgkmcnt(0)
    s_waitcnt vmcnt(38)
    s_barrier
    s_mov_b32 s36, s8
    s_mov_b32 s37, s9
    s_mov_b32 s38, 5242880
    s_mov_b32 s39, 0x20000
    s_add_u32 s79, s78, 0
    s_add_u32 m0, s77, 16384
    s_add_u32 s79, s79, s75
    buffer_load_dwordx4 v68, s[36:39], s79 offen lds
    s_add_u32 s79, s78, 16384
    s_add_u32 m0, s77, 17408
    s_add_u32 s79, s79, s75
    buffer_load_dwordx4 v68, s[36:39], s79 offen lds
    s_add_u32 s79, s78, 32768
    s_add_u32 m0, s77, 18432
    s_add_u32 s79, s79, s75
    buffer_load_dwordx4 v69, s[36:39], s79 offen lds
    s_add_u32 s79, s78, 49152
    s_add_u32 m0, s77, 19456
    s_add_u32 s79, s79, s75
    buffer_load_dwordx4 v69, s[36:39], s79 offen lds
    ds_read_b64_tr_b16 a[240:241], v23 offset:20480
    ds_read_b64_tr_b16 a[242:243], v23 offset:21504
    ds_read_b64_tr_b16 a[244:245], v74 offset:20480
    ds_read_b64_tr_b16 a[246:247], v74 offset:21504
    ds_read_b64_tr_b16 a[248:249], v24 offset:20480
    ds_read_b64_tr_b16 a[250:251], v24 offset:21504
    ds_read_b64_tr_b16 a[252:253], v75 offset:20480
    ds_read_b64_tr_b16 a[254:255], v75 offset:21504
    s_waitcnt lgkmcnt(0)
    s_waitcnt vmcnt(38)
    s_barrier
    s_cmp_eq_u32 s42, 0
    s_cselect_b64 s[80:81], -1, 0
    v_cndmask_b32 v73, v68, v70, s[80:81]
    s_add_u32 s79, s83, 0
    s_add_u32 m0, s77, 20480
    s_add_u32 s79, s79, s75
    buffer_load_dwordx4 v73, s[36:39], s79 offen lds
    s_add_u32 s79, s83, 16384
    s_add_u32 m0, s77, 21504
    s_add_u32 s79, s79, s75
    buffer_load_dwordx4 v73, s[36:39], s79 offen lds
    v_cndmask_b32 v73, v69, v71, s[80:81]
    s_add_u32 s79, s83, 32768
    s_add_u32 m0, s77, 22528
    s_add_u32 s79, s79, s75
    buffer_load_dwordx4 v73, s[36:39], s79 offen lds
    s_add_u32 s79, s83, 49152
    s_add_u32 m0, s77, 23552
    s_add_u32 s79, s79, s75
    buffer_load_dwordx4 v73, s[36:39], s79 offen lds
    ds_read_b64_tr_b16 v[88:89], v23 offset:24576
    ds_read_b64_tr_b16 v[90:91], v23 offset:25600
    ds_read_b64_tr_b16 v[92:93], v74 offset:24576
    ds_read_b64_tr_b16 v[94:95], v74 offset:25600
    ds_read_b64_tr_b16 v[96:97], v24 offset:24576
    ds_read_b64_tr_b16 v[98:99], v24 offset:25600
    ds_read_b64_tr_b16 v[100:101], v75 offset:24576
    ds_read_b64_tr_b16 v[102:103], v75 offset:25600
    s_waitcnt lgkmcnt(0)
    s_waitcnt vmcnt(38)
    s_barrier
    s_cmp_eq_u32 s42, 1
    s_cselect_b64 s[80:81], -1, 0
    v_cndmask_b32 v73, v68, v70, s[80:81]
    s_add_u32 s79, s84, 0
    s_add_u32 m0, s77, 24576
    s_add_u32 s79, s79, s75
    buffer_load_dwordx4 v73, s[36:39], s79 offen lds
    s_add_u32 s79, s84, 16384
    s_add_u32 m0, s77, 25600
    s_add_u32 s79, s79, s75
    buffer_load_dwordx4 v73, s[36:39], s79 offen lds
    v_cndmask_b32 v73, v69, v71, s[80:81]
    s_add_u32 s79, s84, 32768
    s_add_u32 m0, s77, 26624
    s_add_u32 s79, s79, s75
    buffer_load_dwordx4 v73, s[36:39], s79 offen lds
    s_add_u32 s79, s84, 49152
    s_add_u32 m0, s77, 27648
    s_add_u32 s79, s79, s75
    buffer_load_dwordx4 v73, s[36:39], s79 offen lds
    ds_read_b64_tr_b16 v[104:105], v23 offset:28672
    ds_read_b64_tr_b16 v[106:107], v23 offset:29696
    ds_read_b64_tr_b16 v[108:109], v74 offset:28672
    ds_read_b64_tr_b16 v[110:111], v74 offset:29696
    ds_read_b64_tr_b16 v[112:113], v24 offset:28672
    ds_read_b64_tr_b16 v[114:115], v24 offset:29696
    ds_read_b64_tr_b16 v[116:117], v75 offset:28672
    ds_read_b64_tr_b16 v[118:119], v75 offset:29696
    s_waitcnt lgkmcnt(0)
    s_waitcnt vmcnt(24)
    s_barrier
    s_cmp_eq_u32 s42, 2
    s_cselect_b64 s[80:81], -1, 0
    v_cndmask_b32 v73, v68, v70, s[80:81]
    s_add_u32 s79, s85, 0
    s_add_u32 m0, s77, 28672
    s_add_u32 s79, s79, s75
    buffer_load_dwordx4 v73, s[36:39], s79 offen lds
    s_add_u32 s79, s85, 16384
    s_add_u32 m0, s77, 29696
    s_add_u32 s79, s79, s75
    buffer_load_dwordx4 v73, s[36:39], s79 offen lds
    v_cndmask_b32 v73, v69, v71, s[80:81]
    s_add_u32 s79, s85, 32768
    s_add_u32 m0, s77, 30720
    s_add_u32 s79, s79, s75
    buffer_load_dwordx4 v73, s[36:39], s79 offen lds
    s_add_u32 s79, s85, 49152
    s_add_u32 m0, s77, 31744
    s_add_u32 s79, s79, s75
    buffer_load_dwordx4 v73, s[36:39], s79 offen lds
    ds_read_b64_tr_b16 v[120:121], v23 offset:0
    ds_read_b64_tr_b16 v[122:123], v23 offset:1024
    ds_read_b64_tr_b16 v[124:125], v74 offset:0
    ds_read_b64_tr_b16 v[126:127], v74 offset:1024
    ds_read_b64_tr_b16 v[128:129], v24 offset:0
    ds_read_b64_tr_b16 v[130:131], v24 offset:1024
    ds_read_b64_tr_b16 v[132:133], v75 offset:0
    ds_read_b64_tr_b16 v[134:135], v75 offset:1024
    s_waitcnt lgkmcnt(0)
    s_waitcnt vmcnt(24)
    s_barrier
    s_mov_b32 s36, s14
    s_mov_b32 s37, s15
    s_mov_b32 s38, 5242880
    s_mov_b32 s39, 0x20000
    s_mov_b32 exec_hi, 0xff
    s_add_u32 m0, s77, 0
    s_add_u32 s79, s86, 0
    buffer_load_dwordx4 v72, s[36:39], s79 offen lds
    s_add_u32 m0, s77, 640
    s_add_u32 s79, s86, 2560
    buffer_load_dwordx4 v72, s[36:39], s79 offen lds
    s_add_u32 m0, s77, 1280
    s_add_u32 s79, s86, 20480
    buffer_load_dwordx4 v72, s[36:39], s79 offen lds
    s_add_u32 m0, s77, 1920
    s_add_u32 s79, s86, 23040
    buffer_load_dwordx4 v72, s[36:39], s79 offen lds
    s_add_u32 m0, s77, 2560
    s_add_u32 s79, s86, 5120
    buffer_load_dwordx4 v72, s[36:39], s79 offen lds
    s_add_u32 m0, s77, 3200
    s_add_u32 s79, s86, 7680
    buffer_load_dwordx4 v72, s[36:39], s79 offen lds
    s_mov_b32 exec_hi, -1
    ds_read_b64_tr_b16 v[136:137], v23 offset:4096
    ds_read_b64_tr_b16 v[138:139], v23 offset:5120
    ds_read_b64_tr_b16 v[140:141], v74 offset:4096
    ds_read_b64_tr_b16 v[142:143], v74 offset:5120
    ds_read_b64_tr_b16 v[144:145], v24 offset:4096
    ds_read_b64_tr_b16 v[146:147], v24 offset:5120
    ds_read_b64_tr_b16 v[148:149], v75 offset:4096
    ds_read_b64_tr_b16 v[150:151], v75 offset:5120
    s_waitcnt lgkmcnt(0)
    s_cmp_lg_u32 s42, 0
    s_cbranch_scc1 L_ch_arr9
    v_mov_b32 v32, 240
    v_mov_b32 v33, 1
    s_mov_b64 exec, 1
    global_atomic_add v32, v33, s[28:29]
    s_mov_b64 exec, -1
L_ch_arr9:
    s_waitcnt vmcnt(26)
    s_barrier
    s_mov_b32 exec_hi, 0xff
    s_add_u32 m0, s77, 3840
    s_add_u32 s79, s86, 25600
    buffer_load_dwordx4 v72, s[36:39], s79 offen lds
    s_add_u32 m0, s77, 4480
    s_add_u32 s79, s86, 28160
    buffer_load_dwordx4 v72, s[36:39], s79 offen lds
    s_add_u32 m0, s77, 5120
    s_add_u32 s79, s86, 10240
    buffer_load_dwordx4 v72, s[36:39], s79 offen lds
    s_add_u32 m0, s77, 5760
    s_add_u32 s79, s86, 12800
    buffer_load_dwordx4 v72, s[36:39], s79 offen lds
    s_add_u32 m0, s77, 6400
    s_add_u32 s79, s86, 30720
    buffer_load_dwordx4 v72, s[36:39], s79 offen lds
    s_add_u32 m0, s77, 7040
    s_add_u32 s79, s86, 33280
    buffer_load_dwordx4 v72, s[36:39], s79 offen lds
    s_mov_b32 exec_hi, -1
    ds_read_b64_tr_b16 v[36:37], v23 offset:8192
    ds_read_b64_tr_b16 v[38:39], v23 offset:9216
    ds_read_b64_tr_b16 v[40:41], v74 offset:8192
    ds_read_b64_tr_b16 v[42:43], v74 offset:9216
    ds_read_b64_tr_b16 v[232:233], v24 offset:8192
    ds_read_b64_tr_b16 v[234:235], v24 offset:9216
    ds_read_b64_tr_b16 v[236:237], v75 offset:8192
    ds_read_b64_tr_b16 v[238:239], v75 offset:9216
    s_waitcnt lgkmcnt(0)
    ds_write_b128 v9, v[36:39] offset:32768
    ds_write_b128 v9, v[40:43] offset:33792
    s_waitcnt vmcnt(28)
    s_barrier
    s_mov_b32 exec_hi, 0xff
    s_add_u32 m0, s77, 7680
    s_add_u32 s79, s86, 15360
    buffer_load_dwordx4 v72, s[36:39], s79 offen lds
    s_add_u32 m0, s77, 8320
    s_add_u32 s79, s86, 17920
    buffer_load_dwordx4 v72, s[36:39], s79 offen lds
    s_add_u32 m0, s77, 8960
    s_add_u32 s79, s86, 35840
    buffer_load_dwordx4 v72, s[36:39], s79 offen lds
    s_add_u32 m0, s77, 9600
    s_add_u32 s79, s86, 38400
    buffer_load_dwordx4 v72, s[36:39], s79 offen lds
    s_add_u32 m0, s77, 10240
    s_add_u32 s79, s86, 81920
    buffer_load_dwordx4 v72, s[36:39], s79 offen lds
    s_add_u32 m0, s77, 10880
    s_add_u32 s79, s86, 84480
    buffer_load_dwordx4 v72, s[36:39], s79 offen lds
    s_add_u32 m0, s77, 11520
    s_add_u32 s79, s86, 102400
    buffer_load_dwordx4 v72, s[36:39], s79 offen lds
    s_mov_b32 exec_hi, -1
    ds_read_b64_tr_b16 v[240:241], v23 offset:12288
    ds_read_b64_tr_b16 v[242:243], v23 offset:13312
    ds_read_b64_tr_b16 v[244:245], v74 offset:12288
    ds_read_b64_tr_b16 v[246:247], v74 offset:13312
    ds_read_b64_tr_b16 v[248:249], v24 offset:12288
    ds_read_b64_tr_b16 v[250:251], v24 offset:13312
    ds_read_b64_tr_b16 v[252:253], v75 offset:12288
    ds_read_b64_tr_b16 v[254:255], v75 offset:13312
    s_waitcnt lgkmcnt(0)
    s_waitcnt vmcnt(31)
    s_barrier
    s_mov_b32 exec_hi, 0xff
    s_add_u32 m0, s77, 12160
    s_add_u32 s79, s86, 104960
    buffer_load_dwordx4 v72, s[36:39], s79 offen lds
    s_add_u32 m0, s77, 12800
    s_add_u32 s79, s86, 87040
    buffer_load_dwordx4 v72, s[36:39], s79 offen lds
    s_add_u32 m0, s77, 13440
    s_add_u32 s79, s86, 89600
    buffer_load_dwordx4 v72, s[36:39], s79 offen lds
    s_add_u32 m0, s77, 14080
    s_add_u32 s79, s86, 107520
    buffer_load_dwordx4 v72, s[36:39], s79 offen lds
    s_add_u32 m0, s77, 14720
    s_add_u32 s79, s86, 110080
    buffer_load_dwordx4 v72, s[36:39], s79 offen lds
    s_add_u32 m0, s77, 15360
    s_add_u32 s79, s86, 92160
    buffer_load_dwordx4 v72, s[36:39], s79 offen lds
    s_mov_b32 exec_hi, -1
    ds_read_b64_tr_b16 a[0:1], v23 offset:16384
    ds_read_b64_tr_b16 a[2:3], v23 offset:17408
    ds_read_b64_tr_b16 a[4:5], v74 offset:16384
    ds_read_b64_tr_b16 a[6:7], v74 offset:17408
    ds_read_b64_tr_b16 a[8:9], v24 offset:16384
    ds_read_b64_tr_b16 a[10:11], v24 offset:17408
    ds_read_b64_tr_b16 a[12:13], v75 offset:16384
    ds_read_b64_tr_b16 a[14:15], v75 offset:17408
    s_waitcnt lgkmcnt(0)
    s_getpc_b64 s[72:73]
L_ch_pc:
    s_mul_i32 s70, s40, L_ch_step_f1-L_ch_step_f0
    s_add_u32 s70, s70, L_ch_step_f0-L_ch_pc
    s_add_u32 s72, s72, s70
    s_addc_u32 s73, s73, 0
    v_lshlrev_b32 v32, 3, v8
    global_load_dword v33, v32, s[72:73]
    s_waitcnt vmcnt(33)
    s_barrier
    s_mov_b32 exec_hi, 0xff
    s_add_u32 m0, s77, 16000
    s_add_u32 s79, s86, 94720
    buffer_load_dwordx4 v72, s[36:39], s79 offen lds
    s_add_u32 m0, s77, 16640
    s_add_u32 s79, s86, 112640
    buffer_load_dwordx4 v72, s[36:39], s79 offen lds
    s_add_u32 m0, s77, 17280
    s_add_u32 s79, s86, 115200
    buffer_load_dwordx4 v72, s[36:39], s79 offen lds
    s_add_u32 m0, s77, 17920
    s_add_u32 s79, s86, 97280
    buffer_load_dwordx4 v72, s[36:39], s79 offen lds
    s_add_u32 m0, s77, 18560
    s_add_u32 s79, s86, 99840
    buffer_load_dwordx4 v72, s[36:39], s79 offen lds
    s_add_u32 m0, s77, 19200
    s_add_u32 s79, s86, 117760
    buffer_load_dwordx4 v72, s[36:39], s79 offen lds
    s_add_u32 m0, s77, 19840
    s_add_u32 s79, s86, 120320
    buffer_load_dwordx4 v72, s[36:39], s79 offen lds
    s_mov_b32 exec_hi, -1
    ds_read_b64_tr_b16 a[16:17], v23 offset:20480
    ds_read_b64_tr_b16 a[18:19], v23 offset:21504
    ds_read_b64_tr_b16 a[20:21], v74 offset:20480
    ds_read_b64_tr_b16 a[22:23], v74 offset:21504
    ds_read_b64_tr_b16 a[24:25], v24 offset:20480
    ds_read_b64_tr_b16 a[26:27], v24 offset:21504
    ds_read_b64_tr_b16 a[28:29], v75 offset:20480
    ds_read_b64_tr_b16 a[30:31], v75 offset:21504
    s_waitcnt lgkmcnt(0)
    s_waitcnt vmcnt(36)
    s_barrier
    s_mov_b32 s36, s8
    s_mov_b32 s37, s9
    s_mov_b32 s38, 5242880
    s_mov_b32 s39, 0x20000
    s_cmp_eq_u32 s42, 3
    s_cselect_b64 s[80:81], -1, 0
    v_cndmask_b32 v73, v68, v70, s[80:81]
    s_add_u32 s79, s3, 0
    s_add_u32 m0, s77, 20480
    s_add_u32 s79, s79, s75
    buffer_load_dwordx4 v73, s[36:39], s79 offen lds
    s_add_u32 s79, s3, 16384
    s_add_u32 m0, s77, 21504
    s_add_u32 s79, s79, s75
    buffer_load_dwordx4 v73, s[36:39], s79 offen lds
    v_cndmask_b32 v73, v69, v71, s[80:81]
    s_add_u32 s79, s3, 32768
    s_add_u32 m0, s77, 22528
    s_add_u32 s79, s79, s75
    buffer_load_dwordx4 v73, s[36:39], s79 offen lds
    s_add_u32 s79, s3, 49152
    s_add_u32 m0, s77, 23552
    s_add_u32 s79, s79, s75
    buffer_load_dwordx4 v73, s[36:39], s79 offen lds
    ds_read_b64_tr_b16 a[32:33], v23 offset:24576
    ds_read_b64_tr_b16 a[34:35], v23 offset:25600
    ds_read_b64_tr_b16 a[36:37], v74 offset:24576
    ds_read_b64_tr_b16 a[38:39], v74 offset:25600
    ds_read_b64_tr_b16 a[40:41], v24 offset:24576
    ds_read_b64_tr_b16 a[42:43], v24 offset:25600
    ds_read_b64_tr_b16 a[44:45], v75 offset:24576
    ds_read_b64_tr_b16 a[46:47], v75 offset:25600
    s_waitcnt lgkmcnt(0)
    s_waitcnt vmcnt(36)
    s_barrier
    s_add_u32 s79, s78, 0
    s_add_u32 m0, s77, 24576
    s_add_u32 s79, s79, s76
    buffer_load_dwordx4 v68, s[36:39], s79 offen lds
    s_add_u32 s79, s78, 16384
    s_add_u32 m0, s77, 25600
    s_add_u32 s79, s79, s76
    buffer_load_dwordx4 v68, s[36:39], s79 offen lds
    s_add_u32 s79, s78, 32768
    s_add_u32 m0, s77, 26624
    s_add_u32 s79, s79, s76
    buffer_load_dwordx4 v69, s[36:39], s79 offen lds
    s_add_u32 s79, s78, 49152
    s_add_u32 m0, s77, 27648
    s_add_u32 s79, s79, s76
    buffer_load_dwordx4 v69, s[36:39], s79 offen lds
    ds_read_b64_tr_b16 a[48:49], v23 offset:28672
    ds_read_b64_tr_b16 a[50:51], v23 offset:29696
    ds_read_b64_tr_b16 a[52:53], v74 offset:28672
    ds_read_b64_tr_b16 a[54:55], v74 offset:29696
    ds_read_b64_tr_b16 a[56:57], v24 offset:28672
    ds_read_b64_tr_b16 a[58:59], v24 offset:29696
    ds_read_b64_tr_b16 a[60:61], v75 offset:28672
    ds_read_b64_tr_b16 a[62:63], v75 offset:29696
    s_waitcnt lgkmcnt(0)
    s_waitcnt vmcnt(34)
    s_barrier
    s_cmp_eq_u32 s42, 0
    s_cselect_b64 s[80:81], -1, 0
    v_cndmask_b32 v73, v68, v70, s[80:81]
    s_add_u32 s79, s83, 0
    s_add_u32 m0, s77, 28672
    s_add_u32 s79, s79, s76
    buffer_load_dwordx4 v73, s[36:39], s79 offen lds
    s_add_u32 s79, s83, 16384
    s_add_u32 m0, s77, 29696
    s_add_u32 s79, s79, s76
    buffer_load_dwordx4 v73, s[36:39], s79 offen lds
    v_cndmask_b32 v73, v69, v71, s[80:81]
    s_add_u32 s79, s83, 32768
    s_add_u32 m0, s77, 30720
    s_add_u32 s79, s79, s76
    buffer_load_dwordx4 v73, s[36:39], s79 offen lds
    s_add_u32 s79, s83, 49152
    s_add_u32 m0, s77, 31744
    s_add_u32 s79, s79, s76
    buffer_load_dwordx4 v73, s[36:39], s79 offen lds
    s_mov_b32 s88, s6
    s_mov_b32 s89, s7
    s_mov_b32 s90, 10240
    s_mov_b32 s91, 0x20000
    v_mov_b32 v32, 240
    global_load_dwordx2 v[26:27], v32, s[28:29] sc1
    buffer_load_dwordx2 v[28:29], v34, s[88:91], 0 offen
    s_waitcnt vmcnt(34)
    s_barrier
    s_waitcnt vmcnt(27)
    s_barrier
    s_waitcnt vmcnt(21)
    s_barrier
    s_waitcnt vmcnt(14)
    s_barrier
    ds_read_b64_tr_b16 v[152:153], v22 offset:0
    ds_read_b64_tr_b16 v[154:155], v22 offset:640
    ds_read_b64_tr_b16 v[156:157], v22 offset:5120
    ds_read_b64_tr_b16 v[158:159], v22 offset:5760
    ds_read_b64_tr_b16 v[160:161], v22 offset:10240
    ds_read_b64_tr_b16 v[162:163], v22 offset:10880
    ds_read_b64_tr_b16 v[164:165], v22 offset:15360
    ds_read_b64_tr_b16 v[166:167], v22 offset:16000
    s_waitcnt lgkmcnt(0)
    ds_read_b64_tr_b16 v[168:169], v22 offset:32
    ds_read_b64_tr_b16 v[170:171], v22 offset:672
    ds_read_b64_tr_b16 v[172:173], v22 offset:5152
    ds_read_b64_tr_b16 v[174:175], v22 offset:5792
    ds_read_b64_tr_b16 v[176:177], v22 offset:10272
    ds_read_b64_tr_b16 v[178:179], v22 offset:10912
    ds_read_b64_tr_b16 v[180:181], v22 offset:15392
    ds_read_b64_tr_b16 v[182:183], v22 offset:16032
    s_waitcnt lgkmcnt(0)
    ds_read_b64_tr_b16 v[184:185], v22 offset:64
    ds_read_b64_tr_b16 v[186:187], v22 offset:704
    ds_read_b64_tr_b16 v[188:189], v22 offset:5184
    ds_read_b64_tr_b16 v[190:191], v22 offset:5824
    ds_read_b64_tr_b16 v[192:193], v22 offset:10304
    ds_read_b64_tr_b16 v[194:195], v22 offset:10944
    ds_read_b64_tr_b16 v[196:197], v22 offset:15424
    ds_read_b64_tr_b16 v[198:199], v22 offset:16064
    s_waitcnt lgkmcnt(0)
    ds_read_b64_tr_b16 v[200:201], v22 offset:96
    ds_read_b64_tr_b16 v[202:203], v22 offset:736
    ds_read_b64_tr_b16 v[204:205], v22 offset:5216
    ds_read_b64_tr_b16 v[206:207], v22 offset:5856
    ds_read_b64_tr_b16 v[208:209], v22 offset:10336
    ds_read_b64_tr_b16 v[210:211], v22 offset:10976
    ds_read_b64_tr_b16 v[212:213], v22 offset:15456
    ds_read_b64_tr_b16 v[214:215], v22 offset:16096
    s_waitcnt lgkmcnt(0)
    ds_read_b64_tr_b16 v[216:217], v22 offset:128
    ds_read_b64_tr_b16 v[218:219], v22 offset:768
    ds_read_b64_tr_b16 v[220:221], v22 offset:5248
    ds_read_b64_tr_b16 v[222:223], v22 offset:5888
    ds_read_b64_tr_b16 v[224:225], v22 offset:10368
    ds_read_b64_tr_b16 v[226:227], v22 offset:11008
    ds_read_b64_tr_b16 v[228:229], v22 offset:15488
    ds_read_b64_tr_b16 v[230:231], v22 offset:16128
    s_waitcnt lgkmcnt(0)
    s_waitcnt vmcnt(10)
    s_barrier
    s_cmp_eq_u32 s42, 1
    s_cselect_b64 s[80:81], -1, 0
    v_cndmask_b32 v73, v68, v70, s[80:81]
    s_add_u32 s79, s84, 0
    s_add_u32 m0, s77, 0
    s_add_u32 s79, s79, s76
    buffer_load_dwordx4 v73, s[36:39], s79 offen lds
    s_add_u32 s79, s84, 16384
    s_add_u32 m0, s77, 1024
    s_add_u32 s79, s79, s76
    buffer_load_dwordx4 v73, s[36:39], s79 offen lds
    v_cndmask_b32 v73, v69, v71, s[80:81]
    s_add_u32 s79, s84, 32768
    s_add_u32 m0, s77, 2048
    s_add_u32 s79, s79, s76
    buffer_load_dwordx4 v73, s[36:39], s79 offen lds
    s_add_u32 s79, s84, 49152
    s_add_u32 m0, s77, 3072
    s_add_u32 s79, s79, s76
    buffer_load_dwordx4 v73, s[36:39], s79 offen lds
    s_cmp_eq_u32 s42, 2
    s_cselect_b64 s[80:81], -1, 0
    v_cndmask_b32 v73, v68, v70, s[80:81]
    s_add_u32 s79, s85, 0
    s_add_u32 m0, s77, 4096
    s_add_u32 s79, s79, s76
    buffer_load_dwordx4 v73, s[36:39], s79 offen lds
    s_add_u32 s79, s85, 16384
    s_add_u32 m0, s77, 5120
    s_add_u32 s79, s79, s76
    buffer_load_dwordx4 v73, s[36:39], s79 offen lds
    v_cndmask_b32 v73, v69, v71, s[80:81]
    s_add_u32 s79, s85, 32768
    s_add_u32 m0, s77, 6144
    s_add_u32 s79, s79, s76
    buffer_load_dwordx4 v73, s[36:39], s79 offen lds
    s_add_u32 s79, s85, 49152
    s_add_u32 m0, s77, 7168
    s_add_u32 s79, s79, s76
    buffer_load_dwordx4 v73, s[36:39], s79 offen lds
    s_cmp_eq_u32 s42, 3
    s_cselect_b64 s[80:81], -1, 0
    v_cndmask_b32 v73, v68, v70, s[80:81]
    s_add_u32 s79, s3, 0
    s_add_u32 m0, s77, 8192
    s_add_u32 s79, s79, s76
    buffer_load_dwordx4 v73, s[36:39], s79 offen lds
    s_add_u32 s79, s3, 16384
    s_add_u32 m0, s77, 9216
    s_add_u32 s79, s79, s76
    buffer_load_dwordx4 v73, s[36:39], s79 offen lds
    v_cndmask_b32 v73, v69, v71, s[80:81]
    s_add_u32 s79, s3, 32768
    s_add_u32 m0, s77, 10240
    s_add_u32 s79, s79, s76
    buffer_load_dwordx4 v73, s[36:39], s79 offen lds
    s_add_u32 s79, s3, 49152
    s_add_u32 m0, s77, 11264
    s_add_u32 s79, s79, s76
    buffer_load_dwordx4 v73, s[36:39], s79 offen lds
    s_mov_b32 s36, s12
    s_mov_b32 s37, s13
    s_mov_b32 s38, 5242880
    s_mov_b32 s39, 0x20000
    s_add_u32 s79, s78, 0
    s_add_u32 m0, s77, 12288
    s_add_u32 s79, s79, s75
    buffer_load_dwordx4 v68, s[36:39], s79 offen lds
    s_add_u32 s79, s78, 16384
    s_add_u32 m0, s77, 13312
    s_add_u32 s79, s79, s75
    buffer_load_dwordx4 v68, s[36:39], s79 offen lds
    s_add_u32 s79, s78, 32768
    s_add_u32 m0, s77, 14336
    s_add_u32 s79, s79, s75
    buffer_load_dwordx4 v69, s[36:39], s79 offen lds
    s_add_u32 s79, s78, 49152
    s_add_u32 m0, s77, 15360
    s_add_u32 s79, s79, s75
    buffer_load_dwordx4 v69, s[36:39], s79 offen lds
    s_cmp_eq_u32 s42, 0
    s_cselect_b64 s[80:81], -1, 0
    v_cndmask_b32 v73, v68, v70, s[80:81]
    s_add_u32 s79, s83, 0
    s_add_u32 m0, s77, 16384
    s_add_u32 s79, s79, s75
    buffer_load_dwordx4 v73, s[36:39], s79 offen lds
    s_add_u32 s79, s83, 16384
    s_add_u32 m0, s77, 17408
    s_add_u32 s79, s79, s75
    buffer_load_dwordx4 v73, s[36:39], s79 offen lds
    v_cndmask_b32 v73, v69, v71, s[80:81]
    s_add_u32 s79, s83, 32768
    s_add_u32 m0, s77, 18432
    s_add_u32 s79, s79, s75
    buffer_load_dwordx4 v73, s[36:39], s79 offen lds
    s_add_u32 s79, s83, 49152
    s_add_u32 m0, s77, 19456
    s_add_u32 s79, s79, s75
    buffer_load_dwordx4 v73, s[36:39], s79 offen lds
    ds_read_b64_tr_b16 a[64:65], v23 offset:20480
    ds_read_b64_tr_b16 a[66:67], v23 offset:21504
    ds_read_b64_tr_b16 a[68:69], v74 offset:20480
    ds_read_b64_tr_b16 a[70:71], v74 offset:21504
    ds_read_b64_tr_b16 a[72:73], v24 offset:20480
    ds_read_b64_tr_b16 a[74:75], v24 offset:21504
    ds_read_b64_tr_b16 a[76:77], v75 offset:20480
    ds_read_b64_tr_b16 a[78:79], v75 offset:21504
    s_waitcnt lgkmcnt(0)
    s_waitcnt vmcnt(26)
    s_barrier
    s_cmp_eq_u32 s42, 1
    s_cselect_b64 s[80:81], -1, 0
    v_cndmask_b32 v73, v68, v70, s[80:81]
    s_add_u32 s79, s84, 0
    s_add_u32 m0, s77, 20480
    s_add_u32 s79, s79, s75
    buffer_load_dwordx4 v73, s[36:39], s79 offen lds
    s_add_u32 s79, s84, 16384
    s_add_u32 m0, s77, 21504
    s_add_u32 s79, s79, s75
    buffer_load_dwordx4 v73, s[36:39], s79 offen lds
    v_cndmask_b32 v73, v69, v71, s[80:81]
    s_add_u32 s79, s84, 32768
    s_add_u32 m0, s77, 22528
    s_add_u32 s79, s79, s75
    buffer_load_dwordx4 v73, s[36:39], s79 offen lds
    s_add_u32 s79, s84, 49152
    s_add_u32 m0, s77, 23552
    s_add_u32 s79, s79, s75
    buffer_load_dwordx4 v73, s[36:39], s79 offen lds
    ds_read_b64_tr_b16 a[80:81], v23 offset:24576
    ds_read_b64_tr_b16 a[82:83], v23 offset:25600
    ds_read_b64_tr_b16 a[84:85], v74 offset:24576
    ds_read_b64_tr_b16 a[86:87], v74 offset:25600
    ds_read_b64_tr_b16 a[88:89], v24 offset:24576
    ds_read_b64_tr_b16 a[90:91], v24 offset:25600
    ds_read_b64_tr_b16 a[92:93], v75 offset:24576
    ds_read_b64_tr_b16 a[94:95], v75 offset:25600
    s_waitcnt lgkmcnt(0)
    s_waitcnt vmcnt(26)
    s_barrier
    s_cmp_eq_u32 s42, 2
    s_cselect_b64 s[80:81], -1, 0
    v_cndmask_b32 v73, v68, v70, s[80:81]
    s_add_u32 s79, s85, 0
    s_add_u32 m0, s77, 24576
    s_add_u32 s79, s79, s75
    buffer_load_dwordx4 v73, s[36:39], s79 offen lds
    s_add_u32 s79, s85, 16384
    s_add_u32 m0, s77, 25600
    s_add_u32 s79, s79, s75
    buffer_load_dwordx4 v73, s[36:39], s79 offen lds
    v_cndmask_b32 v73, v69, v71, s[80:81]
    s_add_u32 s79, s85, 32768
    s_add_u32 m0, s77, 26624
    s_add_u32 s79, s79, s75
    buffer_load_dwordx4 v73, s[36:39], s79 offen lds
    s_add_u32 s79, s85, 49152
    s_add_u32 m0, s77, 27648
    s_add_u32 s79, s79, s75
    buffer_load_dwordx4 v73, s[36:39], s79 offen lds
    ds_read_b64_tr_b16 a[96:97], v23 offset:28672
    ds_read_b64_tr_b16 a[98:99], v23 offset:29696
    ds_read_b64_tr_b16 a[100:101], v74 offset:28672
    ds_read_b64_tr_b16 a[102:103], v74 offset:29696
    ds_read_b64_tr_b16 a[104:105], v24 offset:28672
    ds_read_b64_tr_b16 a[106:107], v24 offset:29696
    ds_read_b64_tr_b16 a[108:109], v75 offset:28672
    ds_read_b64_tr_b16 a[110:111], v75 offset:29696
    s_waitcnt lgkmcnt(0)
    s_waitcnt vmcnt(24)
    s_barrier
    s_cmp_eq_u32 s42, 3
    s_cselect_b64 s[80:81], -1, 0
    v_cndmask_b32 v73, v68, v70, s[80:81]
    s_add_u32 s79, s3, 0
    s_add_u32 m0, s77, 28672
    s_add_u32 s79, s79, s75
    buffer_load_dwordx4 v73, s[36:39], s79 offen lds
    s_add_u32 s79, s3, 16384
    s_add_u32 m0, s77, 29696
    s_add_u32 s79, s79, s75
    buffer_load_dwordx4 v73, s[36:39], s79 offen lds
    v_cndmask_b32 v73, v69, v71, s[80:81]
    s_add_u32 s79, s3, 32768
    s_add_u32 m0, s77, 30720
    s_add_u32 s79, s79, s75
    buffer_load_dwordx4 v73, s[36:39], s79 offen lds
    s_add_u32 s79, s3, 49152
    s_add_u32 m0, s77, 31744
    s_add_u32 s79, s79, s75
    buffer_load_dwordx4 v73, s[36:39], s79 offen lds
    ds_read_b64_tr_b16 a[112:113], v23 offset:0
    ds_read_b64_tr_b16 a[114:115], v23 offset:1024
    ds_read_b64_tr_b16 a[116:117], v74 offset:0
    ds_read_b64_tr_b16 a[118:119], v74 offset:1024
    ds_read_b64_tr_b16 a[120:121], v24 offset:0
    ds_read_b64_tr_b16 a[122:123], v24 offset:1024
    ds_read_b64_tr_b16 a[124:125], v75 offset:0
    ds_read_b64_tr_b16 a[126:127], v75 offset:1024
    s_waitcnt lgkmcnt(0)
L_ch_team:
    v_readfirstlane_b32 s70, v26
    v_readfirstlane_b32 s71, v27
    s_cmp_lt_u32 s70, 64
    s_cbranch_scc1 L_ch_team_w
    s_cmp_eq_u32 s71, 0
    s_cbranch_scc1 L_ch_team_w
    s_sub_u32 s71, s71, 1
    s_lshl_b32 s71, s71, 13
    s_add_u32 s47, s47, s71
    s_add_u32 s45, s45, s71
    v_and_b32 v32, 31, v16
    v_lshlrev_b32 v32, 2, v32
    s_lshl_b32 s71, s40, 7
    s_add_u32 s71, s71, 95813632
    buffer_load_dword v26, v32, s[32:35], s71 offen sc1
    s_cmp_ge_u32 s53, 40
    s_cbranch_scc1 L_ch_nom0
    v_min_u32 v28, -2, v28
    v_min_u32 v29, -2, v29
    s_mov_b64 exec, s[58:59]
    buffer_store_dwordx2 v[28:29], v2, s[32:35], s44 offen sc1
    buffer_store_dwordx2 v[28:29], v2, s[32:35], s47 offen sc1
    s_mov_b64 exec, -1
L_ch_nom0:
    s_waitcnt vmcnt(25)
    s_barrier
    s_add_u32 s79, s78, 0
    s_add_u32 m0, s77, 0
    s_add_u32 s79, s79, s76
    buffer_load_dwordx4 v68, s[36:39], s79 offen lds
    s_add_u32 s79, s78, 16384
    s_add_u32 m0, s77, 1024
    s_add_u32 s79, s79, s76
    buffer_load_dwordx4 v68, s[36:39], s79 offen lds
    s_add_u32 s79, s78, 32768
    s_add_u32 m0, s77, 2048
    s_add_u32 s79, s79, s76
    buffer_load_dwordx4 v69, s[36:39], s79 offen lds
    s_add_u32 s79, s78, 49152
    s_add_u32 m0, s77, 3072
    s_add_u32 s79, s79, s76
    buffer_load_dwordx4 v69, s[36:39], s79 offen lds
    ds_read_b64_tr_b16 a[128:129], v23 offset:4096
    ds_read_b64_tr_b16 a[130:131], v23 offset:5120
    ds_read_b64_tr_b16 a[132:133], v74 offset:4096
    ds_read_b64_tr_b16 a[134:135], v74 offset:5120
    ds_read_b64_tr_b16 a[136:137], v24 offset:4096
    ds_read_b64_tr_b16 a[138:139], v24 offset:5120
    ds_read_b64_tr_b16 a[140:141], v75 offset:4096
    ds_read_b64_tr_b16 a[142:143], v75 offset:5120
    s_waitcnt lgkmcnt(0)
    s_waitcnt vmcnt(25)
    s_barrier
    s_cmp_eq_u32 s42, 0
    s_cselect_b64 s[80:81], -1, 0
    v_cndmask_b32 v73, v68, v70, s[80:81]
    s_add_u32 s79, s83, 0
    s_add_u32 m0, s77, 4096
    s_add_u32 s79, s79, s76
    buffer_load_dwordx4 v73, s[36:39], s79 offen lds
    s_add_u32 s79, s83, 16384
    s_add_u32 m0, s77, 5120
    s_add_u32 s79, s79, s76
    buffer_load_dwordx4 v73, s[36:39], s79 offen lds
    v_cndmask_b32 v73, v69, v71, s[80:81]
    s_add_u32 s79, s83, 32768
    s_add_u32 m0, s77, 6144
    s_add_u32 s79, s79, s76
    buffer_load_dwordx4 v73, s[36:39], s79 offen lds
    s_add_u32 s79, s83, 49152
    s_add_u32 m0, s77, 7168
    s_add_u32 s79, s79, s76
    buffer_load_dwordx4 v73, s[36:39], s79 offen lds
    ds_read_b64_tr_b16 a[144:145], v23 offset:8192
    ds_read_b64_tr_b16 a[146:147], v23 offset:9216
    ds_read_b64_tr_b16 a[148:149], v74 offset:8192
    ds_read_b64_tr_b16 a[150:151], v74 offset:9216
    ds_read_b64_tr_b16 a[152:153], v24 offset:8192
    ds_read_b64_tr_b16 a[154:155], v24 offset:9216
    ds_read_b64_tr_b16 a[156:157], v75 offset:8192
    ds_read_b64_tr_b16 a[158:159], v75 offset:9216
    s_waitcnt lgkmcnt(0)
    s_waitcnt vmcnt(25)
    s_barrier
    s_cmp_eq_u32 s42, 1
    s_cselect_b64 s[80:81], -1, 0
    v_cndmask_b32 v73, v68, v70, s[80:81]
    s_add_u32 s79, s84, 0
    s_add_u32 m0, s77, 8192
    s_add_u32 s79, s79, s76
    buffer_load_dwordx4 v73, s[36:39], s79 offen lds
    s_add_u32 s79, s84, 16384
    s_add_u32 m0, s77, 9216
    s_add_u32 s79, s79, s76
    buffer_load_dwordx4 v73, s[36:39], s79 offen lds
    v_cndmask_b32 v73, v69, v71, s[80:81]
    s_add_u32 s79, s84, 32768
    s_add_u32 m0, s77, 10240
    s_add_u32 s79, s79, s76
    buffer_load_dwordx4 v73, s[36:39], s79 offen lds
    s_add_u32 s79, s84, 49152
    s_add_u32 m0, s77, 11264
    s_add_u32 s79, s79, s76
    buffer_load_dwordx4 v73, s[36:39], s79 offen lds
    ds_read_b64_tr_b16 v[52:53], v23 offset:12288
    ds_read_b64_tr_b16 v[54:55], v23 offset:13312
    ds_read_b64_tr_b16 v[56:57], v74 offset:12288
    ds_read_b64_tr_b16 v[58:59], v74 offset:13312
    ds_read_b64_tr_b16 v[60:61], v24 offset:12288
    ds_read_b64_tr_b16 v[62:63], v24 offset:13312
    ds_read_b64_tr_b16 v[64:65], v75 offset:12288
    ds_read_b64_tr_b16 v[66:67], v75 offset:13312
    s_waitcnt lgkmcnt(0)
    s_waitcnt vmcnt(25)
    s_barrier
    ds_write_b128 v9, v[52:55] offset:12288
    ds_write_b128 v9, v[56:59] offset:13312
    ds_write_b128 v9, v[60:63] offset:14336
    ds_write_b128 v9, v[64:67] offset:15360
    ds_read_b64_tr_b16 v[36:37], v23 offset:16384
    ds_read_b64_tr_b16 v[38:39], v23 offset:17408
    ds_read_b64_tr_b16 v[40:41], v74 offset:16384
    ds_read_b64_tr_b16 v[42:43], v74 offset:17408
    ds_read_b64_tr_b16 v[44:45], v24 offset:16384
    ds_read_b64_tr_b16 v[46:47], v24 offset:17408
    ds_read_b64_tr_b16 v[48:49], v75 offset:16384
    ds_read_b64_tr_b16 v[50:51], v75 offset:17408
    s_waitcnt lgkmcnt(0)
    s_waitcnt vmcnt(21)
    s_barrier
    ds_write_b128 v9, v[36:39] offset:16384
    ds_write_b128 v9, v[40:43] offset:17408
    ds_write_b128 v9, v[44:47] offset:18432
    ds_write_b128 v9, v[48:51] offset:19456
    ds_read_b64_tr_b16 v[52:53], v23 offset:20480
    ds_read_b64_tr_b16 v[54:55], v23 offset:21504
    ds_read_b64_tr_b16 v[56:57], v74 offset:20480
    ds_read_b64_tr_b16 v[58:59], v74 offset:21504
    ds_read_b64_tr_b16 v[60:61], v24 offset:20480
    ds_read_b64_tr_b16 v[62:63], v24 offset:21504
    ds_read_b64_tr_b16 v[64:65], v75 offset:20480
    ds_read_b64_tr_b16 v[66:67], v75 offset:21504
    s_waitcnt lgkmcnt(0)
    s_waitcnt vmcnt(17)
    s_barrier
    ds_write_b128 v9, v[52:55] offset:20480
    ds_write_b128 v9, v[56:59] offset:21504
    ds_write_b128 v9, v[60:63] offset:22528
    ds_write_b128 v9, v[64:67] offset:23552
    ds_read_b64_tr_b16 v[36:37], v23 offset:24576
    ds_read_b64_tr_b16 v[38:39], v23 offset:25600
    ds_read_b64_tr_b16 v[40:41], v74 offset:24576
    ds_read_b64_tr_b16 v[42:43], v74 offset:25600
    ds_read_b64_tr_b16 v[44:45], v24 offset:24576
    ds_read_b64_tr_b16 v[46:47], v24 offset:25600
    ds_read_b64_tr_b16 v[48:49], v75 offset:24576
    ds_read_b64_tr_b16 v[50:51], v75 offset:25600
    s_waitcnt lgkmcnt(0)
    s_waitcnt vmcnt(13)
    s_barrier
    ds_write_b128 v9, v[36:39] offset:24576
    ds_write_b128 v9, v[40:43] offset:25600
    ds_write_b128 v9, v[44:47] offset:26624
    ds_write_b128 v9, v[48:51] offset:27648
    ds_read_b64_tr_b16 v[52:53], v23 offset:28672
    ds_read_b64_tr_b16 v[54:55], v23 offset:29696
    ds_read_b64_tr_b16 v[56:57], v74 offset:28672
    ds_read_b64_tr_b16 v[58:59], v74 offset:29696
    ds_read_b64_tr_b16 v[60:61], v24 offset:28672
    ds_read_b64_tr_b16 v[62:63], v24 offset:29696
    ds_read_b64_tr_b16 v[64:65], v75 offset:28672
    ds_read_b64_tr_b16 v[66:67], v75 offset:29696
    s_waitcnt lgkmcnt(0)
    s_waitcnt vmcnt(8)
    s_barrier
    ds_write_b128 v9, v[52:55] offset:28672
    ds_write_b128 v9, v[56:59] offset:29696
    ds_write_b128 v9, v[60:63] offset:30720
    ds_write_b128 v9, v[64:67] offset:31744
    ds_read_b64_tr_b16 v[36:37], v23 offset:0
    ds_read_b64_tr_b16 v[38:39], v23 offset:1024
    ds_read_b64_tr_b16 v[40:41], v74 offset:0
    ds_read_b64_tr_b16 v[42:43], v74 offset:1024
    ds_read_b64_tr_b16 v[44:45], v24 offset:0
    ds_read_b64_tr_b16 v[46:47], v24 offset:1024
    ds_read_b64_tr_b16 v[48:49], v75 offset:0
    ds_read_b64_tr_b16 v[50:51], v75 offset:1024
    s_waitcnt lgkmcnt(0)
    s_waitcnt vmcnt(4)
    s_barrier
    ds_write_b128 v9, v[36:39] offset:0
    ds_write_b128 v9, v[40:43] offset:1024
    ds_write_b128 v9, v[44:47] offset:2048
    ds_write_b128 v9, v[48:51] offset:3072
    ds_read_b64_tr_b16 v[52:53], v23 offset:4096
    ds_read_b64_tr_b16 v[54:55], v23 offset:5120
    ds_read_b64_tr_b16 v[56:57], v74 offset:4096
    ds_read_b64_tr_b16 v[58:59], v74 offset:5120
    ds_read_b64_tr_b16 v[60:61], v24 offset:4096
    ds_read_b64_tr_b16 v[62:63], v24 offset:5120
    ds_read_b64_tr_b16 v[64:65], v75 offset:4096
    ds_read_b64_tr_b16 v[66:67], v75 offset:5120
    s_waitcnt lgkmcnt(0)
    buffer_load_dword v33, v3, s[32:35], s44 offen sc1
    buffer_load_dword v33, v3, s[32:35], s45 offen sc1
    buffer_load_dword v33, v4, s[32:35], s44 offen sc1
    buffer_load_dword v33, v4, s[32:35], s45 offen sc1
    s_getreg_b32 s70, hwreg(HW_REG_XCC_ID)
    s_and_b32 s70, s70, 15
    v_cmp_ne_u32 vcc, s70, v26
    s_nop 0
    s_cmp_lg_u64 vcc, 0
    s_cselect_b32 s52, 1, 0
    s_waitcnt vmcnt(0)
    s_barrier
    ds_write_b128 v9, v[52:55] offset:4096
    ds_write_b128 v9, v[56:59] offset:5120
    ds_write_b128 v9, v[60:63] offset:6144
    ds_write_b128 v9, v[64:67] offset:7168
    ds_read_b64_tr_b16 v[36:37], v23 offset:8192
    ds_read_b64_tr_b16 v[38:39], v23 offset:9216
    ds_read_b64_tr_b16 v[40:41], v74 offset:8192
    ds_read_b64_tr_b16 v[42:43], v74 offset:9216
    ds_read_b64_tr_b16 v[44:45], v24 offset:8192
    ds_read_b64_tr_b16 v[46:47], v24 offset:9216
    ds_read_b64_tr_b16 v[48:49], v75 offset:8192
    ds_read_b64_tr_b16 v[50:51], v75 offset:9216
    s_waitcnt lgkmcnt(0)
    s_barrier
    ds_write_b128 v9, v[36:39] offset:8192
    ds_write_b128 v9, v[40:43] offset:9216
    ds_write_b128 v9, v[44:47] offset:10240
    ds_write_b128 v9, v[48:51] offset:11264
    s_mul_i32 s70, s41, 24576
    s_lshl_b32 s71, s42, 11
    s_lshl_b32 s87, s42, 12
    s_add_u32 s62, s70, 4194304
    s_add_u32 s70, s70, s71
    s_add_u32 s63, s70, 4202496
    s_add_u32 s46, s44, 8192
    s_add_u32 s47, s47, 32768
    s_lshl_b32 s70, s41, 2
    s_add_u32 s70, s70, s42
    s_lshl_b32 s70, s70, 10
    s_add_u32 s64, s70, 79560704
    v_mov_b32 v17, 0
    v_mov_b32 v18, 0
    s_mov_b32 s69, 95830016
    v_bfe_u32 v14, v8, 4, 3
    v_lshlrev_b32 v14, 7, v14
L_ch_kv0:
    buffer_load_dword v15, v14, s[32:35], s69 offen sc1
    s_waitcnt vmcnt(0)
    v_add_u32_dpp v15, v15, v15 row_shr:1 row_mask:0xf bank_mask:0xf bound_ctrl:0
    s_nop 1
    v_add_u32_dpp v15, v15, v15 row_shr:2 row_mask:0xf bank_mask:0xf bound_ctrl:0
    s_nop 1
    v_add_u32_dpp v15, v15, v15 row_shr:4 row_mask:0xf bank_mask:0xf bound_ctrl:0
    s_nop 0
    v_readlane_b32 s70, v15, 7
    s_nop 0
    s_cmp_ge_u32 s70, 128
    s_cbranch_scc1 L_ch_kv0d
    s_sleep 2
    s_sub_u32 s65, s65, 1
    s_cbranch_scc1 L_ch_abort
    s_branch L_ch_kv0
L_ch_kv0d:
    s_add_u32 s50, s71, 16384
    s_add_u32 s71, s87, s62
    v_lshlrev_b32 v33, 2, v8
    s_waitcnt vmcnt(0)
    buffer_load_dword v5, v33, s[32:35], s71 offen sc1
    s_add_u32 s62, s62, 786432
    s_add_u32 s63, s63, 786432
    s_add_u32 s87, s87, s62
    s_add_u32 s49, s44, 16384
    s_cmp_eq_u32 s42, 3
    s_cselect_b32 s38, 1, 0
    s_mov_b32 s39, 0
    s_and_b32 s90, s41, 3
    s_cmp_lt_u32 s53, 32
    s_cselect_b32 s58, 0xff, s58
    s_mul_i32 s91, s42, 1280
    s_add_u32 s91, s91, 5120
    s_sub_u32 s88, 0, s40
    s_mov_b32 s89, s88
    s_mov_b32 s36, 0x3f803f80
    s_mov_b32 s37, 0x3f803f80
    s_waitcnt lgkmcnt(0)
    s_barrier
    v_mov_b64 v[36:37], 0
    v_mov_b64 v[38:39], 0
    v_mov_b64 v[40:41], 0
    v_mov_b64 v[42:43], 0
    v_mov_b64 v[44:45], 0
    v_mov_b64 v[46:47], 0
    v_mov_b64 v[48:49], 0
    v_mov_b64 v[50:51], 0
    s_mov_b32 s80, s30
    s_mov_b32 s81, s31
    s_mov_b32 s82, 98631680
    s_mov_b32 s83, 0x20000
    s_mov_b32 s24, s30
    s_mov_b32 s25, s31
    s_mov_b32 s26, 0
    s_mov_b32 s27, 0x20000
    s_mov_b32 s23, s38
    s_cmp_eq_u32 s52, 0
    s_cbranch_scc0 L_ch_slow
    s_cmp_eq_u32 s40, 0
    s_cbranch_scc0 L_ch_step_f1
    s_branch L_ch_step_f0
L_ch_step_f0:
    s_sleep 1
    buffer_load_dwordx4 v[80:83], v3, s[32:35], s44 offen sc1
    buffer_load_dword v84, v4, s[32:35], s44 offen sc1
    s_add_u32 m0, s50, 0
    s_sub_u32 s70, s63, 794624
    buffer_load_dwordx4 v8, s[32:35], s70 offen sc1 lds
    buffer_load_dwordx4 v8, s[32:35], s70 offen offset:1024 sc1 lds
    ds_read_b128 v[64:67], v9 offset:12288
    ds_read_b128 v[68:71], v9 offset:13312
    buffer_load_dwordx4 v[60:63], v3, s[32:35], s44 offen sc1
    buffer_load_dword v85, v4, s[32:35], s44 offen sc1
    ds_read_b128 v[72:75], v9 offset:14336
    ds_read_b128 v[76:79], v9 offset:15360
    v_lshlrev_b32 v11, 2, v8
    s_sub_u32 s72, s63, 786432
    s_waitcnt vmcnt(4)
    ds_write_b128 v3, v[80:83] offset:0
    ds_write_b32 v4, v84 offset:0
    v_max3_u32 v16, v80, v82, v84
    v_cmp_eq_u32 vcc, s74, v16
    v_mov_b64 v[28:29], 0
    v_mov_b64 v[30:31], 0
    v_mov_b64 v[32:33], 0
    v_mov_b64 v[34:35], 0
    s_cbranch_vccnz L_ch_lbf0
L_ch_lcf0:
    buffer_load_dwordx4 v[12:15], v3, s[32:35], s45 offen sc1
    buffer_load_dword v19, v4, s[32:35], s45 offen sc1
    buffer_load_dwordx4 v[20:23], v8, s[32:35], s72 offen sc1
    s_waitcnt lgkmcnt(0)
    s_barrier
    ds_read_b128 v[52:55], v8 offset:0
    buffer_load_dwordx4 v[24:27], v8, s[32:35], s72 offen offset:1024 sc1
    s_waitcnt lgkmcnt(0)
    v_smfmac_f32_16x16x64_bf16 v[28:31], v[52:55], v[64:71], v10
    s_waitcnt vmcnt(4)
    ds_read_b128 v[80:83], v9 offset:16384
    v_smfmac_f32_16x16x64_bf16 v[36:39], v[52:55], a[0:7], v10
    ds_read_b128 v[60:63], v8 offset:1024
    ds_read_b128 v[84:87], v9 offset:17408
    v_smfmac_f32_16x16x64_bf16 v[40:43], v[52:55], a[160:167], v10
    ds_read_b128 v[64:67], v9 offset:18432
    v_smfmac_f32_16x16x64_bf16 v[32:35], v[52:55], v[72:79], v10
    ds_read_b128 v[68:71], v9 offset:19456
    v_smfmac_f32_16x16x64_bf16 v[44:47], v[52:55], a[8:15], v10
    ds_read_b128 v[72:75], v9 offset:20480
    v_smfmac_f32_16x16x64_bf16 v[48:51], v[52:55], a[168:175], v10
    ds_read_b128 v[76:79], v9 offset:21504
    s_waitcnt lgkmcnt(4)
    v_smfmac_f32_16x16x64_bf16 v[28:31], v[60:63], v[80:87], v10
    ds_read_b128 v[52:55], v8 offset:2048
    v_smfmac_f32_16x16x64_bf16 v[36:39], v[60:63], a[16:23], v10
    ds_read_b128 v[80:83], v9 offset:22528
    v_smfmac_f32_16x16x64_bf16 v[40:43], v[60:63], a[176:183], v10
    ds_read_b128 v[84:87], v9 offset:23552
    s_waitcnt lgkmcnt(5)
    v_smfmac_f32_16x16x64_bf16 v[32:35], v[60:63], v[64:71], v10
    ds_read_b128 v[64:67], v9 offset:24576
    v_smfmac_f32_16x16x64_bf16 v[44:47], v[60:63], a[24:31], v10
    ds_read_b128 v[68:71], v9 offset:25600
    v_smfmac_f32_16x16x64_bf16 v[48:51], v[60:63], a[184:191], v10
    s_waitcnt lgkmcnt(4)
    v_smfmac_f32_16x16x64_bf16 v[28:31], v[52:55], v[72:79], v10
    ds_read_b128 v[60:63], v8 offset:3072
    v_smfmac_f32_16x16x64_bf16 v[36:39], v[52:55], a[32:39], v10
    ds_read_b128 v[72:75], v9 offset:26624
    v_smfmac_f32_16x16x64_bf16 v[40:43], v[52:55], a[192:199], v10
    ds_read_b128 v[76:79], v9 offset:27648
    s_waitcnt lgkmcnt(5)
    v_smfmac_f32_16x16x64_bf16 v[32:35], v[52:55], v[80:87], v10
    ds_read_b128 v[80:83], v9 offset:28672
    v_smfmac_f32_16x16x64_bf16 v[44:47], v[52:55], a[40:47], v10
    ds_read_b128 v[84:87], v9 offset:29696
    v_smfmac_f32_16x16x64_bf16 v[48:51], v[52:55], a[200:207], v10
    s_waitcnt vmcnt(2)
    ds_write_b128 v3, v[12:15] offset:5120
    s_waitcnt lgkmcnt(5)
    v_smfmac_f32_16x16x64_bf16 v[28:31], v[60:63], v[64:71], v10
    ds_write_b32 v4, v19 offset:5120
    v_smfmac_f32_16x16x64_bf16 v[36:39], v[60:63], a[48:55], v10
    v_max3_u32 v16, v12, v14, v19
    ds_read_b128 v[52:55], v8 offset:4096
    v_smfmac_f32_16x16x64_bf16 v[40:43], v[60:63], a[208:215], v10
    v_cmp_eq_u32 vcc, s74, v16
    s_waitcnt lgkmcnt(5)
    v_smfmac_f32_16x16x64_bf16 v[32:35], v[60:63], v[72:79], v10
    ds_read_b128 v[64:67], v9 offset:30720
    v_smfmac_f32_16x16x64_bf16 v[44:47], v[60:63], a[56:63], v10
    s_cbranch_vccnz L_ch_rrf0
L_ch_rokf0:
    s_waitcnt lgkmcnt(2)
    s_barrier
    ds_read_b128 v[68:71], v9 offset:31744
    v_smfmac_f32_16x16x64_bf16 v[48:51], v[60:63], a[216:223], v10
    ds_read_b128 v[72:75], v9 offset:0
    s_waitcnt lgkmcnt(3)
    v_smfmac_f32_16x16x64_bf16 v[28:31], v[52:55], v[80:87], v10
    ds_read_b128 v[60:63], v8 offset:5120
    v_smfmac_f32_16x16x64_bf16 v[36:39], v[52:55], a[64:71], v10
    s_waitcnt vmcnt(0)
    buffer_load_dword v11, v11, s[80:83], s87 offen sc1
    ds_read_b128 v[76:79], v9 offset:1024
    v_smfmac_f32_16x16x64_bf16 v[40:43], v[52:55], a[224:231], v10
    ds_read_b128 v[80:83], v9 offset:2048
    s_waitcnt lgkmcnt(4)
    v_smfmac_f32_16x16x64_bf16 v[32:35], v[52:55], v[64:71], v10
    ds_read_b128 v[84:87], v9 offset:3072
    v_smfmac_f32_16x16x64_bf16 v[44:47], v[52:55], a[72:79], v10
    ds_read_b128 v[64:67], v9 offset:4096
    v_smfmac_f32_16x16x64_bf16 v[48:51], v[52:55], a[232:239], v10
    ds_read_b128 v[68:71], v9 offset:5120
    s_waitcnt lgkmcnt(4)
    v_smfmac_f32_16x16x64_bf16 v[28:31], v[60:63], v[72:79], v10
    ds_read_b128 v[52:55], v8 offset:6144
    v_smfmac_f32_16x16x64_bf16 v[36:39], v[60:63], a[80:87], v10
    buffer_store_dwordx4 v[56:59], v8, s[32:35], s64 offen sc1
    v_smfmac_f32_16x16x64_bf16 v[40:43], v[60:63], a[240:247], v10
    ds_read_b128 v[72:75], v9 offset:6144
    s_waitcnt lgkmcnt(4)
    v_smfmac_f32_16x16x64_bf16 v[32:35], v[60:63], v[80:87], v10
    ds_read_b128 v[76:79], v9 offset:7168
    v_smfmac_f32_16x16x64_bf16 v[44:47], v[60:63], a[88:95], v10
    ds_read_b128 v[80:83], v9 offset:8192
    v_smfmac_f32_16x16x64_bf16 v[48:51], v[60:63], a[248:255], v10
    ds_read_b128 v[84:87], v9 offset:9216
    s_waitcnt lgkmcnt(4)
    v_smfmac_f32_16x16x64_bf16 v[28:31], v[52:55], v[64:71], v10
    ds_read_b128 v[60:63], v8 offset:7168
    v_smfmac_f32_16x16x64_bf16 v[36:39], v[52:55], a[96:103], v10
    ds_read_b128 v[64:67], v9 offset:10240
    v_smfmac_f32_16x16x64_bf16 v[40:43], v[52:55], v[88:95], v10
    ds_read_b128 v[68:71], v9 offset:11264
    s_waitcnt lgkmcnt(5)
    v_smfmac_f32_16x16x64_bf16 v[32:35], v[52:55], v[72:79], v10
    ds_read_b128 v[72:75], v9 offset:32768
    v_smfmac_f32_16x16x64_bf16 v[44:47], v[52:55], a[104:111], v10
    ds_read_b128 v[76:79], v9 offset:33792
    v_smfmac_f32_16x16x64_bf16 v[48:51], v[52:55], v[96:103], v10
    s_waitcnt lgkmcnt(4)
    v_smfmac_f32_16x16x64_bf16 v[28:31], v[60:63], v[80:87], v10
    ds_read_b128 v[52:55], v8 offset:8192
    v_smfmac_f32_16x16x64_bf16 v[36:39], v[60:63], a[112:119], v10
    ds_read_b128 v[80:83], v8 offset:9216
    v_smfmac_f32_16x16x64_bf16 v[40:43], v[60:63], v[104:111], v10
    s_waitcnt lgkmcnt(4)
    v_smfmac_f32_16x16x64_bf16 v[32:35], v[60:63], v[64:71], v10
    ds_read_b128 v[64:67], v8 offset:18432
    v_smfmac_f32_16x16x64_bf16 v[44:47], v[60:63], a[120:127], v10
    v_bfe_u32 v14, v8, 4, 3
    v_lshlrev_b32 v14, 7, v14
    v_smfmac_f32_16x16x64_bf16 v[48:51], v[60:63], v[112:119], v10
    buffer_load_dword v15, v14, s[24:27], s69 offen sc1
    s_waitcnt lgkmcnt(2)
    v_smfmac_f32_16x16x64_bf16 v[36:39], v[52:55], a[128:135], v10
    v_mov_b32 v16, s43
    v_smfmac_f32_16x16x64_bf16 v[40:43], v[52:55], v[120:127], v10
    ds_read_b128 v[60:63], v8 offset:16384
    v_smfmac_f32_16x16x64_bf16 v[44:47], v[52:55], a[136:143], v10
    ds_read_b128 v[84:87], v8 offset:17408
    v_smfmac_f32_16x16x64_bf16 v[48:51], v[52:55], v[128:135], v10
    ds_read_b128 v[68:71], v8 offset:19456
    s_waitcnt lgkmcnt(4)
    v_smfmac_f32_16x16x64_bf16 v[36:39], v[80:83], a[144:151], v10
    s_mov_b64 exec, s[38:39]
    buffer_store_dword v16, v17, s[32:35], s68 offen sc1
    s_mov_b64 exec, -1
    v_smfmac_f32_16x16x64_bf16 v[40:43], v[80:83], v[136:143], v10
    v_xor_b32 v12, 128, v6
    v_smfmac_f32_16x16x64_bf16 v[44:47], v[80:83], a[152:159], v10
    v_xor_b32 v13, 128, v7
    v_smfmac_f32_16x16x64_bf16 v[48:51], v[80:83], v[144:151], v10
    v_pk_add_f32 v[36:37], v[36:37], v[38:39]
    v_smfmac_f32_16x16x64_bf16 v[32:35], v[52:55], v[232:239], v10
    v_pk_add_f32 v[40:41], v[40:41], v[42:43]
    v_cvt_pk_bf16_f32 v38, v36, v37
    v_cvt_pk_bf16_f32 v39, v40, v41
    ds_write_b64 v6, v[38:39]
    v_pk_add_f32 v[44:45], v[44:45], v[46:47]
    v_pk_add_f32 v[48:49], v[48:49], v[50:51]
    v_cvt_pk_bf16_f32 v46, v44, v45
    v_cvt_pk_bf16_f32 v47, v48, v49
    ds_write_b64 v12, v[46:47]
    v_smfmac_f32_16x16x64_bf16 v[28:31], v[52:55], v[72:79], v10
    v_smfmac_f32_16x16x64_bf16 v[32:35], v[80:83], v[248:255], v10
    v_mov_b32 v58, v39
    v_mov_b32 v59, v47
    s_cmp_eq_u32 s43, 63
    s_cbranch_scc1 L_ch_lastf0
    s_waitcnt lgkmcnt(0)
    s_barrier
    ds_read_b64_tr_b16 v[48:49], v7 offset:0
    ds_read_b64_tr_b16 v[50:51], v13 offset:0
    ds_read_b64_tr_b16 v[72:73], v7 offset:256
    ds_read_b64_tr_b16 v[74:75], v13 offset:256
    v_smfmac_f32_16x16x64_bf16 v[28:31], v[80:83], v[240:247], v10
    s_waitcnt lgkmcnt(2)
    v_mfma_f32_16x16x32_bf16 v[36:39], v[60:63], v[48:51], 0
    ds_read_b128 v[60:63], v8 offset:20480
    v_mfma_f32_16x16x32_bf16 v[40:43], v[84:87], v[48:51], 0
    ds_read_b128 v[84:87], v8 offset:21504
    v_mfma_f32_16x16x32_bf16 v[44:47], v[48:51], v[48:51], 0
    ds_read_b64_tr_b16 v[48:49], v7 offset:512
    ds_read_b64_tr_b16 v[50:51], v13 offset:512
    s_waitcnt lgkmcnt(4)
    v_mfma_f32_16x16x32_bf16 v[36:39], v[64:67], v[72:75], v[36:39]
    ds_read_b128 v[64:67], v8 offset:22528
    v_mfma_f32_16x16x32_bf16 v[40:43], v[68:71], v[72:75], v[40:43]
    ds_read_b128 v[68:71], v8 offset:23552
    v_mfma_f32_16x16x32_bf16 v[44:47], v[72:75], v[72:75], v[44:47]
    ds_read_b64_tr_b16 v[72:73], v7 offset:768
    ds_read_b64_tr_b16 v[74:75], v13 offset:768
    s_waitcnt lgkmcnt(4)
    v_mfma_f32_16x16x32_bf16 v[36:39], v[60:63], v[48:51], v[36:39]
    v_mfma_f32_16x16x32_bf16 v[40:43], v[84:87], v[48:51], v[40:43]
    v_mfma_f32_16x16x32_bf16 v[44:47], v[48:51], v[48:51], v[44:47]
    s_waitcnt lgkmcnt(0)
    v_mfma_f32_16x16x32_bf16 v[36:39], v[64:67], v[72:75], v[36:39]
    v_mfma_f32_16x16x32_bf16 v[40:43], v[68:71], v[72:75], v[40:43]
    v_mfma_f32_16x16x32_bf16 v[44:47], v[72:75], v[72:75], v[44:47]
    v_pk_add_f32 v[28:29], v[28:29], v[30:31]
    v_pk_add_f32 v[32:33], v[32:33], v[34:35]
    v_cvt_pk_bf16_f32 v56, v28, v29
    v_cvt_pk_bf16_f32 v57, v32, v33
    v_cvt_pk_bf16_f32 v18, v32, v33
    v_max3_f32 v52, v36, v37, v38
    v_max3_f32 v53, v40, v41, v42
    v_max3_f32 v52, v52, v39, v43
    v_max3_f32 v53, v53, v46, v47
    v_max_f32 v54, v52, v53
    v_max_f32 v55, v52, v53
    v_mov_b64 v[76:77], s[36:37]
    v_mov_b64 v[78:79], s[36:37]
    v_permlane16_swap_b32 v54, v55
    v_max_f32 v52, v54, v55
    v_max_f32 v53, v54, v55
    v_add_u32 v14, s48, v8
    v_mov_b64 v[60:61], 0
    v_permlane32_swap_b32 v52, v53
    v_max_f32 v52, v52, v53
    v_mul_f32 v52, s54, v52
    v_pk_fma_f32 v[46:47], v[46:47], s[54:55], v[52:53] op_sel_hi:[1,0,0] neg_lo:[0,0,1] neg_hi:[0,0,1]
    v_pk_fma_f32 v[36:37], v[36:37], s[54:55], v[52:53] op_sel_hi:[1,0,0] neg_lo:[0,0,1] neg_hi:[0,0,1]
    v_pk_fma_f32 v[38:39], v[38:39], s[54:55], v[52:53] op_sel_hi:[1,0,0] neg_lo:[0,0,1] neg_hi:[0,0,1]
    v_pk_fma_f32 v[40:41], v[40:41], s[54:55], v[52:53] op_sel_hi:[1,0,0] neg_lo:[0,0,1] neg_hi:[0,0,1]
    v_pk_fma_f32 v[42:43], v[42:43], s[54:55], v[52:53] op_sel_hi:[1,0,0] neg_lo:[0,0,1] neg_hi:[0,0,1]
    v_exp_f32 v46, v46
    v_exp_f32 v47, v47
    v_exp_f32 v36, v36
    v_cvt_pk_bf16_f32 v16, v46, v47
    v_exp_f32 v37, v37
    v_exp_f32 v38, v38
    v_mfma_f32_16x16x16_bf16 v[72:75], v[76:77], v[16:17], 0
    v_exp_f32 v39, v39
    v_mfma_f32_16x16x16_bf16 v[64:67], v[56:57], v[16:17], 0
    v_exp_f32 v40, v40
    v_mfma_f32_16x16x16_bf16 v[68:71], v[18:19], v[16:17], 0
    v_exp_f32 v41, v41
    v_exp_f32 v42, v42
    v_exp_f32 v43, v43
    v_cvt_pk_bf16_f32 v48, v36, v37
    v_cvt_pk_bf16_f32 v49, v38, v39
    v_cvt_pk_bf16_f32 v50, v40, v41
    v_cvt_pk_bf16_f32 v51, v42, v43
    v_mov_b64 v[62:63], 0
    v_mov_b64 v[36:37], 0
    v_mfma_f32_16x16x32_bf16 v[72:75], v[76:79], v[48:51], v[72:75]
    v_mov_b64 v[38:39], 0
    v_mfma_f32_16x16x32_bf16 v[64:67], v[20:23], v[48:51], v[64:67]
    v_mov_b64 v[40:41], 0
    v_mfma_f32_16x16x32_bf16 v[68:71], v[24:27], v[48:51], v[68:71]
    v_mov_b64 v[42:43], 0
    v_rcp_f32 v52, v72
    v_mov_b64 v[44:45], 0
    s_nop 1
    v_pk_mul_f32 v[64:65], v[64:65], v[52:53] op_sel_hi:[1,0]
    v_pk_mul_f32 v[66:67], v[66:67], v[52:53] op_sel_hi:[1,0]
    v_cvt_pk_bf16_f32 v72, v64, v65
    v_cvt_pk_bf16_f32 v73, v66, v67
    v_pk_mul_f32 v[68:69], v[68:69], v[52:53] op_sel_hi:[1,0]
    v_pk_mul_f32 v[70:71], v[70:71], v[52:53] op_sel_hi:[1,0]
    v_cvt_pk_bf16_f32 v74, v68, v69
    v_cvt_pk_bf16_f32 v75, v70, v71
    s_mov_b64 exec, s[60:61]
    ds_write_b128 v14, v[72:75]
    s_mov_b64 exec, -1
    v_mov_b64 v[46:47], 0
    v_mov_b64 v[48:49], 0
    v_mov_b64 v[50:51], 0
    v_min_u32 v56, -2, v56
    s_waitcnt lgkmcnt(0)
    s_barrier
    ds_read_b128 v[64:67], v8 offset:10240
    ds_read_b128 v[68:71], v8 offset:11264
    s_waitcnt lgkmcnt(1)
    v_smfmac_f32_16x16x64_bf16 v[60:63], v[64:67], v[216:223], v10
    s_waitcnt lgkmcnt(0)
    v_smfmac_f32_16x16x64_bf16 v[60:63], v[68:71], v[224:231], v10
    v_smfmac_f32_16x16x64_bf16 v[36:39], v[64:67], v[152:159], v10
    v_smfmac_f32_16x16x64_bf16 v[36:39], v[68:71], v[160:167], v10
    v_smfmac_f32_16x16x64_bf16 v[40:43], v[64:67], v[168:175], v10
    v_pk_add_f32 v[60:61], v[60:61], v[62:63]
    v_smfmac_f32_16x16x64_bf16 v[40:43], v[68:71], v[176:183], v10
    v_cvt_pk_bf16_f32 v76, v60, v61
    v_smfmac_f32_16x16x64_bf16 v[44:47], v[64:67], v[184:191], v10
    v_pk_add_f32 v[36:37], v[36:37], v[38:39]
    v_smfmac_f32_16x16x64_bf16 v[44:47], v[68:71], v[192:199], v10
    v_mov_b32_dpp v77, v76 row_shl:8 row_mask:0xf bank_mask:0xf
    v_smfmac_f32_16x16x64_bf16 v[48:51], v[64:67], v[200:207], v10
    v_mov_b32_dpp v78, v76 row_shl:4 row_mask:0xf bank_mask:0xf
    v_smfmac_f32_16x16x64_bf16 v[48:51], v[68:71], v[208:215], v10
    v_mov_b32_dpp v79, v76 row_shl:12 row_mask:0xf bank_mask:0xf
    v_bfi_b32 v76, 1, s51, v76
    s_mov_b64 exec, s[56:57]
    buffer_store_dwordx4 v[76:79], v1, s[32:35], 0 offen
    s_mov_b64 exec, -1
    v_cvt_pk_bf16_f32 v72, v36, v37
    v_pk_add_f32 v[40:41], v[40:41], v[42:43]
    v_pk_add_f32 v[44:45], v[44:45], v[46:47]
    v_bfi_b32 v72, 1, s51, v72
    v_cvt_pk_bf16_f32 v73, v40, v41
    v_pk_add_f32 v[48:49], v[48:49], v[50:51]
    v_cvt_pk_bf16_f32 v74, v44, v45
    v_cvt_pk_bf16_f32 v75, v48, v49
    buffer_store_dwordx4 v[72:75], v0, s[32:35], 0 offen
    s_cmp_ge_u32 s53, 40
    s_cbranch_scc1 L_ch_noredf0
    v_bfe_u32 v60, v8, 4, 1
    v_lshlrev_b32 v60, 4, v60
    v_mov_b32 v61, 0x3f80
    v_lshlrev_b32 v61, v60, v61
    v_bfe_u32 v60, v8, 5, 2
    v_cmp_eq_u32 vcc, 0, v60
    s_nop 1
    v_cndmask_b32 v80, 0, v61, vcc
    v_cmp_eq_u32 vcc, 1, v60
    s_nop 1
    v_cndmask_b32 v81, 0, v61, vcc
    v_cmp_eq_u32 vcc, 2, v60
    s_nop 1
    v_cndmask_b32 v82, 0, v61, vcc
    v_cmp_eq_u32 vcc, 3, v60
    s_nop 1
    v_cndmask_b32 v83, 0, v61, vcc
    v_mov_b64 v[52:53], -1
    v_mov_b64 v[54:55], -1
    s_cmp_ge_u32 s53, 32
    s_cbranch_scc1 L_ch_oddf0
    s_sleep 3
    buffer_load_dwordx4 v[36:39], v8, s[32:35], s66 offen offset:0 sc1
    buffer_load_dwordx4 v[40:43], v8, s[32:35], s66 offen offset:1024 sc1
    buffer_load_dwordx4 v[44:47], v8, s[32:35], s66 offen offset:2048 sc1
    buffer_load_dwordx4 v[48:51], v8, s[32:35], s66 offen offset:3072 sc1
    s_sleep 3
    buffer_load_dwordx4 v[28:31], v8, s[32:35], s66 offen offset:0 sc1
    buffer_load_dwordx4 v[32:35], v8, s[32:35], s66 offen offset:1024 sc1
    buffer_load_dwordx4 v[20:23], v8, s[32:35], s66 offen offset:2048 sc1
    buffer_load_dwordx4 v[24:27], v8, s[32:35], s66 offen offset:3072 sc1
    s_waitcnt vmcnt(7)
    v_mfma_f32_16x16x32_bf16 v[84:87], v[36:39], v[80:83], 0
    v_xor_b32 v60, s51, v36
    s_waitcnt vmcnt(6)
    v_mfma_f32_16x16x32_bf16 v[84:87], v[40:43], v[80:83], v[84:87]
    v_xor_b32 v61, s51, v40
    s_waitcnt vmcnt(5)
    v_mfma_f32_16x16x32_bf16 v[84:87], v[44:47], v[80:83], v[84:87]
    v_xor_b32 v62, s51, v44
    v_or3_b32 v60, v60, v61, v62
    s_waitcnt vmcnt(4)
    v_mfma_f32_16x16x32_bf16 v[84:87], v[48:51], v[80:83], v[84:87]
    v_xor_b32 v61, s51, v48
    v_or_b32 v60, v60, v61
    v_and_b32 v60, 1, v60
    v_cmp_ne_u32 vcc, 0, v60
    s_nop 3
    v_permlane32_swap_b32 v84, v86
    v_permlane32_swap_b32 v85, v87
    v_pk_add_f32 v[84:85], v[84:85], v[86:87]
    v_cvt_pk_bf16_f32 v84, v84, v85
    v_min_u32 v60, -2, v84
    v_min_u32 v62, -2, v84
    s_nop 1
    v_permlane16_swap_b32 v60, v62
    v_mov_b32 v61, v60
    v_mov_b32 v63, v62
    s_nop 0
    v_permlane32_swap_b32 v60, v61
    v_permlane32_swap_b32 v62, v63
    s_cbranch_vccnz L_ch_pbf0
L_ch_pokf0:
    s_mov_b64 exec, s[58:59]
    buffer_store_dwordx4 v[60:63], v2, s[32:35], s46 offen
    buffer_store_dwordx4 v[60:63], v2, s[32:35], s47 offen sc1
    buffer_store_dwordx4 v[52:55], v2, s[32:35], s49 offen
    s_mov_b64 exec, -1
L_ch_joinf0:
    v_mov_b64 v[36:37], 0
    v_mov_b64 v[38:39], 0
    v_mov_b64 v[40:41], 0
    v_mov_b64 v[42:43], 0
    v_mov_b64 v[44:45], 0
    v_mov_b64 v[46:47], 0
    v_mov_b64 v[48:49], 0
    v_mov_b64 v[50:51], 0
    s_barrier
    s_not_b64 s[88:89], s[88:89]
    s_add_u32 s45, s45, 32768
    s_add_u32 s62, s62, 786432
    s_add_u32 s87, s87, 786432
    s_add_u32 s63, s63, 786432
    s_add_u32 s64, s64, 131072
    s_add_u32 s43, s43, 1
    s_xor_b32 s51, s51, 1
    s_mov_b32 s70, s44
    s_mov_b32 s44, s46
    s_mov_b32 s46, s49
    s_mov_b32 s49, s70
    s_add_u32 s47, s47, 32768
    s_cmp_eq_u32 s43, 63
    s_cselect_b32 s82, 0, s82
    s_and_b32 s70, s43, 7
    s_cmp_eq_u32 s70, 5
    s_cselect_b32 s26, 98631680, 0
    s_and_b32 s70, s43, 3
    s_cmp_ge_u32 s43, 54
    s_cselect_b32 s70, 0, s70
    s_cmp_eq_u32 s70, 0
    s_cselect_b32 s38, s23, 0
    s_branch L_ch_step_f0
L_ch_noredf0:
    s_waitcnt vmcnt(0)
    s_cmp_eq_u32 s26, 0
    s_cbranch_scc1 L_ch_kvbf0
    v_add_u32_dpp v15, v15, v15 row_shr:1 row_mask:0xf bank_mask:0xf bound_ctrl:0
    s_nop 1
    v_add_u32_dpp v15, v15, v15 row_shr:2 row_mask:0xf bank_mask:0xf bound_ctrl:0
    s_nop 1
    v_add_u32_dpp v15, v15, v15 row_shr:4 row_mask:0xf bank_mask:0xf bound_ctrl:0
    s_nop 0
    v_readlane_b32 s70, v15, 7
    s_nop 0
    s_cmp_lt_u32 s70, 128
    s_cbranch_scc1 L_ch_kvwf0
L_ch_kvbf0:
    s_add_u32 s71, s43, 4
    s_lshr_b32 s71, s71, 3
    s_min_u32 s71, s71, 7
    s_lshl_b32 s71, s71, 10
    s_add_u32 s69, s71, 95830016
    s_branch L_ch_joinf0
L_ch_lastf0:
    v_smfmac_f32_16x16x64_bf16 v[28:31], v[80:83], v[240:247], v10
    s_nop 7
    v_pk_add_f32 v[28:29], v[28:29], v[30:31]
    v_pk_add_f32 v[32:33], v[32:33], v[34:35]
    v_cvt_pk_bf16_f32 v56, v28, v29
    v_cvt_pk_bf16_f32 v57, v32, v33
    s_add_u32 s64, s64, 131072
    v_min_u32 v56, -2, v56
    buffer_store_dwordx4 v[56:59], v8, s[32:35], s64 offen sc1
    s_waitcnt vmcnt(0) lgkmcnt(0)
    s_barrier
    s_cmp_lg_u32 s42, 3
    s_cbranch_scc1 L_ch_finf0
    s_mov_b32 s71, 65
    v_mov_b32 v16, s71
    s_mov_b64 exec, 1
    buffer_store_dword v16, v17, s[32:35], s68 offen sc1
    s_mov_b64 exec, -1
L_ch_finf0:
    s_waitcnt vmcnt(0)
    s_endpgm
L_ch_team_w:
    s_sub_u32 s65, s65, 1
    s_cbranch_scc1 L_ch_abort
    s_sleep 4
    global_load_dwordx2 v[26:27], v32, s[28:29] sc1
    s_waitcnt vmcnt(0)
    s_branch L_ch_team
L_ch_lbf0:
    s_waitcnt vmcnt(0)
    ds_write_b128 v3, v[60:63] offset:0
    ds_write_b32 v4, v85 offset:0
    v_max3_u32 v16, v60, v62, v85
    v_cmp_eq_u32 vcc, s74, v16
    s_nop 0
    s_cbranch_vccz L_ch_lcf0
L_ch_lrf0:
    s_sub_u32 s65, s65, 1
    s_cbranch_scc1 L_ch_abort
    s_waitcnt lgkmcnt(0)
    buffer_load_dwordx4 v[80:83], v3, s[32:35], s44 offen sc1
    buffer_load_dword v84, v4, s[32:35], s44 offen sc1
    s_waitcnt vmcnt(0)
    ds_write_b128 v3, v[80:83] offset:0
    ds_write_b32 v4, v84 offset:0
    v_max3_u32 v16, v80, v82, v84
    v_cmp_eq_u32 vcc, s74, v16
    s_nop 0
    s_cbranch_vccnz L_ch_lrf0
    s_branch L_ch_lcf0
L_ch_rrf0:
    s_sub_u32 s65, s65, 1
    s_cbranch_scc1 L_ch_abort
    s_waitcnt lgkmcnt(0)
    buffer_load_dwordx4 v[12:15], v3, s[32:35], s45 offen sc1
    buffer_load_dword v19, v4, s[32:35], s45 offen sc1
    s_waitcnt vmcnt(0)
    ds_write_b128 v3, v[12:15] offset:5120
    ds_write_b32 v4, v19 offset:5120
    v_max3_u32 v16, v12, v14, v19
    v_cmp_eq_u32 vcc, s74, v16
    s_nop 0
    s_cbranch_vccnz L_ch_rrf0
    s_waitcnt lgkmcnt(0)
    s_branch L_ch_rokf0
L_ch_pbof0:
    s_sub_u32 s65, s65, 1
    s_cbranch_scc1 L_ch_abort
    buffer_load_dwordx4 v[36:39], v8, s[32:35], s66 offen offset:0 sc1
    buffer_load_dwordx4 v[40:43], v8, s[32:35], s66 offen offset:1024 sc1
    buffer_load_dwordx4 v[44:47], v8, s[32:35], s66 offen offset:2048 sc1
    buffer_load_dwordx4 v[48:51], v8, s[32:35], s66 offen offset:3072 sc1
    s_waitcnt vmcnt(7)
    v_mfma_f32_16x16x32_bf16 v[84:87], v[28:31], v[80:83], 0
    v_xor_b32 v60, s51, v28
    s_waitcnt vmcnt(6)
    v_mfma_f32_16x16x32_bf16 v[84:87], v[32:35], v[80:83], v[84:87]
    v_xor_b32 v61, s51, v32
    s_waitcnt vmcnt(5)
    v_mfma_f32_16x16x32_bf16 v[84:87], v[20:23], v[80:83], v[84:87]
    v_xor_b32 v62, s51, v20
    v_or3_b32 v60, v60, v61, v62
    s_waitcnt vmcnt(4)
    v_mfma_f32_16x16x32_bf16 v[84:87], v[24:27], v[80:83], v[84:87]
    v_xor_b32 v61, s51, v24
    v_or_b32 v60, v60, v61
    v_and_b32 v60, 1, v60
    v_cmp_ne_u32 vcc, 0, v60
    s_nop 3
    v_permlane32_swap_b32 v84, v86
    v_permlane32_swap_b32 v85, v87
    v_pk_add_f32 v[84:85], v[84:85], v[86:87]
    v_cvt_pk_bf16_f32 v84, v84, v85
    v_min_u32 v60, -2, v84
    v_min_u32 v61, -2, v84
    s_nop 1
    v_permlane32_swap_b32 v60, v61
    s_cbranch_vccnz L_ch_paof0
    s_mov_b64 exec, s[58:59]
    buffer_store_dwordx2 v[60:61], v2, s[32:35], s46 offen
    buffer_store_dwordx2 v[60:61], v2, s[32:35], s47 offen sc1
    buffer_store_dwordx2 v[52:53], v2, s[32:35], s49 offen
    s_mov_b64 exec, -1
    s_waitcnt vmcnt(3)
    s_branch L_ch_joinf0
L_ch_paof0:
    buffer_load_dwordx4 v[28:31], v8, s[32:35], s66 offen offset:0 sc1
    buffer_load_dwordx4 v[32:35], v8, s[32:35], s66 offen offset:1024 sc1
    buffer_load_dwordx4 v[20:23], v8, s[32:35], s66 offen offset:2048 sc1
    buffer_load_dwordx4 v[24:27], v8, s[32:35], s66 offen offset:3072 sc1
    s_waitcnt vmcnt(7)
    v_mfma_f32_16x16x32_bf16 v[84:87], v[36:39], v[80:83], 0
    v_xor_b32 v60, s51, v36
    s_waitcnt vmcnt(6)
    v_mfma_f32_16x16x32_bf16 v[84:87], v[40:43], v[80:83], v[84:87]
    v_xor_b32 v61, s51, v40
    s_waitcnt vmcnt(5)
    v_mfma_f32_16x16x32_bf16 v[84:87], v[44:47], v[80:83], v[84:87]
    v_xor_b32 v62, s51, v44
    v_or3_b32 v60, v60, v61, v62
    s_waitcnt vmcnt(4)
    v_mfma_f32_16x16x32_bf16 v[84:87], v[48:51], v[80:83], v[84:87]
    v_xor_b32 v61, s51, v48
    v_or_b32 v60, v60, v61
    v_and_b32 v60, 1, v60
    v_cmp_ne_u32 vcc, 0, v60
    s_nop 3
    v_permlane32_swap_b32 v84, v86
    v_permlane32_swap_b32 v85, v87
    v_pk_add_f32 v[84:85], v[84:85], v[86:87]
    v_cvt_pk_bf16_f32 v84, v84, v85
    v_min_u32 v60, -2, v84
    v_min_u32 v61, -2, v84
    s_nop 1
    v_permlane32_swap_b32 v60, v61
    s_cbranch_vccnz L_ch_pbof0
    s_branch L_ch_pokof0
L_ch_oddf0:
    s_sleep 2
    buffer_load_dwordx4 v[36:39], v8, s[32:35], s66 offen offset:0 sc1
    buffer_load_dwordx4 v[40:43], v8, s[32:35], s66 offen offset:1024 sc1
    buffer_load_dwordx4 v[44:47], v8, s[32:35], s66 offen offset:2048 sc1
    buffer_load_dwordx4 v[48:51], v8, s[32:35], s66 offen offset:3072 sc1
    s_sleep 3
    buffer_load_dwordx4 v[28:31], v8, s[32:35], s66 offen offset:0 sc1
    buffer_load_dwordx4 v[32:35], v8, s[32:35], s66 offen offset:1024 sc1
    buffer_load_dwordx4 v[20:23], v8, s[32:35], s66 offen offset:2048 sc1
    buffer_load_dwordx4 v[24:27], v8, s[32:35], s66 offen offset:3072 sc1
    s_waitcnt vmcnt(7)
    v_mfma_f32_16x16x32_bf16 v[84:87], v[36:39], v[80:83], 0
    v_xor_b32 v60, s51, v36
    s_waitcnt vmcnt(6)
    v_mfma_f32_16x16x32_bf16 v[84:87], v[40:43], v[80:83], v[84:87]
    v_xor_b32 v61, s51, v40
    s_waitcnt vmcnt(5)
    v_mfma_f32_16x16x32_bf16 v[84:87], v[44:47], v[80:83], v[84:87]
    v_xor_b32 v62, s51, v44
    v_or3_b32 v60, v60, v61, v62
    s_waitcnt vmcnt(4)
    v_mfma_f32_16x16x32_bf16 v[84:87], v[48:51], v[80:83], v[84:87]
    v_xor_b32 v61, s51, v48
    v_or_b32 v60, v60, v61
    v_and_b32 v60, 1, v60
    v_cmp_ne_u32 vcc, 0, v60
    s_nop 3
    v_permlane32_swap_b32 v84, v86
    v_permlane32_swap_b32 v85, v87
    v_pk_add_f32 v[84:85], v[84:85], v[86:87]
    v_cvt_pk_bf16_f32 v84, v84, v85
    v_min_u32 v60, -2, v84
    v_min_u32 v61, -2, v84
    s_nop 1
    v_permlane32_swap_b32 v60, v61
    s_cbranch_vccnz L_ch_pbof0
L_ch_pokof0:
    s_mov_b64 exec, s[58:59]
    buffer_store_dwordx2 v[60:61], v2, s[32:35], s46 offen
    buffer_store_dwordx2 v[60:61], v2, s[32:35], s47 offen sc1
    buffer_store_dwordx2 v[52:53], v2, s[32:35], s49 offen
    s_mov_b64 exec, -1
    s_branch L_ch_joinf0
L_ch_pbf0:
    s_sub_u32 s65, s65, 1
    s_cbranch_scc1 L_ch_abort
    buffer_load_dwordx4 v[36:39], v8, s[32:35], s66 offen offset:0 sc1
    buffer_load_dwordx4 v[40:43], v8, s[32:35], s66 offen offset:1024 sc1
    buffer_load_dwordx4 v[44:47], v8, s[32:35], s66 offen offset:2048 sc1
    buffer_load_dwordx4 v[48:51], v8, s[32:35], s66 offen offset:3072 sc1
    s_waitcnt vmcnt(7)
    v_mfma_f32_16x16x32_bf16 v[84:87], v[28:31], v[80:83], 0
    v_xor_b32 v60, s51, v28
    s_waitcnt vmcnt(6)
    v_mfma_f32_16x16x32_bf16 v[84:87], v[32:35], v[80:83], v[84:87]
    v_xor_b32 v61, s51, v32
    s_waitcnt vmcnt(5)
    v_mfma_f32_16x16x32_bf16 v[84:87], v[20:23], v[80:83], v[84:87]
    v_xor_b32 v62, s51, v20
    v_or3_b32 v60, v60, v61, v62
    s_waitcnt vmcnt(4)
    v_mfma_f32_16x16x32_bf16 v[84:87], v[24:27], v[80:83], v[84:87]
    v_xor_b32 v61, s51, v24
    v_or_b32 v60, v60, v61
    v_and_b32 v60, 1, v60
    v_cmp_ne_u32 vcc, 0, v60
    s_nop 3
    v_permlane32_swap_b32 v84, v86
    v_permlane32_swap_b32 v85, v87
    v_pk_add_f32 v[84:85], v[84:85], v[86:87]
    v_cvt_pk_bf16_f32 v84, v84, v85
    v_min_u32 v60, -2, v84
    v_min_u32 v62, -2, v84
    s_nop 1
    v_permlane16_swap_b32 v60, v62
    v_mov_b32 v61, v60
    v_mov_b32 v63, v62
    s_nop 0
    v_permlane32_swap_b32 v60, v61
    v_permlane32_swap_b32 v62, v63
    s_cbranch_vccnz L_ch_paf0
    s_mov_b64 exec, s[58:59]
    buffer_store_dwordx4 v[60:63], v2, s[32:35], s46 offen
    buffer_store_dwordx4 v[60:63], v2, s[32:35], s47 offen sc1
    buffer_store_dwordx4 v[52:55], v2, s[32:35], s49 offen
    s_mov_b64 exec, -1
    s_waitcnt vmcnt(3)
    s_branch L_ch_joinf0
L_ch_paf0:
    buffer_load_dwordx4 v[28:31], v8, s[32:35], s66 offen offset:0 sc1
    buffer_load_dwordx4 v[32:35], v8, s[32:35], s66 offen offset:1024 sc1
    buffer_load_dwordx4 v[20:23], v8, s[32:35], s66 offen offset:2048 sc1
    buffer_load_dwordx4 v[24:27], v8, s[32:35], s66 offen offset:3072 sc1
    s_waitcnt vmcnt(7)
    v_mfma_f32_16x16x32_bf16 v[84:87], v[36:39], v[80:83], 0
    v_xor_b32 v60, s51, v36
    s_waitcnt vmcnt(6)
    v_mfma_f32_16x16x32_bf16 v[84:87], v[40:43], v[80:83], v[84:87]
    v_xor_b32 v61, s51, v40
    s_waitcnt vmcnt(5)
    v_mfma_f32_16x16x32_bf16 v[84:87], v[44:47], v[80:83], v[84:87]
    v_xor_b32 v62, s51, v44
    v_or3_b32 v60, v60, v61, v62
    s_waitcnt vmcnt(4)
    v_mfma_f32_16x16x32_bf16 v[84:87], v[48:51], v[80:83], v[84:87]
    v_xor_b32 v61, s51, v48
    v_or_b32 v60, v60, v61
    v_and_b32 v60, 1, v60
    v_cmp_ne_u32 vcc, 0, v60
    s_nop 3
    v_permlane32_swap_b32 v84, v86
    v_permlane32_swap_b32 v85, v87
    v_pk_add_f32 v[84:85], v[84:85], v[86:87]
    v_cvt_pk_bf16_f32 v84, v84, v85
    v_min_u32 v60, -2, v84
    v_min_u32 v62, -2, v84
    s_nop 1
    v_permlane16_swap_b32 v60, v62
    v_mov_b32 v61, v60
    v_mov_b32 v63, v62
    s_nop 0
    v_permlane32_swap_b32 v60, v61
    v_permlane32_swap_b32 v62, v63
    s_cbranch_vccnz L_ch_pbf0
    s_branch L_ch_pokf0
L_ch_kvwf0:
    s_sub_u32 s65, s65, 1
    s_cbranch_scc1 L_ch_abort
    s_sleep 2
    v_bfe_u32 v14, v8, 4, 3
    v_lshlrev_b32 v14, 7, v14
    buffer_load_dword v15, v14, s[32:35], s69 offen sc1
    s_waitcnt vmcnt(0)
    v_add_u32_dpp v15, v15, v15 row_shr:1 row_mask:0xf bank_mask:0xf bound_ctrl:0
    s_nop 1
    v_add_u32_dpp v15, v15, v15 row_shr:2 row_mask:0xf bank_mask:0xf bound_ctrl:0
    s_nop 1
    v_add_u32_dpp v15, v15, v15 row_shr:4 row_mask:0xf bank_mask:0xf bound_ctrl:0
    s_nop 0
    v_readlane_b32 s70, v15, 7
    s_nop 0
    s_cmp_lt_u32 s70, 128
    s_cbranch_scc1 L_ch_kvwf0
    s_branch L_ch_kvbf0
L_ch_step_f1:
    s_sleep 1
    buffer_load_dwordx4 v[80:83], v3, s[32:35], s44 offen sc1
    buffer_load_dword v84, v4, s[32:35], s44 offen sc1
    s_add_u32 m0, s50, 0
    s_sub_u32 s70, s63, 794624
    buffer_load_dwordx4 v8, s[32:35], s70 offen sc1 lds
    buffer_load_dwordx4 v8, s[32:35], s70 offen offset:1024 sc1 lds
    ds_read_b128 v[64:67], v9 offset:12288
    ds_read_b128 v[68:71], v9 offset:13312
    buffer_load_dwordx4 v[60:63], v3, s[32:35], s44 offen sc1
    buffer_load_dword v85, v4, s[32:35], s44 offen sc1
    ds_read_b128 v[72:75], v9 offset:14336
    ds_read_b128 v[76:79], v9 offset:15360
    v_lshlrev_b32 v11, 2, v8
    s_sub_u32 s72, s63, 786432
    s_waitcnt vmcnt(4)
    ds_write_b128 v3, v[80:83] offset:0
    ds_write_b32 v4, v84 offset:0
    v_max3_u32 v16, v80, v82, v84
    v_cmp_eq_u32 vcc, s74, v16
    v_mov_b64 v[28:29], 0
    v_mov_b64 v[30:31], 0
    v_mov_b64 v[32:33], 0
    v_mov_b64 v[34:35], 0
    s_cbranch_vccnz L_ch_lbf1
L_ch_lcf1:
    buffer_load_dwordx4 v[12:15], v3, s[32:35], s45 offen sc1
    buffer_load_dword v19, v4, s[32:35], s45 offen sc1
    buffer_load_dwordx4 v[20:23], v8, s[32:35], s72 offen sc1
    s_waitcnt lgkmcnt(0)
    s_barrier
    ds_read_b128 v[52:55], v8 offset:0
    buffer_load_dwordx4 v[24:27], v8, s[32:35], s72 offen offset:1024 sc1
    s_waitcnt lgkmcnt(0)
    v_smfmac_f32_16x16x64_bf16 v[28:31], v[52:55], v[64:71], v10
    s_waitcnt vmcnt(4)
    ds_read_b128 v[80:83], v9 offset:16384
    v_smfmac_f32_16x16x64_bf16 v[36:39], v[52:55], a[0:7], v10
    ds_read_b128 v[60:63], v8 offset:1024
    ds_read_b128 v[84:87], v9 offset:17408
    v_smfmac_f32_16x16x64_bf16 v[40:43], v[52:55], a[160:167], v10
    ds_read_b128 v[64:67], v9 offset:18432
    v_smfmac_f32_16x16x64_bf16 v[32:35], v[52:55], v[72:79], v10
    ds_read_b128 v[68:71], v9 offset:19456
    v_smfmac_f32_16x16x64_bf16 v[44:47], v[52:55], a[8:15], v10
    ds_read_b128 v[72:75], v9 offset:20480
    v_smfmac_f32_16x16x64_bf16 v[48:51], v[52:55], a[168:175], v10
    ds_read_b128 v[76:79], v9 offset:21504
    s_waitcnt lgkmcnt(4)
    v_smfmac_f32_16x16x64_bf16 v[28:31], v[60:63], v[80:87], v10
    ds_read_b128 v[52:55], v8 offset:2048
    v_smfmac_f32_16x16x64_bf16 v[36:39], v[60:63], a[16:23], v10
    ds_read_b128 v[80:83], v9 offset:22528
    v_smfmac_f32_16x16x64_bf16 v[40:43], v[60:63], a[176:183], v10
    ds_read_b128 v[84:87], v9 offset:23552
    s_waitcnt lgkmcnt(5)
    v_smfmac_f32_16x16x64_bf16 v[32:35], v[60:63], v[64:71], v10
    ds_read_b128 v[64:67], v9 offset:24576
    v_smfmac_f32_16x16x64_bf16 v[44:47], v[60:63], a[24:31], v10
    ds_read_b128 v[68:71], v9 offset:25600
    v_smfmac_f32_16x16x64_bf16 v[48:51], v[60:63], a[184:191], v10
    s_waitcnt lgkmcnt(4)
    v_smfmac_f32_16x16x64_bf16 v[28:31], v[52:55], v[72:79], v10
    ds_read_b128 v[60:63], v8 offset:3072
    v_smfmac_f32_16x16x64_bf16 v[36:39], v[52:55], a[32:39], v10
    ds_read_b128 v[72:75], v9 offset:26624
    v_smfmac_f32_16x16x64_bf16 v[40:43], v[52:55], a[192:199], v10
    ds_read_b128 v[76:79], v9 offset:27648
    s_waitcnt lgkmcnt(5)
    v_smfmac_f32_16x16x64_bf16 v[32:35], v[52:55], v[80:87], v10
    ds_read_b128 v[80:83], v9 offset:28672
    v_smfmac_f32_16x16x64_bf16 v[44:47], v[52:55], a[40:47], v10
    ds_read_b128 v[84:87], v9 offset:29696
    v_smfmac_f32_16x16x64_bf16 v[48:51], v[52:55], a[200:207], v10
    s_waitcnt vmcnt(2)
    ds_write_b128 v3, v[12:15] offset:5120
    s_waitcnt lgkmcnt(5)
    v_smfmac_f32_16x16x64_bf16 v[28:31], v[60:63], v[64:71], v10
    ds_write_b32 v4, v19 offset:5120
    v_smfmac_f32_16x16x64_bf16 v[36:39], v[60:63], a[48:55], v10
    v_max3_u32 v16, v12, v14, v19
    ds_read_b128 v[52:55], v8 offset:4096
    v_smfmac_f32_16x16x64_bf16 v[40:43], v[60:63], a[208:215], v10
    v_cmp_eq_u32 vcc, s74, v16
    s_waitcnt lgkmcnt(5)
    v_smfmac_f32_16x16x64_bf16 v[32:35], v[60:63], v[72:79], v10
    ds_read_b128 v[64:67], v9 offset:30720
    v_smfmac_f32_16x16x64_bf16 v[44:47], v[60:63], a[56:63], v10
    s_cbranch_vccnz L_ch_rrf1
L_ch_rokf1:
    s_waitcnt lgkmcnt(2)
    s_barrier
    ds_read_b128 v[68:71], v9 offset:31744
    v_smfmac_f32_16x16x64_bf16 v[48:51], v[60:63], a[216:223], v10
    ds_read_b128 v[72:75], v9 offset:0
    s_waitcnt lgkmcnt(3)
    v_smfmac_f32_16x16x64_bf16 v[28:31], v[52:55], v[80:87], v10
    ds_read_b128 v[60:63], v8 offset:5120
    v_smfmac_f32_16x16x64_bf16 v[36:39], v[52:55], a[64:71], v10
    s_waitcnt vmcnt(0)
    buffer_load_dword v11, v11, s[80:83], s87 offen sc1
    ds_read_b128 v[76:79], v9 offset:1024
    v_smfmac_f32_16x16x64_bf16 v[40:43], v[52:55], a[224:231], v10
    ds_read_b128 v[80:83], v9 offset:2048
    s_waitcnt lgkmcnt(4)
    v_smfmac_f32_16x16x64_bf16 v[32:35], v[52:55], v[64:71], v10
    ds_read_b128 v[84:87], v9 offset:3072
    v_smfmac_f32_16x16x64_bf16 v[44:47], v[52:55], a[72:79], v10
    ds_read_b128 v[64:67], v9 offset:4096
    v_smfmac_f32_16x16x64_bf16 v[48:51], v[52:55], a[232:239], v10
    ds_read_b128 v[68:71], v9 offset:5120
    s_waitcnt lgkmcnt(4)
    v_smfmac_f32_16x16x64_bf16 v[28:31], v[60:63], v[72:79], v10
    ds_read_b128 v[52:55], v8 offset:6144
    v_smfmac_f32_16x16x64_bf16 v[36:39], v[60:63], a[80:87], v10
    ds_read_b128 v[72:75], v9 offset:6144
    v_smfmac_f32_16x16x64_bf16 v[40:43], v[60:63], a[240:247], v10
    ds_read_b128 v[76:79], v9 offset:7168
    s_waitcnt lgkmcnt(5)
    v_smfmac_f32_16x16x64_bf16 v[32:35], v[60:63], v[80:87], v10
    ds_read_b128 v[80:83], v9 offset:8192
    v_smfmac_f32_16x16x64_bf16 v[44:47], v[60:63], a[88:95], v10
    ds_read_b128 v[84:87], v9 offset:9216
    v_smfmac_f32_16x16x64_bf16 v[48:51], v[60:63], a[248:255], v10
    s_waitcnt lgkmcnt(4)
    v_smfmac_f32_16x16x64_bf16 v[28:31], v[52:55], v[64:71], v10
    ds_read_b128 v[60:63], v8 offset:7168
    v_smfmac_f32_16x16x64_bf16 v[36:39], v[52:55], a[96:103], v10
    ds_read_b128 v[64:67], v9 offset:10240
    v_smfmac_f32_16x16x64_bf16 v[40:43], v[52:55], v[88:95], v10
    ds_read_b128 v[68:71], v9 offset:11264
    s_waitcnt lgkmcnt(5)
    v_smfmac_f32_16x16x64_bf16 v[32:35], v[52:55], v[72:79], v10
    ds_read_b128 v[72:75], v9 offset:32768
    v_smfmac_f32_16x16x64_bf16 v[44:47], v[52:55], a[104:111], v10
    ds_read_b128 v[76:79], v9 offset:33792
    v_smfmac_f32_16x16x64_bf16 v[48:51], v[52:55], v[96:103], v10
    s_waitcnt lgkmcnt(4)
    v_smfmac_f32_16x16x64_bf16 v[28:31], v[60:63], v[80:87], v10
    ds_read_b128 v[52:55], v8 offset:8192
    v_smfmac_f32_16x16x64_bf16 v[36:39], v[60:63], a[112:119], v10
    ds_read_b128 v[80:83], v8 offset:9216
    v_smfmac_f32_16x16x64_bf16 v[40:43], v[60:63], v[104:111], v10
    s_waitcnt lgkmcnt(4)
    v_smfmac_f32_16x16x64_bf16 v[32:35], v[60:63], v[64:71], v10
    ds_read_b128 v[64:67], v8 offset:18432
    v_smfmac_f32_16x16x64_bf16 v[44:47], v[60:63], a[120:127], v10
    v_smfmac_f32_16x16x64_bf16 v[48:51], v[60:63], v[112:119], v10
    s_waitcnt lgkmcnt(2)
    v_smfmac_f32_16x16x64_bf16 v[36:39], v[52:55], a[128:135], v10
    v_smfmac_f32_16x16x64_bf16 v[40:43], v[52:55], v[120:127], v10
    ds_read_b128 v[60:63], v8 offset:16384
    v_smfmac_f32_16x16x64_bf16 v[44:47], v[52:55], a[136:143], v10
    ds_read_b128 v[84:87], v8 offset:17408
    v_smfmac_f32_16x16x64_bf16 v[48:51], v[52:55], v[128:135], v10
    ds_read_b128 v[68:71], v8 offset:19456
    s_waitcnt lgkmcnt(4)
    v_smfmac_f32_16x16x64_bf16 v[36:39], v[80:83], a[144:151], v10
    v_smfmac_f32_16x16x64_bf16 v[40:43], v[80:83], v[136:143], v10
    v_xor_b32 v12, 128, v6
    v_smfmac_f32_16x16x64_bf16 v[44:47], v[80:83], a[152:159], v10
    v_xor_b32 v13, 128, v7
    v_smfmac_f32_16x16x64_bf16 v[48:51], v[80:83], v[144:151], v10
    v_pk_add_f32 v[36:37], v[36:37], v[38:39]
    v_smfmac_f32_16x16x64_bf16 v[32:35], v[52:55], v[232:239], v10
    v_pk_add_f32 v[40:41], v[40:41], v[42:43]
    v_cvt_pk_bf16_f32 v38, v36, v37
    v_cvt_pk_bf16_f32 v39, v40, v41
    ds_write_b64 v6, v[38:39]
    v_pk_add_f32 v[44:45], v[44:45], v[46:47]
    v_pk_add_f32 v[48:49], v[48:49], v[50:51]
    v_cvt_pk_bf16_f32 v46, v44, v45
    v_cvt_pk_bf16_f32 v47, v48, v49
    ds_write_b64 v12, v[46:47]
    v_smfmac_f32_16x16x64_bf16 v[28:31], v[52:55], v[72:79], v10
    v_smfmac_f32_16x16x64_bf16 v[32:35], v[80:83], v[248:255], v10
    s_cmp_eq_u32 s43, 63
    s_cbranch_scc1 L_ch_lastf1
    s_waitcnt lgkmcnt(0)
    s_barrier
    ds_read_b64_tr_b16 v[48:49], v7 offset:0
    ds_read_b64_tr_b16 v[50:51], v13 offset:0
    ds_read_b64_tr_b16 v[72:73], v7 offset:256
    ds_read_b64_tr_b16 v[74:75], v13 offset:256
    v_smfmac_f32_16x16x64_bf16 v[28:31], v[80:83], v[240:247], v10
    s_waitcnt lgkmcnt(2)
    v_mfma_f32_16x16x32_bf16 v[36:39], v[60:63], v[48:51], 0
    ds_read_b128 v[60:63], v8 offset:20480
    v_mfma_f32_16x16x32_bf16 v[40:43], v[84:87], v[48:51], 0
    ds_read_b128 v[84:87], v8 offset:21504
    v_mfma_f32_16x16x32_bf16 v[44:47], v[48:51], v[48:51], 0
    ds_read_b64_tr_b16 v[48:49], v7 offset:512
    ds_read_b64_tr_b16 v[50:51], v13 offset:512
    s_waitcnt lgkmcnt(4)
    v_mfma_f32_16x16x32_bf16 v[36:39], v[64:67], v[72:75], v[36:39]
    ds_read_b128 v[64:67], v8 offset:22528
    v_mfma_f32_16x16x32_bf16 v[40:43], v[68:71], v[72:75], v[40:43]
    ds_read_b128 v[68:71], v8 offset:23552
    v_mfma_f32_16x16x32_bf16 v[44:47], v[72:75], v[72:75], v[44:47]
    ds_read_b64_tr_b16 v[72:73], v7 offset:768
    ds_read_b64_tr_b16 v[74:75], v13 offset:768
    s_waitcnt lgkmcnt(4)
    v_mfma_f32_16x16x32_bf16 v[36:39], v[60:63], v[48:51], v[36:39]
    v_mfma_f32_16x16x32_bf16 v[40:43], v[84:87], v[48:51], v[40:43]
    v_mfma_f32_16x16x32_bf16 v[44:47], v[48:51], v[48:51], v[44:47]
    s_waitcnt lgkmcnt(0)
    v_mfma_f32_16x16x32_bf16 v[36:39], v[64:67], v[72:75], v[36:39]
    v_mfma_f32_16x16x32_bf16 v[40:43], v[68:71], v[72:75], v[40:43]
    v_mfma_f32_16x16x32_bf16 v[44:47], v[72:75], v[72:75], v[44:47]
    v_pk_add_f32 v[28:29], v[28:29], v[30:31]
    v_pk_add_f32 v[32:33], v[32:33], v[34:35]
    v_cvt_pk_bf16_f32 v56, v28, v29
    v_cvt_pk_bf16_f32 v57, v32, v33
    v_cvt_pk_bf16_f32 v18, v32, v33
    v_max3_f32 v52, v36, v37, v38
    v_max3_f32 v53, v40, v41, v42
    v_max3_f32 v52, v52, v39, v43
    v_max3_f32 v53, v53, v46, v47
    v_max_f32 v54, v52, v53
    v_max_f32 v55, v52, v53
    v_mov_b64 v[76:77], s[36:37]
    v_mov_b64 v[78:79], s[36:37]
    v_permlane16_swap_b32 v54, v55
    v_max_f32 v52, v54, v55
    v_max_f32 v53, v54, v55
    v_add_u32 v14, s48, v8
    v_mov_b64 v[60:61], 0
    v_permlane32_swap_b32 v52, v53
    v_max_f32 v52, v52, v53
    v_mul_f32 v52, s54, v52
    v_pk_fma_f32 v[46:47], v[46:47], s[54:55], v[52:53] op_sel_hi:[1,0,0] neg_lo:[0,0,1] neg_hi:[0,0,1]
    v_pk_fma_f32 v[36:37], v[36:37], s[54:55], v[52:53] op_sel_hi:[1,0,0] neg_lo:[0,0,1] neg_hi:[0,0,1]
    v_pk_fma_f32 v[38:39], v[38:39], s[54:55], v[52:53] op_sel_hi:[1,0,0] neg_lo:[0,0,1] neg_hi:[0,0,1]
    v_pk_fma_f32 v[40:41], v[40:41], s[54:55], v[52:53] op_sel_hi:[1,0,0] neg_lo:[0,0,1] neg_hi:[0,0,1]
    v_pk_fma_f32 v[42:43], v[42:43], s[54:55], v[52:53] op_sel_hi:[1,0,0] neg_lo:[0,0,1] neg_hi:[0,0,1]
    v_exp_f32 v46, v46
    v_exp_f32 v47, v47
    v_exp_f32 v36, v36
    v_cvt_pk_bf16_f32 v16, v46, v47
    v_exp_f32 v37, v37
    v_exp_f32 v38, v38
    v_mfma_f32_16x16x16_bf16 v[72:75], v[76:77], v[16:17], 0
    v_exp_f32 v39, v39
    v_mfma_f32_16x16x16_bf16 v[64:67], v[56:57], v[16:17], 0
    v_exp_f32 v40, v40
    v_mfma_f32_16x16x16_bf16 v[68:71], v[18:19], v[16:17], 0
    v_exp_f32 v41, v41
    v_exp_f32 v42, v42
    v_exp_f32 v43, v43
    v_cvt_pk_bf16_f32 v48, v36, v37
    v_cvt_pk_bf16_f32 v49, v38, v39
    v_cvt_pk_bf16_f32 v50, v40, v41
    v_cvt_pk_bf16_f32 v51, v42, v43
    v_mov_b64 v[62:63], 0
    v_mov_b64 v[36:37], 0
    v_mfma_f32_16x16x32_bf16 v[72:75], v[76:79], v[48:51], v[72:75]
    v_mov_b64 v[38:39], 0
    v_mfma_f32_16x16x32_bf16 v[64:67], v[20:23], v[48:51], v[64:67]
    v_mov_b64 v[40:41], 0
    v_mfma_f32_16x16x32_bf16 v[68:71], v[24:27], v[48:51], v[68:71]
    v_mov_b64 v[42:43], 0
    v_rcp_f32 v52, v72
    v_mov_b64 v[44:45], 0
    s_nop 1
    v_pk_mul_f32 v[64:65], v[64:65], v[52:53] op_sel_hi:[1,0]
    v_pk_mul_f32 v[66:67], v[66:67], v[52:53] op_sel_hi:[1,0]
    v_cvt_pk_bf16_f32 v72, v64, v65
    v_cvt_pk_bf16_f32 v73, v66, v67
    v_pk_mul_f32 v[68:69], v[68:69], v[52:53] op_sel_hi:[1,0]
    v_pk_mul_f32 v[70:71], v[70:71], v[52:53] op_sel_hi:[1,0]
    v_cvt_pk_bf16_f32 v74, v68, v69
    v_cvt_pk_bf16_f32 v75, v70, v71
    s_mov_b64 exec, s[60:61]
    ds_write_b128 v14, v[72:75]
    s_mov_b64 exec, -1
    v_mov_b64 v[46:47], 0
    v_mov_b64 v[48:49], 0
    v_mov_b64 v[50:51], 0
    s_waitcnt lgkmcnt(0)
    s_barrier
    ds_read_b128 v[64:67], v8 offset:10240
    ds_read_b128 v[68:71], v8 offset:11264
    s_waitcnt lgkmcnt(1)
    v_smfmac_f32_16x16x64_bf16 v[60:63], v[64:67], v[216:223], v10
    s_waitcnt lgkmcnt(0)
    v_smfmac_f32_16x16x64_bf16 v[60:63], v[68:71], v[224:231], v10
    v_smfmac_f32_16x16x64_bf16 v[36:39], v[64:67], v[152:159], v10
    v_smfmac_f32_16x16x64_bf16 v[36:39], v[68:71], v[160:167], v10
    v_smfmac_f32_16x16x64_bf16 v[40:43], v[64:67], v[168:175], v10
    v_pk_add_f32 v[60:61], v[60:61], v[62:63]
    v_smfmac_f32_16x16x64_bf16 v[40:43], v[68:71], v[176:183], v10
    v_cvt_pk_bf16_f32 v76, v60, v61
    v_smfmac_f32_16x16x64_bf16 v[44:47], v[64:67], v[184:191], v10
    v_pk_add_f32 v[36:37], v[36:37], v[38:39]
    v_smfmac_f32_16x16x64_bf16 v[44:47], v[68:71], v[192:199], v10
    v_mov_b32_dpp v77, v76 row_shl:8 row_mask:0xf bank_mask:0xf
    v_smfmac_f32_16x16x64_bf16 v[48:51], v[64:67], v[200:207], v10
    v_mov_b32_dpp v78, v76 row_shl:4 row_mask:0xf bank_mask:0xf
    v_smfmac_f32_16x16x64_bf16 v[48:51], v[68:71], v[208:215], v10
    v_mov_b32_dpp v79, v76 row_shl:12 row_mask:0xf bank_mask:0xf
    v_bfi_b32 v76, 1, s51, v76
    s_mov_b64 exec, s[56:57]
    buffer_store_dwordx4 v[76:79], v1, s[32:35], 0 offen
    s_mov_b64 exec, -1
    v_cvt_pk_bf16_f32 v72, v36, v37
    v_pk_add_f32 v[40:41], v[40:41], v[42:43]
    v_pk_add_f32 v[44:45], v[44:45], v[46:47]
    v_bfi_b32 v72, 1, s51, v72
    v_cvt_pk_bf16_f32 v73, v40, v41
    v_pk_add_f32 v[48:49], v[48:49], v[50:51]
    v_cvt_pk_bf16_f32 v74, v44, v45
    v_cvt_pk_bf16_f32 v75, v48, v49
    buffer_store_dwordx4 v[72:75], v0, s[32:35], 0 offen
    s_cmp_ge_u32 s53, 40
    s_cbranch_scc1 L_ch_noredf1
    v_bfe_u32 v60, v8, 4, 1
    v_lshlrev_b32 v60, 4, v60
    v_mov_b32 v61, 0x3f80
    v_lshlrev_b32 v61, v60, v61
    v_bfe_u32 v60, v8, 5, 2
    v_cmp_eq_u32 vcc, 0, v60
    s_nop 1
    v_cndmask_b32 v80, 0, v61, vcc
    v_cmp_eq_u32 vcc, 1, v60
    s_nop 1
    v_cndmask_b32 v81, 0, v61, vcc
    v_cmp_eq_u32 vcc, 2, v60
    s_nop 1
    v_cndmask_b32 v82, 0, v61, vcc
    v_cmp_eq_u32 vcc, 3, v60
    s_nop 1
    v_cndmask_b32 v83, 0, v61, vcc
    v_mov_b64 v[52:53], -1
    v_mov_b64 v[54:55], -1
    s_cmp_ge_u32 s53, 32
    s_cbranch_scc1 L_ch_oddf1
    s_sleep 3
    buffer_load_dwordx4 v[36:39], v8, s[32:35], s66 offen offset:0 sc1
    buffer_load_dwordx4 v[40:43], v8, s[32:35], s66 offen offset:1024 sc1
    buffer_load_dwordx4 v[44:47], v8, s[32:35], s66 offen offset:2048 sc1
    buffer_load_dwordx4 v[48:51], v8, s[32:35], s66 offen offset:3072 sc1
    s_sleep 3
    buffer_load_dwordx4 v[28:31], v8, s[32:35], s66 offen offset:0 sc1
    buffer_load_dwordx4 v[32:35], v8, s[32:35], s66 offen offset:1024 sc1
    buffer_load_dwordx4 v[20:23], v8, s[32:35], s66 offen offset:2048 sc1
    buffer_load_dwordx4 v[24:27], v8, s[32:35], s66 offen offset:3072 sc1
    s_waitcnt vmcnt(7)
    v_mfma_f32_16x16x32_bf16 v[84:87], v[36:39], v[80:83], 0
    v_xor_b32 v60, s51, v36
    s_waitcnt vmcnt(6)
    v_mfma_f32_16x16x32_bf16 v[84:87], v[40:43], v[80:83], v[84:87]
    v_xor_b32 v61, s51, v40
    s_waitcnt vmcnt(5)
    v_mfma_f32_16x16x32_bf16 v[84:87], v[44:47], v[80:83], v[84:87]
    v_xor_b32 v62, s51, v44
    v_or3_b32 v60, v60, v61, v62
    s_waitcnt vmcnt(4)
    v_mfma_f32_16x16x32_bf16 v[84:87], v[48:51], v[80:83], v[84:87]
    v_xor_b32 v61, s51, v48
    v_or_b32 v60, v60, v61
    v_and_b32 v60, 1, v60
    v_cmp_ne_u32 vcc, 0, v60
    s_nop 3
    v_permlane32_swap_b32 v84, v86
    v_permlane32_swap_b32 v85, v87
    v_pk_add_f32 v[84:85], v[84:85], v[86:87]
    v_cvt_pk_bf16_f32 v84, v84, v85
    v_min_u32 v60, -2, v84
    v_min_u32 v62, -2, v84
    s_nop 1
    v_permlane16_swap_b32 v60, v62
    v_mov_b32 v61, v60
    v_mov_b32 v63, v62
    s_nop 0
    v_permlane32_swap_b32 v60, v61
    v_permlane32_swap_b32 v62, v63
    s_cbranch_vccnz L_ch_pbf1
L_ch_pokf1:
    s_mov_b64 exec, s[58:59]
    buffer_store_dwordx4 v[60:63], v2, s[32:35], s46 offen
    buffer_store_dwordx4 v[60:63], v2, s[32:35], s47 offen sc1
    buffer_store_dwordx4 v[52:55], v2, s[32:35], s49 offen
    s_mov_b64 exec, -1
L_ch_joinf1:
    v_mov_b64 v[36:37], 0
    v_mov_b64 v[38:39], 0
    v_mov_b64 v[40:41], 0
    v_mov_b64 v[42:43], 0
    v_mov_b64 v[44:45], 0
    v_mov_b64 v[46:47], 0
    v_mov_b64 v[48:49], 0
    v_mov_b64 v[50:51], 0
    s_barrier
    s_not_b64 s[88:89], s[88:89]
    s_add_u32 s45, s45, 32768
    s_add_u32 s62, s62, 786432
    s_add_u32 s87, s87, 786432
    s_add_u32 s63, s63, 786432
    s_add_u32 s64, s64, 131072
    s_add_u32 s43, s43, 1
    s_xor_b32 s51, s51, 1
    s_mov_b32 s70, s44
    s_mov_b32 s44, s46
    s_mov_b32 s46, s49
    s_mov_b32 s49, s70
    s_add_u32 s47, s47, 32768
    s_cmp_eq_u32 s43, 63
    s_cselect_b32 s82, 0, s82
    s_branch L_ch_step_f1
L_ch_noredf1:
    s_waitcnt vmcnt(0)
    s_branch L_ch_joinf1
L_ch_lastf1:
    v_smfmac_f32_16x16x64_bf16 v[28:31], v[80:83], v[240:247], v10
    s_nop 7
    v_pk_add_f32 v[28:29], v[28:29], v[30:31]
    v_pk_add_f32 v[32:33], v[32:33], v[34:35]
    v_cvt_pk_bf16_f32 v56, v28, v29
    v_cvt_pk_bf16_f32 v57, v32, v33
    s_add_u32 s64, s64, 131072
    s_waitcnt vmcnt(0) lgkmcnt(0)
    s_barrier
    s_cmp_lg_u32 s42, 3
    s_cbranch_scc1 L_ch_finf1
    s_mov_b32 s71, 65
    v_mov_b32 v16, s71
    s_mov_b64 exec, 1
    buffer_store_dword v16, v17, s[32:35], s68 offen sc1
    s_mov_b64 exec, -1
L_ch_finf1:
    s_waitcnt vmcnt(0)
    s_endpgm
L_ch_lbf1:
    s_waitcnt vmcnt(0)
    ds_write_b128 v3, v[60:63] offset:0
    ds_write_b32 v4, v85 offset:0
    v_max3_u32 v16, v60, v62, v85
    v_cmp_eq_u32 vcc, s74, v16
    s_nop 0
    s_cbranch_vccz L_ch_lcf1
L_ch_lrf1:
    s_sub_u32 s65, s65, 1
    s_cbranch_scc1 L_ch_abort
    s_waitcnt lgkmcnt(0)
    buffer_load_dwordx4 v[80:83], v3, s[32:35], s44 offen sc1
    buffer_load_dword v84, v4, s[32:35], s44 offen sc1
    s_waitcnt vmcnt(0)
    ds_write_b128 v3, v[80:83] offset:0
    ds_write_b32 v4, v84 offset:0
    v_max3_u32 v16, v80, v82, v84
    v_cmp_eq_u32 vcc, s74, v16
    s_nop 0
    s_cbranch_vccnz L_ch_lrf1
    s_branch L_ch_lcf1
L_ch_rrf1:
    s_sub_u32 s65, s65, 1
    s_cbranch_scc1 L_ch_abort
    s_waitcnt lgkmcnt(0)
    buffer_load_dwordx4 v[12:15], v3, s[32:35], s45 offen sc1
    buffer_load_dword v19, v4, s[32:35], s45 offen sc1
    s_waitcnt vmcnt(0)
    ds_write_b128 v3, v[12:15] offset:5120
    ds_write_b32 v4, v19 offset:5120
    v_max3_u32 v16, v12, v14, v19
    v_cmp_eq_u32 vcc, s74, v16
    s_nop 0
    s_cbranch_vccnz L_ch_rrf1
    s_waitcnt lgkmcnt(0)
    s_branch L_ch_rokf1
L_ch_pbof1:
    s_sub_u32 s65, s65, 1
    s_cbranch_scc1 L_ch_abort
    buffer_load_dwordx4 v[36:39], v8, s[32:35], s66 offen offset:0 sc1
    buffer_load_dwordx4 v[40:43], v8, s[32:35], s66 offen offset:1024 sc1
    buffer_load_dwordx4 v[44:47], v8, s[32:35], s66 offen offset:2048 sc1
    buffer_load_dwordx4 v[48:51], v8, s[32:35], s66 offen offset:3072 sc1
    s_waitcnt vmcnt(7)
    v_mfma_f32_16x16x32_bf16 v[84:87], v[28:31], v[80:83], 0
    v_xor_b32 v60, s51, v28
    s_waitcnt vmcnt(6)
    v_mfma_f32_16x16x32_bf16 v[84:87], v[32:35], v[80:83], v[84:87]
    v_xor_b32 v61, s51, v32
    s_waitcnt vmcnt(5)
    v_mfma_f32_16x16x32_bf16 v[84:87], v[20:23], v[80:83], v[84:87]
    v_xor_b32 v62, s51, v20
    v_or3_b32 v60, v60, v61, v62
    s_waitcnt vmcnt(4)
    v_mfma_f32_16x16x32_bf16 v[84:87], v[24:27], v[80:83], v[84:87]
    v_xor_b32 v61, s51, v24
    v_or_b32 v60, v60, v61
    v_and_b32 v60, 1, v60
    v_cmp_ne_u32 vcc, 0, v60
    s_nop 3
    v_permlane32_swap_b32 v84, v86
    v_permlane32_swap_b32 v85, v87
    v_pk_add_f32 v[84:85], v[84:85], v[86:87]
    v_cvt_pk_bf16_f32 v84, v84, v85
    v_min_u32 v60, -2, v84
    v_min_u32 v61, -2, v84
    s_nop 1
    v_permlane32_swap_b32 v60, v61
    s_cbranch_vccnz L_ch_paof1
    s_mov_b64 exec, s[58:59]
    buffer_store_dwordx2 v[60:61], v2, s[32:35], s46 offen
    buffer_store_dwordx2 v[60:61], v2, s[32:35], s47 offen sc1
    buffer_store_dwordx2 v[52:53], v2, s[32:35], s49 offen
    s_mov_b64 exec, -1
    s_waitcnt vmcnt(3)
    s_branch L_ch_joinf1
L_ch_paof1:
    buffer_load_dwordx4 v[28:31], v8, s[32:35], s66 offen offset:0 sc1
    buffer_load_dwordx4 v[32:35], v8, s[32:35], s66 offen offset:1024 sc1
    buffer_load_dwordx4 v[20:23], v8, s[32:35], s66 offen offset:2048 sc1
    buffer_load_dwordx4 v[24:27], v8, s[32:35], s66 offen offset:3072 sc1
    s_waitcnt vmcnt(7)
    v_mfma_f32_16x16x32_bf16 v[84:87], v[36:39], v[80:83], 0
    v_xor_b32 v60, s51, v36
    s_waitcnt vmcnt(6)
    v_mfma_f32_16x16x32_bf16 v[84:87], v[40:43], v[80:83], v[84:87]
    v_xor_b32 v61, s51, v40
    s_waitcnt vmcnt(5)
    v_mfma_f32_16x16x32_bf16 v[84:87], v[44:47], v[80:83], v[84:87]
    v_xor_b32 v62, s51, v44
    v_or3_b32 v60, v60, v61, v62
    s_waitcnt vmcnt(4)
    v_mfma_f32_16x16x32_bf16 v[84:87], v[48:51], v[80:83], v[84:87]
    v_xor_b32 v61, s51, v48
    v_or_b32 v60, v60, v61
    v_and_b32 v60, 1, v60
    v_cmp_ne_u32 vcc, 0, v60
    s_nop 3
    v_permlane32_swap_b32 v84, v86
    v_permlane32_swap_b32 v85, v87
    v_pk_add_f32 v[84:85], v[84:85], v[86:87]
    v_cvt_pk_bf16_f32 v84, v84, v85
    v_min_u32 v60, -2, v84
    v_min_u32 v61, -2, v84
    s_nop 1
    v_permlane32_swap_b32 v60, v61
    s_cbranch_vccnz L_ch_pbof1
    s_branch L_ch_pokof1
L_ch_oddf1:
    s_sleep 2
    buffer_load_dwordx4 v[36:39], v8, s[32:35], s66 offen offset:0 sc1
    buffer_load_dwordx4 v[40:43], v8, s[32:35], s66 offen offset:1024 sc1
    buffer_load_dwordx4 v[44:47], v8, s[32:35], s66 offen offset:2048 sc1
    buffer_load_dwordx4 v[48:51], v8, s[32:35], s66 offen offset:3072 sc1
    s_sleep 3
    buffer_load_dwordx4 v[28:31], v8, s[32:35], s66 offen offset:0 sc1
    buffer_load_dwordx4 v[32:35], v8, s[32:35], s66 offen offset:1024 sc1
    buffer_load_dwordx4 v[20:23], v8, s[32:35], s66 offen offset:2048 sc1
    buffer_load_dwordx4 v[24:27], v8, s[32:35], s66 offen offset:3072 sc1
    s_waitcnt vmcnt(7)
    v_mfma_f32_16x16x32_bf16 v[84:87], v[36:39], v[80:83], 0
    v_xor_b32 v60, s51, v36
    s_waitcnt vmcnt(6)
    v_mfma_f32_16x16x32_bf16 v[84:87], v[40:43], v[80:83], v[84:87]
    v_xor_b32 v61, s51, v40
    s_waitcnt vmcnt(5)
    v_mfma_f32_16x16x32_bf16 v[84:87], v[44:47], v[80:83], v[84:87]
    v_xor_b32 v62, s51, v44
    v_or3_b32 v60, v60, v61, v62
    s_waitcnt vmcnt(4)
    v_mfma_f32_16x16x32_bf16 v[84:87], v[48:51], v[80:83], v[84:87]
    v_xor_b32 v61, s51, v48
    v_or_b32 v60, v60, v61
    v_and_b32 v60, 1, v60
    v_cmp_ne_u32 vcc, 0, v60
    s_nop 3
    v_permlane32_swap_b32 v84, v86
    v_permlane32_swap_b32 v85, v87
    v_pk_add_f32 v[84:85], v[84:85], v[86:87]
    v_cvt_pk_bf16_f32 v84, v84, v85
    v_min_u32 v60, -2, v84
    v_min_u32 v61, -2, v84
    s_nop 1
    v_permlane32_swap_b32 v60, v61
    s_cbranch_vccnz L_ch_pbof1
L_ch_pokof1:
    s_mov_b64 exec, s[58:59]
    buffer_store_dwordx2 v[60:61], v2, s[32:35], s46 offen
    buffer_store_dwordx2 v[60:61], v2, s[32:35], s47 offen sc1
    buffer_store_dwordx2 v[52:53], v2, s[32:35], s49 offen
    s_mov_b64 exec, -1
    s_branch L_ch_joinf1
L_ch_pbf1:
    s_sub_u32 s65, s65, 1
    s_cbranch_scc1 L_ch_abort
    buffer_load_dwordx4 v[36:39], v8, s[32:35], s66 offen offset:0 sc1
    buffer_load_dwordx4 v[40:43], v8, s[32:35], s66 offen offset:1024 sc1
    buffer_load_dwordx4 v[44:47], v8, s[32:35], s66 offen offset:2048 sc1
    buffer_load_dwordx4 v[48:51], v8, s[32:35], s66 offen offset:3072 sc1
    s_waitcnt vmcnt(7)
    v_mfma_f32_16x16x32_bf16 v[84:87], v[28:31], v[80:83], 0
    v_xor_b32 v60, s51, v28
    s_waitcnt vmcnt(6)
    v_mfma_f32_16x16x32_bf16 v[84:87], v[32:35], v[80:83], v[84:87]
    v_xor_b32 v61, s51, v32
    s_waitcnt vmcnt(5)
    v_mfma_f32_16x16x32_bf16 v[84:87], v[20:23], v[80:83], v[84:87]
    v_xor_b32 v62, s51, v20
    v_or3_b32 v60, v60, v61, v62
    s_waitcnt vmcnt(4)
    v_mfma_f32_16x16x32_bf16 v[84:87], v[24:27], v[80:83], v[84:87]
    v_xor_b32 v61, s51, v24
    v_or_b32 v60, v60, v61
    v_and_b32 v60, 1, v60
    v_cmp_ne_u32 vcc, 0, v60
    s_nop 3
    v_permlane32_swap_b32 v84, v86
    v_permlane32_swap_b32 v85, v87
    v_pk_add_f32 v[84:85], v[84:85], v[86:87]
    v_cvt_pk_bf16_f32 v84, v84, v85
    v_min_u32 v60, -2, v84
    v_min_u32 v62, -2, v84
    s_nop 1
    v_permlane16_swap_b32 v60, v62
    v_mov_b32 v61, v60
    v_mov_b32 v63, v62
    s_nop 0
    v_permlane32_swap_b32 v60, v61
    v_permlane32_swap_b32 v62, v63
    s_cbranch_vccnz L_ch_paf1
    s_mov_b64 exec, s[58:59]
    buffer_store_dwordx4 v[60:63], v2, s[32:35], s46 offen
    buffer_store_dwordx4 v[60:63], v2, s[32:35], s47 offen sc1
    buffer_store_dwordx4 v[52:55], v2, s[32:35], s49 offen
    s_mov_b64 exec, -1
    s_waitcnt vmcnt(3)
    s_branch L_ch_joinf1
L_ch_paf1:
    buffer_load_dwordx4 v[28:31], v8, s[32:35], s66 offen offset:0 sc1
    buffer_load_dwordx4 v[32:35], v8, s[32:35], s66 offen offset:1024 sc1
    buffer_load_dwordx4 v[20:23], v8, s[32:35], s66 offen offset:2048 sc1
    buffer_load_dwordx4 v[24:27], v8, s[32:35], s66 offen offset:3072 sc1
    s_waitcnt vmcnt(7)
    v_mfma_f32_16x16x32_bf16 v[84:87], v[36:39], v[80:83], 0
    v_xor_b32 v60, s51, v36
    s_waitcnt vmcnt(6)
    v_mfma_f32_16x16x32_bf16 v[84:87], v[40:43], v[80:83], v[84:87]
    v_xor_b32 v61, s51, v40
    s_waitcnt vmcnt(5)
    v_mfma_f32_16x16x32_bf16 v[84:87], v[44:47], v[80:83], v[84:87]
    v_xor_b32 v62, s51, v44
    v_or3_b32 v60, v60, v61, v62
    s_waitcnt vmcnt(4)
    v_mfma_f32_16x16x32_bf16 v[84:87], v[48:51], v[80:83], v[84:87]
    v_xor_b32 v61, s51, v48
    v_or_b32 v60, v60, v61
    v_and_b32 v60, 1, v60
    v_cmp_ne_u32 vcc, 0, v60
    s_nop 3
    v_permlane32_swap_b32 v84, v86
    v_permlane32_swap_b32 v85, v87
    v_pk_add_f32 v[84:85], v[84:85], v[86:87]
    v_cvt_pk_bf16_f32 v84, v84, v85
    v_min_u32 v60, -2, v84
    v_min_u32 v62, -2, v84
    s_nop 1
    v_permlane16_swap_b32 v60, v62
    v_mov_b32 v61, v60
    v_mov_b32 v63, v62
    s_nop 0
    v_permlane32_swap_b32 v60, v61
    v_permlane32_swap_b32 v62, v63
    s_cbranch_vccnz L_ch_pbf1
    s_branch L_ch_pokf1
L_ch_slow:
    s_cmp_eq_u32 s40, 0
    s_cbranch_scc0 L_ch_step_s1
    s_branch L_ch_step_s0
L_ch_step_s0:
    s_sleep 1
    buffer_load_dwordx4 v[80:83], v3, s[32:35], s44 offen sc1
    buffer_load_dword v84, v4, s[32:35], s44 offen sc1
    s_add_u32 m0, s50, 0
    s_sub_u32 s70, s63, 794624
    buffer_load_dwordx4 v8, s[32:35], s70 offen sc1 lds
    buffer_load_dwordx4 v8, s[32:35], s70 offen offset:1024 sc1 lds
    ds_read_b128 v[64:67], v9 offset:12288
    ds_read_b128 v[68:71], v9 offset:13312
    buffer_load_dwordx4 v[60:63], v3, s[32:35], s44 offen sc1
    buffer_load_dword v85, v4, s[32:35], s44 offen sc1
    ds_read_b128 v[72:75], v9 offset:14336
    ds_read_b128 v[76:79], v9 offset:15360
    v_lshlrev_b32 v11, 2, v8
    s_sub_u32 s72, s63, 786432
    s_waitcnt vmcnt(4)
    ds_write_b128 v3, v[80:83] offset:0
    ds_write_b32 v4, v84 offset:0
    v_max3_u32 v16, v80, v82, v84
    v_cmp_eq_u32 vcc, s74, v16
    v_mov_b64 v[28:29], 0
    v_mov_b64 v[30:31], 0
    v_mov_b64 v[32:33], 0
    v_mov_b64 v[34:35], 0
    s_cbranch_vccnz L_ch_lbs0
L_ch_lcs0:
    buffer_load_dwordx4 v[12:15], v3, s[32:35], s45 offen sc1
    buffer_load_dword v19, v4, s[32:35], s45 offen sc1
    buffer_load_dwordx4 v[20:23], v8, s[32:35], s72 offen sc1
    s_waitcnt lgkmcnt(0)
    s_barrier
    ds_read_b128 v[52:55], v8 offset:0
    buffer_load_dwordx4 v[24:27], v8, s[32:35], s72 offen offset:1024 sc1
    s_waitcnt lgkmcnt(0)
    v_smfmac_f32_16x16x64_bf16 v[28:31], v[52:55], v[64:71], v10
    s_waitcnt vmcnt(4)
    ds_read_b128 v[80:83], v9 offset:16384
    v_smfmac_f32_16x16x64_bf16 v[36:39], v[52:55], a[0:7], v10
    ds_read_b128 v[60:63], v8 offset:1024
    ds_read_b128 v[84:87], v9 offset:17408
    v_smfmac_f32_16x16x64_bf16 v[40:43], v[52:55], a[160:167], v10
    ds_read_b128 v[64:67], v9 offset:18432
    v_smfmac_f32_16x16x64_bf16 v[32:35], v[52:55], v[72:79], v10
    ds_read_b128 v[68:71], v9 offset:19456
    v_smfmac_f32_16x16x64_bf16 v[44:47], v[52:55], a[8:15], v10
    ds_read_b128 v[72:75], v9 offset:20480
    v_smfmac_f32_16x16x64_bf16 v[48:51], v[52:55], a[168:175], v10
    ds_read_b128 v[76:79], v9 offset:21504
    s_waitcnt lgkmcnt(4)
    v_smfmac_f32_16x16x64_bf16 v[28:31], v[60:63], v[80:87], v10
    ds_read_b128 v[52:55], v8 offset:2048
    v_smfmac_f32_16x16x64_bf16 v[36:39], v[60:63], a[16:23], v10
    ds_read_b128 v[80:83], v9 offset:22528
    v_smfmac_f32_16x16x64_bf16 v[40:43], v[60:63], a[176:183], v10
    ds_read_b128 v[84:87], v9 offset:23552
    s_waitcnt lgkmcnt(5)
    v_smfmac_f32_16x16x64_bf16 v[32:35], v[60:63], v[64:71], v10
    ds_read_b128 v[64:67], v9 offset:24576
    v_smfmac_f32_16x16x64_bf16 v[44:47], v[60:63], a[24:31], v10
    ds_read_b128 v[68:71], v9 offset:25600
    v_smfmac_f32_16x16x64_bf16 v[48:51], v[60:63], a[184:191], v10
    s_waitcnt lgkmcnt(4)
    v_smfmac_f32_16x16x64_bf16 v[28:31], v[52:55], v[72:79], v10
    ds_read_b128 v[60:63], v8 offset:3072
    v_smfmac_f32_16x16x64_bf16 v[36:39], v[52:55], a[32:39], v10
    ds_read_b128 v[72:75], v9 offset:26624
    v_smfmac_f32_16x16x64_bf16 v[40:43], v[52:55], a[192:199], v10
    ds_read_b128 v[76:79], v9 offset:27648
    s_waitcnt lgkmcnt(5)
    v_smfmac_f32_16x16x64_bf16 v[32:35], v[52:55], v[80:87], v10
    ds_read_b128 v[80:83], v9 offset:28672
    v_smfmac_f32_16x16x64_bf16 v[44:47], v[52:55], a[40:47], v10
    ds_read_b128 v[84:87], v9 offset:29696
    v_smfmac_f32_16x16x64_bf16 v[48:51], v[52:55], a[200:207], v10
    s_waitcnt vmcnt(2)
    ds_write_b128 v3, v[12:15] offset:5120
    s_waitcnt lgkmcnt(5)
    v_smfmac_f32_16x16x64_bf16 v[28:31], v[60:63], v[64:71], v10
    ds_write_b32 v4, v19 offset:5120
    v_smfmac_f32_16x16x64_bf16 v[36:39], v[60:63], a[48:55], v10
    v_max3_u32 v16, v12, v14, v19
    ds_read_b128 v[52:55], v8 offset:4096
    v_smfmac_f32_16x16x64_bf16 v[40:43], v[60:63], a[208:215], v10
    v_cmp_eq_u32 vcc, s74, v16
    s_waitcnt lgkmcnt(5)
    v_smfmac_f32_16x16x64_bf16 v[32:35], v[60:63], v[72:79], v10
    ds_read_b128 v[64:67], v9 offset:30720
    v_smfmac_f32_16x16x64_bf16 v[44:47], v[60:63], a[56:63], v10
    s_cbranch_vccnz L_ch_rrs0
L_ch_roks0:
    s_waitcnt lgkmcnt(2)
    s_barrier
    ds_read_b128 v[68:71], v9 offset:31744
    v_smfmac_f32_16x16x64_bf16 v[48:51], v[60:63], a[216:223], v10
    ds_read_b128 v[72:75], v9 offset:0
    s_waitcnt lgkmcnt(3)
    v_smfmac_f32_16x16x64_bf16 v[28:31], v[52:55], v[80:87], v10
    ds_read_b128 v[60:63], v8 offset:5120
    v_smfmac_f32_16x16x64_bf16 v[36:39], v[52:55], a[64:71], v10
    s_waitcnt vmcnt(0)
    buffer_load_dword v11, v11, s[80:83], s87 offen sc1
    ds_read_b128 v[76:79], v9 offset:1024
    v_smfmac_f32_16x16x64_bf16 v[40:43], v[52:55], a[224:231], v10
    ds_read_b128 v[80:83], v9 offset:2048
    s_waitcnt lgkmcnt(4)
    v_smfmac_f32_16x16x64_bf16 v[32:35], v[52:55], v[64:71], v10
    ds_read_b128 v[84:87], v9 offset:3072
    v_smfmac_f32_16x16x64_bf16 v[44:47], v[52:55], a[72:79], v10
    ds_read_b128 v[64:67], v9 offset:4096
    v_smfmac_f32_16x16x64_bf16 v[48:51], v[52:55], a[232:239], v10
    ds_read_b128 v[68:71], v9 offset:5120
    s_waitcnt lgkmcnt(4)
    v_smfmac_f32_16x16x64_bf16 v[28:31], v[60:63], v[72:79], v10
    ds_read_b128 v[52:55], v8 offset:6144
    v_smfmac_f32_16x16x64_bf16 v[36:39], v[60:63], a[80:87], v10
    buffer_store_dwordx4 v[56:59], v8, s[32:35], s64 offen sc1
    v_smfmac_f32_16x16x64_bf16 v[40:43], v[60:63], a[240:247], v10
    ds_read_b128 v[72:75], v9 offset:6144
    s_waitcnt lgkmcnt(4)
    v_smfmac_f32_16x16x64_bf16 v[32:35], v[60:63], v[80:87], v10
    ds_read_b128 v[76:79], v9 offset:7168
    v_smfmac_f32_16x16x64_bf16 v[44:47], v[60:63], a[88:95], v10
    ds_read_b128 v[80:83], v9 offset:8192
    v_smfmac_f32_16x16x64_bf16 v[48:51], v[60:63], a[248:255], v10
    ds_read_b128 v[84:87], v9 offset:9216
    s_waitcnt lgkmcnt(4)
    v_smfmac_f32_16x16x64_bf16 v[28:31], v[52:55], v[64:71], v10
    ds_read_b128 v[60:63], v8 offset:7168
    v_smfmac_f32_16x16x64_bf16 v[36:39], v[52:55], a[96:103], v10
    ds_read_b128 v[64:67], v9 offset:10240
    v_smfmac_f32_16x16x64_bf16 v[40:43], v[52:55], v[88:95], v10
    ds_read_b128 v[68:71], v9 offset:11264
    s_waitcnt lgkmcnt(5)
    v_smfmac_f32_16x16x64_bf16 v[32:35], v[52:55], v[72:79], v10
    ds_read_b128 v[72:75], v9 offset:32768
    v_smfmac_f32_16x16x64_bf16 v[44:47], v[52:55], a[104:111], v10
    ds_read_b128 v[76:79], v9 offset:33792
    v_smfmac_f32_16x16x64_bf16 v[48:51], v[52:55], v[96:103], v10
    s_waitcnt lgkmcnt(4)
    v_smfmac_f32_16x16x64_bf16 v[28:31], v[60:63], v[80:87], v10
    ds_read_b128 v[52:55], v8 offset:8192
    v_smfmac_f32_16x16x64_bf16 v[36:39], v[60:63], a[112:119], v10
    ds_read_b128 v[80:83], v8 offset:9216
    v_smfmac_f32_16x16x64_bf16 v[40:43], v[60:63], v[104:111], v10
    s_waitcnt lgkmcnt(4)
    v_smfmac_f32_16x16x64_bf16 v[32:35], v[60:63], v[64:71], v10
    ds_read_b128 v[64:67], v8 offset:18432
    v_smfmac_f32_16x16x64_bf16 v[44:47], v[60:63], a[120:127], v10
    v_bfe_u32 v14, v8, 4, 3
    v_lshlrev_b32 v14, 7, v14
    v_smfmac_f32_16x16x64_bf16 v[48:51], v[60:63], v[112:119], v10
    buffer_load_dword v15, v14, s[24:27], s69 offen sc1
    s_waitcnt lgkmcnt(2)
    v_smfmac_f32_16x16x64_bf16 v[36:39], v[52:55], a[128:135], v10
    v_mov_b32 v16, s43
    v_smfmac_f32_16x16x64_bf16 v[40:43], v[52:55], v[120:127], v10
    ds_read_b128 v[60:63], v8 offset:16384
    v_smfmac_f32_16x16x64_bf16 v[44:47], v[52:55], a[136:143], v10
    ds_read_b128 v[84:87], v8 offset:17408
    v_smfmac_f32_16x16x64_bf16 v[48:51], v[52:55], v[128:135], v10
    ds_read_b128 v[68:71], v8 offset:19456
    s_waitcnt lgkmcnt(4)
    v_smfmac_f32_16x16x64_bf16 v[36:39], v[80:83], a[144:151], v10
    s_mov_b64 exec, s[38:39]
    buffer_store_dword v16, v17, s[32:35], s68 offen sc1
    s_mov_b64 exec, -1
    v_smfmac_f32_16x16x64_bf16 v[40:43], v[80:83], v[136:143], v10
    v_xor_b32 v12, 128, v6
    v_smfmac_f32_16x16x64_bf16 v[44:47], v[80:83], a[152:159], v10
    v_xor_b32 v13, 128, v7
    v_smfmac_f32_16x16x64_bf16 v[48:51], v[80:83], v[144:151], v10
    v_pk_add_f32 v[36:37], v[36:37], v[38:39]
    v_smfmac_f32_16x16x64_bf16 v[32:35], v[52:55], v[232:239], v10
    v_pk_add_f32 v[40:41], v[40:41], v[42:43]
    v_cvt_pk_bf16_f32 v38, v36, v37
    v_cvt_pk_bf16_f32 v39, v40, v41
    ds_write_b64 v6, v[38:39]
    v_pk_add_f32 v[44:45], v[44:45], v[46:47]
    v_pk_add_f32 v[48:49], v[48:49], v[50:51]
    v_cvt_pk_bf16_f32 v46, v44, v45
    v_cvt_pk_bf16_f32 v47, v48, v49
    ds_write_b64 v12, v[46:47]
    v_smfmac_f32_16x16x64_bf16 v[28:31], v[52:55], v[72:79], v10
    v_smfmac_f32_16x16x64_bf16 v[32:35], v[80:83], v[248:255], v10
    v_mov_b32 v58, v39
    v_mov_b32 v59, v47
    s_cmp_eq_u32 s43, 63
    s_cbranch_scc1 L_ch_lasts0
    s_waitcnt lgkmcnt(0)
    s_barrier
    ds_read_b64_tr_b16 v[48:49], v7 offset:0
    ds_read_b64_tr_b16 v[50:51], v13 offset:0
    ds_read_b64_tr_b16 v[72:73], v7 offset:256
    ds_read_b64_tr_b16 v[74:75], v13 offset:256
    v_smfmac_f32_16x16x64_bf16 v[28:31], v[80:83], v[240:247], v10
    s_waitcnt lgkmcnt(2)
    v_mfma_f32_16x16x32_bf16 v[36:39], v[60:63], v[48:51], 0
    ds_read_b128 v[60:63], v8 offset:20480
    v_mfma_f32_16x16x32_bf16 v[40:43], v[84:87], v[48:51], 0
    ds_read_b128 v[84:87], v8 offset:21504
    v_mfma_f32_16x16x32_bf16 v[44:47], v[48:51], v[48:51], 0
    ds_read_b64_tr_b16 v[48:49], v7 offset:512
    ds_read_b64_tr_b16 v[50:51], v13 offset:512
    s_waitcnt lgkmcnt(4)
    v_mfma_f32_16x16x32_bf16 v[36:39], v[64:67], v[72:75], v[36:39]
    ds_read_b128 v[64:67], v8 offset:22528
    v_mfma_f32_16x16x32_bf16 v[40:43], v[68:71], v[72:75], v[40:43]
    ds_read_b128 v[68:71], v8 offset:23552
    v_mfma_f32_16x16x32_bf16 v[44:47], v[72:75], v[72:75], v[44:47]
    ds_read_b64_tr_b16 v[72:73], v7 offset:768
    ds_read_b64_tr_b16 v[74:75], v13 offset:768
    s_waitcnt lgkmcnt(4)
    v_mfma_f32_16x16x32_bf16 v[36:39], v[60:63], v[48:51], v[36:39]
    v_mfma_f32_16x16x32_bf16 v[40:43], v[84:87], v[48:51], v[40:43]
    v_mfma_f32_16x16x32_bf16 v[44:47], v[48:51], v[48:51], v[44:47]
    s_waitcnt lgkmcnt(0)
    v_mfma_f32_16x16x32_bf16 v[36:39], v[64:67], v[72:75], v[36:39]
    v_mfma_f32_16x16x32_bf16 v[40:43], v[68:71], v[72:75], v[40:43]
    v_mfma_f32_16x16x32_bf16 v[44:47], v[72:75], v[72:75], v[44:47]
    v_pk_add_f32 v[28:29], v[28:29], v[30:31]
    v_pk_add_f32 v[32:33], v[32:33], v[34:35]
    v_cvt_pk_bf16_f32 v56, v28, v29
    v_cvt_pk_bf16_f32 v57, v32, v33
    v_cvt_pk_bf16_f32 v18, v32, v33
    v_max3_f32 v52, v36, v37, v38
    v_max3_f32 v53, v40, v41, v42
    v_max3_f32 v52, v52, v39, v43
    v_max3_f32 v53, v53, v46, v47
    v_max_f32 v54, v52, v53
    v_max_f32 v55, v52, v53
    v_mov_b64 v[76:77], s[36:37]
    v_mov_b64 v[78:79], s[36:37]
    v_permlane16_swap_b32 v54, v55
    v_max_f32 v52, v54, v55
    v_max_f32 v53, v54, v55
    v_add_u32 v14, s48, v8
    v_mov_b64 v[60:61], 0
    v_permlane32_swap_b32 v52, v53
    v_max_f32 v52, v52, v53
    v_mul_f32 v52, s54, v52
    v_pk_fma_f32 v[46:47], v[46:47], s[54:55], v[52:53] op_sel_hi:[1,0,0] neg_lo:[0,0,1] neg_hi:[0,0,1]
    v_pk_fma_f32 v[36:37], v[36:37], s[54:55], v[52:53] op_sel_hi:[1,0,0] neg_lo:[0,0,1] neg_hi:[0,0,1]
    v_pk_fma_f32 v[38:39], v[38:39], s[54:55], v[52:53] op_sel_hi:[1,0,0] neg_lo:[0,0,1] neg_hi:[0,0,1]
    v_pk_fma_f32 v[40:41], v[40:41], s[54:55], v[52:53] op_sel_hi:[1,0,0] neg_lo:[0,0,1] neg_hi:[0,0,1]
    v_pk_fma_f32 v[42:43], v[42:43], s[54:55], v[52:53] op_sel_hi:[1,0,0] neg_lo:[0,0,1] neg_hi:[0,0,1]
    v_exp_f32 v46, v46
    v_exp_f32 v47, v47
    v_exp_f32 v36, v36
    v_cvt_pk_bf16_f32 v16, v46, v47
    v_exp_f32 v37, v37
    v_exp_f32 v38, v38
    v_mfma_f32_16x16x16_bf16 v[72:75], v[76:77], v[16:17], 0
    v_exp_f32 v39, v39
    v_mfma_f32_16x16x16_bf16 v[64:67], v[56:57], v[16:17], 0
    v_exp_f32 v40, v40
    v_mfma_f32_16x16x16_bf16 v[68:71], v[18:19], v[16:17], 0
    v_exp_f32 v41, v41
    v_exp_f32 v42, v42
    v_exp_f32 v43, v43
    v_cvt_pk_bf16_f32 v48, v36, v37
    v_cvt_pk_bf16_f32 v49, v38, v39
    v_cvt_pk_bf16_f32 v50, v40, v41
    v_cvt_pk_bf16_f32 v51, v42, v43
    v_mov_b64 v[62:63], 0
    v_mov_b64 v[36:37], 0
    v_mfma_f32_16x16x32_bf16 v[72:75], v[76:79], v[48:51], v[72:75]
    v_mov_b64 v[38:39], 0
    v_mfma_f32_16x16x32_bf16 v[64:67], v[20:23], v[48:51], v[64:67]
    v_mov_b64 v[40:41], 0
    v_mfma_f32_16x16x32_bf16 v[68:71], v[24:27], v[48:51], v[68:71]
    v_mov_b64 v[42:43], 0
    v_rcp_f32 v52, v72
    v_mov_b64 v[44:45], 0
    s_nop 1
    v_pk_mul_f32 v[64:65], v[64:65], v[52:53] op_sel_hi:[1,0]
    v_pk_mul_f32 v[66:67], v[66:67], v[52:53] op_sel_hi:[1,0]
    v_cvt_pk_bf16_f32 v72, v64, v65
    v_cvt_pk_bf16_f32 v73, v66, v67
    v_pk_mul_f32 v[68:69], v[68:69], v[52:53] op_sel_hi:[1,0]
    v_pk_mul_f32 v[70:71], v[70:71], v[52:53] op_sel_hi:[1,0]
    v_cvt_pk_bf16_f32 v74, v68, v69
    v_cvt_pk_bf16_f32 v75, v70, v71
    s_mov_b64 exec, s[60:61]
    ds_write_b128 v14, v[72:75]
    s_mov_b64 exec, -1
    v_mov_b64 v[46:47], 0
    v_mov_b64 v[48:49], 0
    v_mov_b64 v[50:51], 0
    v_min_u32 v56, -2, v56
    s_waitcnt lgkmcnt(0)
    s_barrier
    ds_read_b128 v[64:67], v8 offset:10240
    ds_read_b128 v[68:71], v8 offset:11264
    s_waitcnt lgkmcnt(1)
    v_smfmac_f32_16x16x64_bf16 v[60:63], v[64:67], v[216:223], v10
    s_waitcnt lgkmcnt(0)
    v_smfmac_f32_16x16x64_bf16 v[60:63], v[68:71], v[224:231], v10
    v_smfmac_f32_16x16x64_bf16 v[36:39], v[64:67], v[152:159], v10
    v_smfmac_f32_16x16x64_bf16 v[36:39], v[68:71], v[160:167], v10
    v_smfmac_f32_16x16x64_bf16 v[40:43], v[64:67], v[168:175], v10
    v_pk_add_f32 v[60:61], v[60:61], v[62:63]
    v_smfmac_f32_16x16x64_bf16 v[40:43], v[68:71], v[176:183], v10
    v_cvt_pk_bf16_f32 v76, v60, v61
    v_smfmac_f32_16x16x64_bf16 v[44:47], v[64:67], v[184:191], v10
    v_pk_add_f32 v[36:37], v[36:37], v[38:39]
    v_smfmac_f32_16x16x64_bf16 v[44:47], v[68:71], v[192:199], v10
    v_mov_b32_dpp v77, v76 row_shl:8 row_mask:0xf bank_mask:0xf
    v_smfmac_f32_16x16x64_bf16 v[48:51], v[64:67], v[200:207], v10
    v_mov_b32_dpp v78, v76 row_shl:4 row_mask:0xf bank_mask:0xf
    v_smfmac_f32_16x16x64_bf16 v[48:51], v[68:71], v[208:215], v10
    v_mov_b32_dpp v79, v76 row_shl:12 row_mask:0xf bank_mask:0xf
    v_bfi_b32 v76, 1, s51, v76
    s_mov_b64 exec, s[56:57]
    buffer_store_dwordx4 v[76:79], v1, s[32:35], 0 offen sc1
    s_mov_b64 exec, -1
    v_cvt_pk_bf16_f32 v72, v36, v37
    v_pk_add_f32 v[40:41], v[40:41], v[42:43]
    v_pk_add_f32 v[44:45], v[44:45], v[46:47]
    v_bfi_b32 v72, 1, s51, v72
    v_cvt_pk_bf16_f32 v73, v40, v41
    v_pk_add_f32 v[48:49], v[48:49], v[50:51]
    v_cvt_pk_bf16_f32 v74, v44, v45
    v_cvt_pk_bf16_f32 v75, v48, v49
    buffer_store_dwordx4 v[72:75], v0, s[32:35], 0 offen sc1
    s_cmp_ge_u32 s53, 40
    s_cbranch_scc1 L_ch_noreds0
    v_bfe_u32 v60, v8, 4, 1
    v_lshlrev_b32 v60, 4, v60
    v_mov_b32 v61, 0x3f80
    v_lshlrev_b32 v61, v60, v61
    v_bfe_u32 v60, v8, 5, 2
    v_cmp_eq_u32 vcc, 0, v60
    s_nop 1
    v_cndmask_b32 v80, 0, v61, vcc
    v_cmp_eq_u32 vcc, 1, v60
    s_nop 1
    v_cndmask_b32 v81, 0, v61, vcc
    v_cmp_eq_u32 vcc, 2, v60
    s_nop 1
    v_cndmask_b32 v82, 0, v61, vcc
    v_cmp_eq_u32 vcc, 3, v60
    s_nop 1
    v_cndmask_b32 v83, 0, v61, vcc
    v_mov_b64 v[52:53], -1
    v_mov_b64 v[54:55], -1
    s_cmp_ge_u32 s53, 32
    s_cbranch_scc1 L_ch_odds0
    s_sleep 3
    buffer_load_dwordx4 v[36:39], v8, s[32:35], s66 offen offset:0 sc1
    buffer_load_dwordx4 v[40:43], v8, s[32:35], s66 offen offset:1024 sc1
    buffer_load_dwordx4 v[44:47], v8, s[32:35], s66 offen offset:2048 sc1
    buffer_load_dwordx4 v[48:51], v8, s[32:35], s66 offen offset:3072 sc1
    s_sleep 3
    buffer_load_dwordx4 v[28:31], v8, s[32:35], s66 offen offset:0 sc1
    buffer_load_dwordx4 v[32:35], v8, s[32:35], s66 offen offset:1024 sc1
    buffer_load_dwordx4 v[20:23], v8, s[32:35], s66 offen offset:2048 sc1
    buffer_load_dwordx4 v[24:27], v8, s[32:35], s66 offen offset:3072 sc1
    s_waitcnt vmcnt(7)
    v_mfma_f32_16x16x32_bf16 v[84:87], v[36:39], v[80:83], 0
    v_xor_b32 v60, s51, v36
    s_waitcnt vmcnt(6)
    v_mfma_f32_16x16x32_bf16 v[84:87], v[40:43], v[80:83], v[84:87]
    v_xor_b32 v61, s51, v40
    s_waitcnt vmcnt(5)
    v_mfma_f32_16x16x32_bf16 v[84:87], v[44:47], v[80:83], v[84:87]
    v_xor_b32 v62, s51, v44
    v_or3_b32 v60, v60, v61, v62
    s_waitcnt vmcnt(4)
    v_mfma_f32_16x16x32_bf16 v[84:87], v[48:51], v[80:83], v[84:87]
    v_xor_b32 v61, s51, v48
    v_or_b32 v60, v60, v61
    v_and_b32 v60, 1, v60
    v_cmp_ne_u32 vcc, 0, v60
    s_nop 3
    v_permlane32_swap_b32 v84, v86
    v_permlane32_swap_b32 v85, v87
    v_pk_add_f32 v[84:85], v[84:85], v[86:87]
    v_cvt_pk_bf16_f32 v84, v84, v85
    v_min_u32 v60, -2, v84
    v_min_u32 v62, -2, v84
    s_nop 1
    v_permlane16_swap_b32 v60, v62
    v_mov_b32 v61, v60
    v_mov_b32 v63, v62
    s_nop 0
    v_permlane32_swap_b32 v60, v61
    v_permlane32_swap_b32 v62, v63
    s_cbranch_vccnz L_ch_pbs0
L_ch_poks0:
    s_mov_b64 exec, s[58:59]
    buffer_store_dwordx4 v[60:63], v2, s[32:35], s46 offen sc1
    buffer_store_dwordx4 v[60:63], v2, s[32:35], s47 offen sc1
    buffer_store_dwordx4 v[52:55], v2, s[32:35], s49 offen sc1
    s_mov_b64 exec, -1
L_ch_joins0:
    v_mov_b64 v[36:37], 0
    v_mov_b64 v[38:39], 0
    v_mov_b64 v[40:41], 0
    v_mov_b64 v[42:43], 0
    v_mov_b64 v[44:45], 0
    v_mov_b64 v[46:47], 0
    v_mov_b64 v[48:49], 0
    v_mov_b64 v[50:51], 0
    s_barrier
    s_not_b64 s[88:89], s[88:89]
    s_add_u32 s45, s45, 32768
    s_add_u32 s62, s62, 786432
    s_add_u32 s87, s87, 786432
    s_add_u32 s63, s63, 786432
    s_add_u32 s64, s64, 131072
    s_add_u32 s43, s43, 1
    s_xor_b32 s51, s51, 1
    s_mov_b32 s70, s44
    s_mov_b32 s44, s46
    s_mov_b32 s46, s49
    s_mov_b32 s49, s70
    s_add_u32 s47, s47, 32768
    s_cmp_eq_u32 s43, 63
    s_cselect_b32 s82, 0, s82
    s_and_b32 s70, s43, 7
    s_cmp_eq_u32 s70, 5
    s_cselect_b32 s26, 98631680, 0
    s_and_b32 s70, s43, 3
    s_cmp_ge_u32 s43, 54
    s_cselect_b32 s70, 0, s70
    s_cmp_eq_u32 s70, 0
    s_cselect_b32 s38, s23, 0
    s_branch L_ch_step_s0
L_ch_noreds0:
    s_waitcnt vmcnt(0)
    s_cmp_eq_u32 s26, 0
    s_cbranch_scc1 L_ch_kvbs0
    v_add_u32_dpp v15, v15, v15 row_shr:1 row_mask:0xf bank_mask:0xf bound_ctrl:0
    s_nop 1
    v_add_u32_dpp v15, v15, v15 row_shr:2 row_mask:0xf bank_mask:0xf bound_ctrl:0
    s_nop 1
    v_add_u32_dpp v15, v15, v15 row_shr:4 row_mask:0xf bank_mask:0xf bound_ctrl:0
    s_nop 0
    v_readlane_b32 s70, v15, 7
    s_nop 0
    s_cmp_lt_u32 s70, 128
    s_cbranch_scc1 L_ch_kvws0
L_ch_kvbs0:
    s_add_u32 s71, s43, 4
    s_lshr_b32 s71, s71, 3
    s_min_u32 s71, s71, 7
    s_lshl_b32 s71, s71, 10
    s_add_u32 s69, s71, 95830016
    s_branch L_ch_joins0
L_ch_lasts0:
    v_smfmac_f32_16x16x64_bf16 v[28:31], v[80:83], v[240:247], v10
    s_nop 7
    v_pk_add_f32 v[28:29], v[28:29], v[30:31]
    v_pk_add_f32 v[32:33], v[32:33], v[34:35]
    v_cvt_pk_bf16_f32 v56, v28, v29
    v_cvt_pk_bf16_f32 v57, v32, v33
    s_add_u32 s64, s64, 131072
    v_min_u32 v56, -2, v56
    buffer_store_dwordx4 v[56:59], v8, s[32:35], s64 offen sc1
    s_waitcnt vmcnt(0) lgkmcnt(0)
    s_barrier
    s_cmp_lg_u32 s42, 3
    s_cbranch_scc1 L_ch_fins0
    s_mov_b32 s71, 65
    v_mov_b32 v16, s71
    s_mov_b64 exec, 1
    buffer_store_dword v16, v17, s[32:35], s68 offen sc1
    s_mov_b64 exec, -1
L_ch_fins0:
    s_waitcnt vmcnt(0)
    s_endpgm
L_ch_lbs0:
    s_waitcnt vmcnt(0)
    ds_write_b128 v3, v[60:63] offset:0
    ds_write_b32 v4, v85 offset:0
    v_max3_u32 v16, v60, v62, v85
    v_cmp_eq_u32 vcc, s74, v16
    s_nop 0
    s_cbranch_vccz L_ch_lcs0
L_ch_lrs0:
    s_sub_u32 s65, s65, 1
    s_cbranch_scc1 L_ch_abort
    s_waitcnt lgkmcnt(0)
    buffer_load_dwordx4 v[80:83], v3, s[32:35], s44 offen sc1
    buffer_load_dword v84, v4, s[32:35], s44 offen sc1
    s_waitcnt vmcnt(0)
    ds_write_b128 v3, v[80:83] offset:0
    ds_write_b32 v4, v84 offset:0
    v_max3_u32 v16, v80, v82, v84
    v_cmp_eq_u32 vcc, s74, v16
    s_nop 0
    s_cbranch_vccnz L_ch_lrs0
    s_branch L_ch_lcs0
L_ch_rrs0:
    s_sub_u32 s65, s65, 1
    s_cbranch_scc1 L_ch_abort
    s_waitcnt lgkmcnt(0)
    buffer_load_dwordx4 v[12:15], v3, s[32:35], s45 offen sc1
    buffer_load_dword v19, v4, s[32:35], s45 offen sc1
    s_waitcnt vmcnt(0)
    ds_write_b128 v3, v[12:15] offset:5120
    ds_write_b32 v4, v19 offset:5120
    v_max3_u32 v16, v12, v14, v19
    v_cmp_eq_u32 vcc, s74, v16
    s_nop 0
    s_cbranch_vccnz L_ch_rrs0
    s_waitcnt lgkmcnt(0)
    s_branch L_ch_roks0
L_ch_pbos0:
    s_sub_u32 s65, s65, 1
    s_cbranch_scc1 L_ch_abort
    buffer_load_dwordx4 v[36:39], v8, s[32:35], s66 offen offset:0 sc1
    buffer_load_dwordx4 v[40:43], v8, s[32:35], s66 offen offset:1024 sc1
    buffer_load_dwordx4 v[44:47], v8, s[32:35], s66 offen offset:2048 sc1
    buffer_load_dwordx4 v[48:51], v8, s[32:35], s66 offen offset:3072 sc1
    s_waitcnt vmcnt(7)
    v_mfma_f32_16x16x32_bf16 v[84:87], v[28:31], v[80:83], 0
    v_xor_b32 v60, s51, v28
    s_waitcnt vmcnt(6)
    v_mfma_f32_16x16x32_bf16 v[84:87], v[32:35], v[80:83], v[84:87]
    v_xor_b32 v61, s51, v32
    s_waitcnt vmcnt(5)
    v_mfma_f32_16x16x32_bf16 v[84:87], v[20:23], v[80:83], v[84:87]
    v_xor_b32 v62, s51, v20
    v_or3_b32 v60, v60, v61, v62
    s_waitcnt vmcnt(4)
    v_mfma_f32_16x16x32_bf16 v[84:87], v[24:27], v[80:83], v[84:87]
    v_xor_b32 v61, s51, v24
    v_or_b32 v60, v60, v61
    v_and_b32 v60, 1, v60
    v_cmp_ne_u32 vcc, 0, v60
    s_nop 3
    v_permlane32_swap_b32 v84, v86
    v_permlane32_swap_b32 v85, v87
    v_pk_add_f32 v[84:85], v[84:85], v[86:87]
    v_cvt_pk_bf16_f32 v84, v84, v85
    v_min_u32 v60, -2, v84
    v_min_u32 v61, -2, v84
    s_nop 1
    v_permlane32_swap_b32 v60, v61
    s_cbranch_vccnz L_ch_paos0
    s_mov_b64 exec, s[58:59]
    buffer_store_dwordx2 v[60:61], v2, s[32:35], s46 offen sc1
    buffer_store_dwordx2 v[60:61], v2, s[32:35], s47 offen sc1
    buffer_store_dwordx2 v[52:53], v2, s[32:35], s49 offen sc1
    s_mov_b64 exec, -1
    s_waitcnt vmcnt(3)
    s_branch L_ch_joins0
L_ch_paos0:
    buffer_load_dwordx4 v[28:31], v8, s[32:35], s66 offen offset:0 sc1
    buffer_load_dwordx4 v[32:35], v8, s[32:35], s66 offen offset:1024 sc1
    buffer_load_dwordx4 v[20:23], v8, s[32:35], s66 offen offset:2048 sc1
    buffer_load_dwordx4 v[24:27], v8, s[32:35], s66 offen offset:3072 sc1
    s_waitcnt vmcnt(7)
    v_mfma_f32_16x16x32_bf16 v[84:87], v[36:39], v[80:83], 0
    v_xor_b32 v60, s51, v36
    s_waitcnt vmcnt(6)
    v_mfma_f32_16x16x32_bf16 v[84:87], v[40:43], v[80:83], v[84:87]
    v_xor_b32 v61, s51, v40
    s_waitcnt vmcnt(5)
    v_mfma_f32_16x16x32_bf16 v[84:87], v[44:47], v[80:83], v[84:87]
    v_xor_b32 v62, s51, v44
    v_or3_b32 v60, v60, v61, v62
    s_waitcnt vmcnt(4)
    v_mfma_f32_16x16x32_bf16 v[84:87], v[48:51], v[80:83], v[84:87]
    v_xor_b32 v61, s51, v48
    v_or_b32 v60, v60, v61
    v_and_b32 v60, 1, v60
    v_cmp_ne_u32 vcc, 0, v60
    s_nop 3
    v_permlane32_swap_b32 v84, v86
    v_permlane32_swap_b32 v85, v87
    v_pk_add_f32 v[84:85], v[84:85], v[86:87]
    v_cvt_pk_bf16_f32 v84, v84, v85
    v_min_u32 v60, -2, v84
    v_min_u32 v61, -2, v84
    s_nop 1
    v_permlane32_swap_b32 v60, v61
    s_cbranch_vccnz L_ch_pbos0
    s_branch L_ch_pokos0
L_ch_odds0:
    s_sleep 2
    buffer_load_dwordx4 v[36:39], v8, s[32:35], s66 offen offset:0 sc1
    buffer_load_dwordx4 v[40:43], v8, s[32:35], s66 offen offset:1024 sc1
    buffer_load_dwordx4 v[44:47], v8, s[32:35], s66 offen offset:2048 sc1
    buffer_load_dwordx4 v[48:51], v8, s[32:35], s66 offen offset:3072 sc1
    s_sleep 3
    buffer_load_dwordx4 v[28:31], v8, s[32:35], s66 offen offset:0 sc1
    buffer_load_dwordx4 v[32:35], v8, s[32:35], s66 offen offset:1024 sc1
    buffer_load_dwordx4 v[20:23], v8, s[32:35], s66 offen offset:2048 sc1
    buffer_load_dwordx4 v[24:27], v8, s[32:35], s66 offen offset:3072 sc1
    s_waitcnt vmcnt(7)
    v_mfma_f32_16x16x32_bf16 v[84:87], v[36:39], v[80:83], 0
    v_xor_b32 v60, s51, v36
    s_waitcnt vmcnt(6)
    v_mfma_f32_16x16x32_bf16 v[84:87], v[40:43], v[80:83], v[84:87]
    v_xor_b32 v61, s51, v40
    s_waitcnt vmcnt(5)
    v_mfma_f32_16x16x32_bf16 v[84:87], v[44:47], v[80:83], v[84:87]
    v_xor_b32 v62, s51, v44
    v_or3_b32 v60, v60, v61, v62
    s_waitcnt vmcnt(4)
    v_mfma_f32_16x16x32_bf16 v[84:87], v[48:51], v[80:83], v[84:87]
    v_xor_b32 v61, s51, v48
    v_or_b32 v60, v60, v61
    v_and_b32 v60, 1, v60
    v_cmp_ne_u32 vcc, 0, v60
    s_nop 3
    v_permlane32_swap_b32 v84, v86
    v_permlane32_swap_b32 v85, v87
    v_pk_add_f32 v[84:85], v[84:85], v[86:87]
    v_cvt_pk_bf16_f32 v84, v84, v85
    v_min_u32 v60, -2, v84
    v_min_u32 v61, -2, v84
    s_nop 1
    v_permlane32_swap_b32 v60, v61
    s_cbranch_vccnz L_ch_pbos0
L_ch_pokos0:
    s_mov_b64 exec, s[58:59]
    buffer_store_dwordx2 v[60:61], v2, s[32:35], s46 offen sc1
    buffer_store_dwordx2 v[60:61], v2, s[32:35], s47 offen sc1
    buffer_store_dwordx2 v[52:53], v2, s[32:35], s49 offen sc1
    s_mov_b64 exec, -1
    s_branch L_ch_joins0
L_ch_pbs0:
    s_sub_u32 s65, s65, 1
    s_cbranch_scc1 L_ch_abort
    buffer_load_dwordx4 v[36:39], v8, s[32:35], s66 offen offset:0 sc1
    buffer_load_dwordx4 v[40:43], v8, s[32:35], s66 offen offset:1024 sc1
    buffer_load_dwordx4 v[44:47], v8, s[32:35], s66 offen offset:2048 sc1
    buffer_load_dwordx4 v[48:51], v8, s[32:35], s66 offen offset:3072 sc1
    s_waitcnt vmcnt(7)
    v_mfma_f32_16x16x32_bf16 v[84:87], v[28:31], v[80:83], 0
    v_xor_b32 v60, s51, v28
    s_waitcnt vmcnt(6)
    v_mfma_f32_16x16x32_bf16 v[84:87], v[32:35], v[80:83], v[84:87]
    v_xor_b32 v61, s51, v32
    s_waitcnt vmcnt(5)
    v_mfma_f32_16x16x32_bf16 v[84:87], v[20:23], v[80:83], v[84:87]
    v_xor_b32 v62, s51, v20
    v_or3_b32 v60, v60, v61, v62
    s_waitcnt vmcnt(4)
    v_mfma_f32_16x16x32_bf16 v[84:87], v[24:27], v[80:83], v[84:87]
    v_xor_b32 v61, s51, v24
    v_or_b32 v60, v60, v61
    v_and_b32 v60, 1, v60
    v_cmp_ne_u32 vcc, 0, v60
    s_nop 3
    v_permlane32_swap_b32 v84, v86
    v_permlane32_swap_b32 v85, v87
    v_pk_add_f32 v[84:85], v[84:85], v[86:87]
    v_cvt_pk_bf16_f32 v84, v84, v85
    v_min_u32 v60, -2, v84
    v_min_u32 v62, -2, v84
    s_nop 1
    v_permlane16_swap_b32 v60, v62
    v_mov_b32 v61, v60
    v_mov_b32 v63, v62
    s_nop 0
    v_permlane32_swap_b32 v60, v61
    v_permlane32_swap_b32 v62, v63
    s_cbranch_vccnz L_ch_pas0
    s_mov_b64 exec, s[58:59]
    buffer_store_dwordx4 v[60:63], v2, s[32:35], s46 offen sc1
    buffer_store_dwordx4 v[60:63], v2, s[32:35], s47 offen sc1
    buffer_store_dwordx4 v[52:55], v2, s[32:35], s49 offen sc1
    s_mov_b64 exec, -1
    s_waitcnt vmcnt(3)
    s_branch L_ch_joins0
L_ch_pas0:
    buffer_load_dwordx4 v[28:31], v8, s[32:35], s66 offen offset:0 sc1
    buffer_load_dwordx4 v[32:35], v8, s[32:35], s66 offen offset:1024 sc1
    buffer_load_dwordx4 v[20:23], v8, s[32:35], s66 offen offset:2048 sc1
    buffer_load_dwordx4 v[24:27], v8, s[32:35], s66 offen offset:3072 sc1
    s_waitcnt vmcnt(7)
    v_mfma_f32_16x16x32_bf16 v[84:87], v[36:39], v[80:83], 0
    v_xor_b32 v60, s51, v36
    s_waitcnt vmcnt(6)
    v_mfma_f32_16x16x32_bf16 v[84:87], v[40:43], v[80:83], v[84:87]
    v_xor_b32 v61, s51, v40
    s_waitcnt vmcnt(5)
    v_mfma_f32_16x16x32_bf16 v[84:87], v[44:47], v[80:83], v[84:87]
    v_xor_b32 v62, s51, v44
    v_or3_b32 v60, v60, v61, v62
    s_waitcnt vmcnt(4)
    v_mfma_f32_16x16x32_bf16 v[84:87], v[48:51], v[80:83], v[84:87]
    v_xor_b32 v61, s51, v48
    v_or_b32 v60, v60, v61
    v_and_b32 v60, 1, v60
    v_cmp_ne_u32 vcc, 0, v60
    s_nop 3
    v_permlane32_swap_b32 v84, v86
    v_permlane32_swap_b32 v85, v87
    v_pk_add_f32 v[84:85], v[84:85], v[86:87]
    v_cvt_pk_bf16_f32 v84, v84, v85
    v_min_u32 v60, -2, v84
    v_min_u32 v62, -2, v84
    s_nop 1
    v_permlane16_swap_b32 v60, v62
    v_mov_b32 v61, v60
    v_mov_b32 v63, v62
    s_nop 0
    v_permlane32_swap_b32 v60, v61
    v_permlane32_swap_b32 v62, v63
    s_cbranch_vccnz L_ch_pbs0
    s_branch L_ch_poks0
L_ch_kvws0:
    s_sub_u32 s65, s65, 1
    s_cbranch_scc1 L_ch_abort
    s_sleep 2
    v_bfe_u32 v14, v8, 4, 3
    v_lshlrev_b32 v14, 7, v14
    buffer_load_dword v15, v14, s[32:35], s69 offen sc1
    s_waitcnt vmcnt(0)
    v_add_u32_dpp v15, v15, v15 row_shr:1 row_mask:0xf bank_mask:0xf bound_ctrl:0
    s_nop 1
    v_add_u32_dpp v15, v15, v15 row_shr:2 row_mask:0xf bank_mask:0xf bound_ctrl:0
    s_nop 1
    v_add_u32_dpp v15, v15, v15 row_shr:4 row_mask:0xf bank_mask:0xf bound_ctrl:0
    s_nop 0
    v_readlane_b32 s70, v15, 7
    s_nop 0
    s_cmp_lt_u32 s70, 128
    s_cbranch_scc1 L_ch_kvws0
    s_branch L_ch_kvbs0
L_ch_step_s1:
    s_sleep 1
    buffer_load_dwordx4 v[80:83], v3, s[32:35], s44 offen sc1
    buffer_load_dword v84, v4, s[32:35], s44 offen sc1
    s_add_u32 m0, s50, 0
    s_sub_u32 s70, s63, 794624
    buffer_load_dwordx4 v8, s[32:35], s70 offen sc1 lds
    buffer_load_dwordx4 v8, s[32:35], s70 offen offset:1024 sc1 lds
    ds_read_b128 v[64:67], v9 offset:12288
    ds_read_b128 v[68:71], v9 offset:13312
    buffer_load_dwordx4 v[60:63], v3, s[32:35], s44 offen sc1
    buffer_load_dword v85, v4, s[32:35], s44 offen sc1
    ds_read_b128 v[72:75], v9 offset:14336
    ds_read_b128 v[76:79], v9 offset:15360
    v_lshlrev_b32 v11, 2, v8
    s_sub_u32 s72, s63, 786432
    s_waitcnt vmcnt(4)
    ds_write_b128 v3, v[80:83] offset:0
    ds_write_b32 v4, v84 offset:0
    v_max3_u32 v16, v80, v82, v84
    v_cmp_eq_u32 vcc, s74, v16
    v_mov_b64 v[28:29], 0
    v_mov_b64 v[30:31], 0
    v_mov_b64 v[32:33], 0
    v_mov_b64 v[34:35], 0
    s_cbranch_vccnz L_ch_lbs1
L_ch_lcs1:
    buffer_load_dwordx4 v[12:15], v3, s[32:35], s45 offen sc1
    buffer_load_dword v19, v4, s[32:35], s45 offen sc1
    buffer_load_dwordx4 v[20:23], v8, s[32:35], s72 offen sc1
    s_waitcnt lgkmcnt(0)
    s_barrier
    ds_read_b128 v[52:55], v8 offset:0
    buffer_load_dwordx4 v[24:27], v8, s[32:35], s72 offen offset:1024 sc1
    s_waitcnt lgkmcnt(0)
    v_smfmac_f32_16x16x64_bf16 v[28:31], v[52:55], v[64:71], v10
    s_waitcnt vmcnt(4)
    ds_read_b128 v[80:83], v9 offset:16384
    v_smfmac_f32_16x16x64_bf16 v[36:39], v[52:55], a[0:7], v10
    ds_read_b128 v[60:63], v8 offset:1024
    ds_read_b128 v[84:87], v9 offset:17408
    v_smfmac_f32_16x16x64_bf16 v[40:43], v[52:55], a[160:167], v10
    ds_read_b128 v[64:67], v9 offset:18432
    v_smfmac_f32_16x16x64_bf16 v[32:35], v[52:55], v[72:79], v10
    ds_read_b128 v[68:71], v9 offset:19456
    v_smfmac_f32_16x16x64_bf16 v[44:47], v[52:55], a[8:15], v10
    ds_read_b128 v[72:75], v9 offset:20480
    v_smfmac_f32_16x16x64_bf16 v[48:51], v[52:55], a[168:175], v10
    ds_read_b128 v[76:79], v9 offset:21504
    s_waitcnt lgkmcnt(4)
    v_smfmac_f32_16x16x64_bf16 v[28:31], v[60:63], v[80:87], v10
    ds_read_b128 v[52:55], v8 offset:2048
    v_smfmac_f32_16x16x64_bf16 v[36:39], v[60:63], a[16:23], v10
    ds_read_b128 v[80:83], v9 offset:22528
    v_smfmac_f32_16x16x64_bf16 v[40:43], v[60:63], a[176:183], v10
    ds_read_b128 v[84:87], v9 offset:23552
    s_waitcnt lgkmcnt(5)
    v_smfmac_f32_16x16x64_bf16 v[32:35], v[60:63], v[64:71], v10
    ds_read_b128 v[64:67], v9 offset:24576
    v_smfmac_f32_16x16x64_bf16 v[44:47], v[60:63], a[24:31], v10
    ds_read_b128 v[68:71], v9 offset:25600
    v_smfmac_f32_16x16x64_bf16 v[48:51], v[60:63], a[184:191], v10
    s_waitcnt lgkmcnt(4)
    v_smfmac_f32_16x16x64_bf16 v[28:31], v[52:55], v[72:79], v10
    ds_read_b128 v[60:63], v8 offset:3072
    v_smfmac_f32_16x16x64_bf16 v[36:39], v[52:55], a[32:39], v10
    ds_read_b128 v[72:75], v9 offset:26624
    v_smfmac_f32_16x16x64_bf16 v[40:43], v[52:55], a[192:199], v10
    ds_read_b128 v[76:79], v9 offset:27648
    s_waitcnt lgkmcnt(5)
    v_smfmac_f32_16x16x64_bf16 v[32:35], v[52:55], v[80:87], v10
    ds_read_b128 v[80:83], v9 offset:28672
    v_smfmac_f32_16x16x64_bf16 v[44:47], v[52:55], a[40:47], v10
    ds_read_b128 v[84:87], v9 offset:29696
    v_smfmac_f32_16x16x64_bf16 v[48:51], v[52:55], a[200:207], v10
    s_waitcnt vmcnt(2)
    ds_write_b128 v3, v[12:15] offset:5120
    s_waitcnt lgkmcnt(5)
    v_smfmac_f32_16x16x64_bf16 v[28:31], v[60:63], v[64:71], v10
    ds_write_b32 v4, v19 offset:5120
    v_smfmac_f32_16x16x64_bf16 v[36:39], v[60:63], a[48:55], v10
    v_max3_u32 v16, v12, v14, v19
    ds_read_b128 v[52:55], v8 offset:4096
    v_smfmac_f32_16x16x64_bf16 v[40:43], v[60:63], a[208:215], v10
    v_cmp_eq_u32 vcc, s74, v16
    s_waitcnt lgkmcnt(5)
    v_smfmac_f32_16x16x64_bf16 v[32:35], v[60:63], v[72:79], v10
    ds_read_b128 v[64:67], v9 offset:30720
    v_smfmac_f32_16x16x64_bf16 v[44:47], v[60:63], a[56:63], v10
    s_cbranch_vccnz L_ch_rrs1
L_ch_roks1:
    s_waitcnt lgkmcnt(2)
    s_barrier
    ds_read_b128 v[68:71], v9 offset:31744
    v_smfmac_f32_16x16x64_bf16 v[48:51], v[60:63], a[216:223], v10
    ds_read_b128 v[72:75], v9 offset:0
    s_waitcnt lgkmcnt(3)
    v_smfmac_f32_16x16x64_bf16 v[28:31], v[52:55], v[80:87], v10
    ds_read_b128 v[60:63], v8 offset:5120
    v_smfmac_f32_16x16x64_bf16 v[36:39], v[52:55], a[64:71], v10
    s_waitcnt vmcnt(0)
    buffer_load_dword v11, v11, s[80:83], s87 offen sc1
    ds_read_b128 v[76:79], v9 offset:1024
    v_smfmac_f32_16x16x64_bf16 v[40:43], v[52:55], a[224:231], v10
    ds_read_b128 v[80:83], v9 offset:2048
    s_waitcnt lgkmcnt(4)
    v_smfmac_f32_16x16x64_bf16 v[32:35], v[52:55], v[64:71], v10
    ds_read_b128 v[84:87], v9 offset:3072
    v_smfmac_f32_16x16x64_bf16 v[44:47], v[52:55], a[72:79], v10
    ds_read_b128 v[64:67], v9 offset:4096
    v_smfmac_f32_16x16x64_bf16 v[48:51], v[52:55], a[232:239], v10
    ds_read_b128 v[68:71], v9 offset:5120
    s_waitcnt lgkmcnt(4)
    v_smfmac_f32_16x16x64_bf16 v[28:31], v[60:63], v[72:79], v10
    ds_read_b128 v[52:55], v8 offset:6144
    v_smfmac_f32_16x16x64_bf16 v[36:39], v[60:63], a[80:87], v10
    ds_read_b128 v[72:75], v9 offset:6144
    v_smfmac_f32_16x16x64_bf16 v[40:43], v[60:63], a[240:247], v10
    ds_read_b128 v[76:79], v9 offset:7168
    s_waitcnt lgkmcnt(5)
    v_smfmac_f32_16x16x64_bf16 v[32:35], v[60:63], v[80:87], v10
    ds_read_b128 v[80:83], v9 offset:8192
    v_smfmac_f32_16x16x64_bf16 v[44:47], v[60:63], a[88:95], v10
    ds_read_b128 v[84:87], v9 offset:9216
    v_smfmac_f32_16x16x64_bf16 v[48:51], v[60:63], a[248:255], v10
    s_waitcnt lgkmcnt(4)
    v_smfmac_f32_16x16x64_bf16 v[28:31], v[52:55], v[64:71], v10
    ds_read_b128 v[60:63], v8 offset:7168
    v_smfmac_f32_16x16x64_bf16 v[36:39], v[52:55], a[96:103], v10
    ds_read_b128 v[64:67], v9 offset:10240
    v_smfmac_f32_16x16x64_bf16 v[40:43], v[52:55], v[88:95], v10
    ds_read_b128 v[68:71], v9 offset:11264
    s_waitcnt lgkmcnt(5)
    v_smfmac_f32_16x16x64_bf16 v[32:35], v[52:55], v[72:79], v10
    ds_read_b128 v[72:75], v9 offset:32768
    v_smfmac_f32_16x16x64_bf16 v[44:47], v[52:55], a[104:111], v10
    ds_read_b128 v[76:79], v9 offset:33792
    v_smfmac_f32_16x16x64_bf16 v[48:51], v[52:55], v[96:103], v10
    s_waitcnt lgkmcnt(4)
    v_smfmac_f32_16x16x64_bf16 v[28:31], v[60:63], v[80:87], v10
    ds_read_b128 v[52:55], v8 offset:8192
    v_smfmac_f32_16x16x64_bf16 v[36:39], v[60:63], a[112:119], v10
    ds_read_b128 v[80:83], v8 offset:9216
    v_smfmac_f32_16x16x64_bf16 v[40:43], v[60:63], v[104:111], v10
    s_waitcnt lgkmcnt(4)
    v_smfmac_f32_16x16x64_bf16 v[32:35], v[60:63], v[64:71], v10
    ds_read_b128 v[64:67], v8 offset:18432
    v_smfmac_f32_16x16x64_bf16 v[44:47], v[60:63], a[120:127], v10
    v_smfmac_f32_16x16x64_bf16 v[48:51], v[60:63], v[112:119], v10
    s_waitcnt lgkmcnt(2)
    v_smfmac_f32_16x16x64_bf16 v[36:39], v[52:55], a[128:135], v10
    v_smfmac_f32_16x16x64_bf16 v[40:43], v[52:55], v[120:127], v10
    ds_read_b128 v[60:63], v8 offset:16384
    v_smfmac_f32_16x16x64_bf16 v[44:47], v[52:55], a[136:143], v10
    ds_read_b128 v[84:87], v8 offset:17408
    v_smfmac_f32_16x16x64_bf16 v[48:51], v[52:55], v[128:135], v10
    ds_read_b128 v[68:71], v8 offset:19456
    s_waitcnt lgkmcnt(4)
    v_smfmac_f32_16x16x64_bf16 v[36:39], v[80:83], a[144:151], v10
    v_smfmac_f32_16x16x64_bf16 v[40:43], v[80:83], v[136:143], v10
    v_xor_b32 v12, 128, v6
    v_smfmac_f32_16x16x64_bf16 v[44:47], v[80:83], a[152:159], v10
    v_xor_b32 v13, 128, v7
    v_smfmac_f32_16x16x64_bf16 v[48:51], v[80:83], v[144:151], v10
    v_pk_add_f32 v[36:37], v[36:37], v[38:39]
    v_smfmac_f32_16x16x64_bf16 v[32:35], v[52:55], v[232:239], v10
    v_pk_add_f32 v[40:41], v[40:41], v[42:43]
    v_cvt_pk_bf16_f32 v38, v36, v37
    v_cvt_pk_bf16_f32 v39, v40, v41
    ds_write_b64 v6, v[38:39]
    v_pk_add_f32 v[44:45], v[44:45], v[46:47]
    v_pk_add_f32 v[48:49], v[48:49], v[50:51]
    v_cvt_pk_bf16_f32 v46, v44, v45
    v_cvt_pk_bf16_f32 v47, v48, v49
    ds_write_b64 v12, v[46:47]
    v_smfmac_f32_16x16x64_bf16 v[28:31], v[52:55], v[72:79], v10
    v_smfmac_f32_16x16x64_bf16 v[32:35], v[80:83], v[248:255], v10
    s_cmp_eq_u32 s43, 63
    s_cbranch_scc1 L_ch_lasts1
    s_waitcnt lgkmcnt(0)
    s_barrier
    ds_read_b64_tr_b16 v[48:49], v7 offset:0
    ds_read_b64_tr_b16 v[50:51], v13 offset:0
    ds_read_b64_tr_b16 v[72:73], v7 offset:256
    ds_read_b64_tr_b16 v[74:75], v13 offset:256
    v_smfmac_f32_16x16x64_bf16 v[28:31], v[80:83], v[240:247], v10
    s_waitcnt lgkmcnt(2)
    v_mfma_f32_16x16x32_bf16 v[36:39], v[60:63], v[48:51], 0
    ds_read_b128 v[60:63], v8 offset:20480
    v_mfma_f32_16x16x32_bf16 v[40:43], v[84:87], v[48:51], 0
    ds_read_b128 v[84:87], v8 offset:21504
    v_mfma_f32_16x16x32_bf16 v[44:47], v[48:51], v[48:51], 0
    ds_read_b64_tr_b16 v[48:49], v7 offset:512
    ds_read_b64_tr_b16 v[50:51], v13 offset:512
    s_waitcnt lgkmcnt(4)
    v_mfma_f32_16x16x32_bf16 v[36:39], v[64:67], v[72:75], v[36:39]
    ds_read_b128 v[64:67], v8 offset:22528
    v_mfma_f32_16x16x32_bf16 v[40:43], v[68:71], v[72:75], v[40:43]
    ds_read_b128 v[68:71], v8 offset:23552
    v_mfma_f32_16x16x32_bf16 v[44:47], v[72:75], v[72:75], v[44:47]
    ds_read_b64_tr_b16 v[72:73], v7 offset:768
    ds_read_b64_tr_b16 v[74:75], v13 offset:768
    s_waitcnt lgkmcnt(4)
    v_mfma_f32_16x16x32_bf16 v[36:39], v[60:63], v[48:51], v[36:39]
    v_mfma_f32_16x16x32_bf16 v[40:43], v[84:87], v[48:51], v[40:43]
    v_mfma_f32_16x16x32_bf16 v[44:47], v[48:51], v[48:51], v[44:47]
    s_waitcnt lgkmcnt(0)
    v_mfma_f32_16x16x32_bf16 v[36:39], v[64:67], v[72:75], v[36:39]
    v_mfma_f32_16x16x32_bf16 v[40:43], v[68:71], v[72:75], v[40:43]
    v_mfma_f32_16x16x32_bf16 v[44:47], v[72:75], v[72:75], v[44:47]
    v_pk_add_f32 v[28:29], v[28:29], v[30:31]
    v_pk_add_f32 v[32:33], v[32:33], v[34:35]
    v_cvt_pk_bf16_f32 v56, v28, v29
    v_cvt_pk_bf16_f32 v57, v32, v33
    v_cvt_pk_bf16_f32 v18, v32, v33
    v_max3_f32 v52, v36, v37, v38
    v_max3_f32 v53, v40, v41, v42
    v_max3_f32 v52, v52, v39, v43
    v_max3_f32 v53, v53, v46, v47
    v_max_f32 v54, v52, v53
    v_max_f32 v55, v52, v53
    v_mov_b64 v[76:77], s[36:37]
    v_mov_b64 v[78:79], s[36:37]
    v_permlane16_swap_b32 v54, v55
    v_max_f32 v52, v54, v55
    v_max_f32 v53, v54, v55
    v_add_u32 v14, s48, v8
    v_mov_b64 v[60:61], 0
    v_permlane32_swap_b32 v52, v53
    v_max_f32 v52, v52, v53
    v_mul_f32 v52, s54, v52
    v_pk_fma_f32 v[46:47], v[46:47], s[54:55], v[52:53] op_sel_hi:[1,0,0] neg_lo:[0,0,1] neg_hi:[0,0,1]
    v_pk_fma_f32 v[36:37], v[36:37], s[54:55], v[52:53] op_sel_hi:[1,0,0] neg_lo:[0,0,1] neg_hi:[0,0,1]
    v_pk_fma_f32 v[38:39], v[38:39], s[54:55], v[52:53] op_sel_hi:[1,0,0] neg_lo:[0,0,1] neg_hi:[0,0,1]
    v_pk_fma_f32 v[40:41], v[40:41], s[54:55], v[52:53] op_sel_hi:[1,0,0] neg_lo:[0,0,1] neg_hi:[0,0,1]
    v_pk_fma_f32 v[42:43], v[42:43], s[54:55], v[52:53] op_sel_hi:[1,0,0] neg_lo:[0,0,1] neg_hi:[0,0,1]
    v_exp_f32 v46, v46
    v_exp_f32 v47, v47
    v_exp_f32 v36, v36
    v_cvt_pk_bf16_f32 v16, v46, v47
    v_exp_f32 v37, v37
    v_exp_f32 v38, v38
    v_mfma_f32_16x16x16_bf16 v[72:75], v[76:77], v[16:17], 0
    v_exp_f32 v39, v39
    v_mfma_f32_16x16x16_bf16 v[64:67], v[56:57], v[16:17], 0
    v_exp_f32 v40, v40
    v_mfma_f32_16x16x16_bf16 v[68:71], v[18:19], v[16:17], 0
    v_exp_f32 v41, v41
    v_exp_f32 v42, v42
    v_exp_f32 v43, v43
    v_cvt_pk_bf16_f32 v48, v36, v37
    v_cvt_pk_bf16_f32 v49, v38, v39
    v_cvt_pk_bf16_f32 v50, v40, v41
    v_cvt_pk_bf16_f32 v51, v42, v43
    v_mov_b64 v[62:63], 0
    v_mov_b64 v[36:37], 0
    v_mfma_f32_16x16x32_bf16 v[72:75], v[76:79], v[48:51], v[72:75]
    v_mov_b64 v[38:39], 0
    v_mfma_f32_16x16x32_bf16 v[64:67], v[20:23], v[48:51], v[64:67]
    v_mov_b64 v[40:41], 0
    v_mfma_f32_16x16x32_bf16 v[68:71], v[24:27], v[48:51], v[68:71]
    v_mov_b64 v[42:43], 0
    v_rcp_f32 v52, v72
    v_mov_b64 v[44:45], 0
    s_nop 1
    v_pk_mul_f32 v[64:65], v[64:65], v[52:53] op_sel_hi:[1,0]
    v_pk_mul_f32 v[66:67], v[66:67], v[52:53] op_sel_hi:[1,0]
    v_cvt_pk_bf16_f32 v72, v64, v65
    v_cvt_pk_bf16_f32 v73, v66, v67
    v_pk_mul_f32 v[68:69], v[68:69], v[52:53] op_sel_hi:[1,0]
    v_pk_mul_f32 v[70:71], v[70:71], v[52:53] op_sel_hi:[1,0]
    v_cvt_pk_bf16_f32 v74, v68, v69
    v_cvt_pk_bf16_f32 v75, v70, v71
    s_mov_b64 exec, s[60:61]
    ds_write_b128 v14, v[72:75]
    s_mov_b64 exec, -1
    v_mov_b64 v[46:47], 0
    v_mov_b64 v[48:49], 0
    v_mov_b64 v[50:51], 0
    s_waitcnt lgkmcnt(0)
    s_barrier
    ds_read_b128 v[64:67], v8 offset:10240
    ds_read_b128 v[68:71], v8 offset:11264
    s_waitcnt lgkmcnt(1)
    v_smfmac_f32_16x16x64_bf16 v[60:63], v[64:67], v[216:223], v10
    s_waitcnt lgkmcnt(0)
    v_smfmac_f32_16x16x64_bf16 v[60:63], v[68:71], v[224:231], v10
    v_smfmac_f32_16x16x64_bf16 v[36:39], v[64:67], v[152:159], v10
    v_smfmac_f32_16x16x64_bf16 v[36:39], v[68:71], v[160:167], v10
    v_smfmac_f32_16x16x64_bf16 v[40:43], v[64:67], v[168:175], v10
    v_pk_add_f32 v[60:61], v[60:61], v[62:63]
    v_smfmac_f32_16x16x64_bf16 v[40:43], v[68:71], v[176:183], v10
    v_cvt_pk_bf16_f32 v76, v60, v61
    v_smfmac_f32_16x16x64_bf16 v[44:47], v[64:67], v[184:191], v10
    v_pk_add_f32 v[36:37], v[36:37], v[38:39]
    v_smfmac_f32_16x16x64_bf16 v[44:47], v[68:71], v[192:199], v10
    v_mov_b32_dpp v77, v76 row_shl:8 row_mask:0xf bank_mask:0xf
    v_smfmac_f32_16x16x64_bf16 v[48:51], v[64:67], v[200:207], v10
    v_mov_b32_dpp v78, v76 row_shl:4 row_mask:0xf bank_mask:0xf
    v_smfmac_f32_16x16x64_bf16 v[48:51], v[68:71], v[208:215], v10
    v_mov_b32_dpp v79, v76 row_shl:12 row_mask:0xf bank_mask:0xf
    v_bfi_b32 v76, 1, s51, v76
    s_mov_b64 exec, s[56:57]
    buffer_store_dwordx4 v[76:79], v1, s[32:35], 0 offen sc1
    s_mov_b64 exec, -1
    v_cvt_pk_bf16_f32 v72, v36, v37
    v_pk_add_f32 v[40:41], v[40:41], v[42:43]
    v_pk_add_f32 v[44:45], v[44:45], v[46:47]
    v_bfi_b32 v72, 1, s51, v72
    v_cvt_pk_bf16_f32 v73, v40, v41
    v_pk_add_f32 v[48:49], v[48:49], v[50:51]
    v_cvt_pk_bf16_f32 v74, v44, v45
    v_cvt_pk_bf16_f32 v75, v48, v49
    buffer_store_dwordx4 v[72:75], v0, s[32:35], 0 offen sc1
    s_cmp_ge_u32 s53, 40
    s_cbranch_scc1 L_ch_noreds1
    v_bfe_u32 v60, v8, 4, 1
    v_lshlrev_b32 v60, 4, v60
    v_mov_b32 v61, 0x3f80
    v_lshlrev_b32 v61, v60, v61
    v_bfe_u32 v60, v8, 5, 2
    v_cmp_eq_u32 vcc, 0, v60
    s_nop 1
    v_cndmask_b32 v80, 0, v61, vcc
    v_cmp_eq_u32 vcc, 1, v60
    s_nop 1
    v_cndmask_b32 v81, 0, v61, vcc
    v_cmp_eq_u32 vcc, 2, v60
    s_nop 1
    v_cndmask_b32 v82, 0, v61, vcc
    v_cmp_eq_u32 vcc, 3, v60
    s_nop 1
    v_cndmask_b32 v83, 0, v61, vcc
    v_mov_b64 v[52:53], -1
    v_mov_b64 v[54:55], -1
    s_cmp_ge_u32 s53, 32
    s_cbranch_scc1 L_ch_odds1
    s_sleep 3
    buffer_load_dwordx4 v[36:39], v8, s[32:35], s66 offen offset:0 sc1
    buffer_load_dwordx4 v[40:43], v8, s[32:35], s66 offen offset:1024 sc1
    buffer_load_dwordx4 v[44:47], v8, s[32:35], s66 offen offset:2048 sc1
    buffer_load_dwordx4 v[48:51], v8, s[32:35], s66 offen offset:3072 sc1
    s_sleep 3
    buffer_load_dwordx4 v[28:31], v8, s[32:35], s66 offen offset:0 sc1
    buffer_load_dwordx4 v[32:35], v8, s[32:35], s66 offen offset:1024 sc1
    buffer_load_dwordx4 v[20:23], v8, s[32:35], s66 offen offset:2048 sc1
    buffer_load_dwordx4 v[24:27], v8, s[32:35], s66 offen offset:3072 sc1
    s_waitcnt vmcnt(7)
    v_mfma_f32_16x16x32_bf16 v[84:87], v[36:39], v[80:83], 0
    v_xor_b32 v60, s51, v36
    s_waitcnt vmcnt(6)
    v_mfma_f32_16x16x32_bf16 v[84:87], v[40:43], v[80:83], v[84:87]
    v_xor_b32 v61, s51, v40
    s_waitcnt vmcnt(5)
    v_mfma_f32_16x16x32_bf16 v[84:87], v[44:47], v[80:83], v[84:87]
    v_xor_b32 v62, s51, v44
    v_or3_b32 v60, v60, v61, v62
    s_waitcnt vmcnt(4)
    v_mfma_f32_16x16x32_bf16 v[84:87], v[48:51], v[80:83], v[84:87]
    v_xor_b32 v61, s51, v48
    v_or_b32 v60, v60, v61
    v_and_b32 v60, 1, v60
    v_cmp_ne_u32 vcc, 0, v60
    s_nop 3
    v_permlane32_swap_b32 v84, v86
    v_permlane32_swap_b32 v85, v87
    v_pk_add_f32 v[84:85], v[84:85], v[86:87]
    v_cvt_pk_bf16_f32 v84, v84, v85
    v_min_u32 v60, -2, v84
    v_min_u32 v62, -2, v84
    s_nop 1
    v_permlane16_swap_b32 v60, v62
    v_mov_b32 v61, v60
    v_mov_b32 v63, v62
    s_nop 0
    v_permlane32_swap_b32 v60, v61
    v_permlane32_swap_b32 v62, v63
    s_cbranch_vccnz L_ch_pbs1
L_ch_poks1:
    s_mov_b64 exec, s[58:59]
    buffer_store_dwordx4 v[60:63], v2, s[32:35], s46 offen sc1
    buffer_store_dwordx4 v[60:63], v2, s[32:35], s47 offen sc1
    buffer_store_dwordx4 v[52:55], v2, s[32:35], s49 offen sc1
    s_mov_b64 exec, -1
L_ch_joins1:
    v_mov_b64 v[36:37], 0
    v_mov_b64 v[38:39], 0
    v_mov_b64 v[40:41], 0
    v_mov_b64 v[42:43], 0
    v_mov_b64 v[44:45], 0
    v_mov_b64 v[46:47], 0
    v_mov_b64 v[48:49], 0
    v_mov_b64 v[50:51], 0
    s_barrier
    s_not_b64 s[88:89], s[88:89]
    s_add_u32 s45, s45, 32768
    s_add_u32 s62, s62, 786432
    s_add_u32 s87, s87, 786432
    s_add_u32 s63, s63, 786432
    s_add_u32 s64, s64, 131072
    s_add_u32 s43, s43, 1
    s_xor_b32 s51, s51, 1
    s_mov_b32 s70, s44
    s_mov_b32 s44, s46
    s_mov_b32 s46, s49
    s_mov_b32 s49, s70
    s_add_u32 s47, s47, 32768
    s_cmp_eq_u32 s43, 63
    s_cselect_b32 s82, 0, s82
    s_branch L_ch_step_s1
L_ch_noreds1:
    s_waitcnt vmcnt(0)
    s_branch L_ch_joins1
L_ch_lasts1:
    v_smfmac_f32_16x16x64_bf16 v[28:31], v[80:83], v[240:247], v10
    s_nop 7
    v_pk_add_f32 v[28:29], v[28:29], v[30:31]
    v_pk_add_f32 v[32:33], v[32:33], v[34:35]
    v_cvt_pk_bf16_f32 v56, v28, v29
    v_cvt_pk_bf16_f32 v57, v32, v33
    s_add_u32 s64, s64, 131072
    s_waitcnt vmcnt(0) lgkmcnt(0)
    s_barrier
    s_cmp_lg_u32 s42, 3
    s_cbranch_scc1 L_ch_fins1
    s_mov_b32 s71, 65
    v_mov_b32 v16, s71
    s_mov_b64 exec, 1
    buffer_store_dword v16, v17, s[32:35], s68 offen sc1
    s_mov_b64 exec, -1
L_ch_fins1:
    s_waitcnt vmcnt(0)
    s_endpgm
L_ch_lbs1:
    s_waitcnt vmcnt(0)
    ds_write_b128 v3, v[60:63] offset:0
    ds_write_b32 v4, v85 offset:0
    v_max3_u32 v16, v60, v62, v85
    v_cmp_eq_u32 vcc, s74, v16
    s_nop 0
    s_cbranch_vccz L_ch_lcs1
L_ch_lrs1:
    s_sub_u32 s65, s65, 1
    s_cbranch_scc1 L_ch_abort
    s_waitcnt lgkmcnt(0)
    buffer_load_dwordx4 v[80:83], v3, s[32:35], s44 offen sc1
    buffer_load_dword v84, v4, s[32:35], s44 offen sc1
    s_waitcnt vmcnt(0)
    ds_write_b128 v3, v[80:83] offset:0
    ds_write_b32 v4, v84 offset:0
    v_max3_u32 v16, v80, v82, v84
    v_cmp_eq_u32 vcc, s74, v16
    s_nop 0
    s_cbranch_vccnz L_ch_lrs1
    s_branch L_ch_lcs1
L_ch_rrs1:
    s_sub_u32 s65, s65, 1
    s_cbranch_scc1 L_ch_abort
    s_waitcnt lgkmcnt(0)
    buffer_load_dwordx4 v[12:15], v3, s[32:35], s45 offen sc1
    buffer_load_dword v19, v4, s[32:35], s45 offen sc1
    s_waitcnt vmcnt(0)
    ds_write_b128 v3, v[12:15] offset:5120
    ds_write_b32 v4, v19 offset:5120
    v_max3_u32 v16, v12, v14, v19
    v_cmp_eq_u32 vcc, s74, v16
    s_nop 0
    s_cbranch_vccnz L_ch_rrs1
    s_waitcnt lgkmcnt(0)
    s_branch L_ch_roks1
L_ch_pbos1:
    s_sub_u32 s65, s65, 1
    s_cbranch_scc1 L_ch_abort
    buffer_load_dwordx4 v[36:39], v8, s[32:35], s66 offen offset:0 sc1
    buffer_load_dwordx4 v[40:43], v8, s[32:35], s66 offen offset:1024 sc1
    buffer_load_dwordx4 v[44:47], v8, s[32:35], s66 offen offset:2048 sc1
    buffer_load_dwordx4 v[48:51], v8, s[32:35], s66 offen offset:3072 sc1
    s_waitcnt vmcnt(7)
    v_mfma_f32_16x16x32_bf16 v[84:87], v[28:31], v[80:83], 0
    v_xor_b32 v60, s51, v28
    s_waitcnt vmcnt(6)
    v_mfma_f32_16x16x32_bf16 v[84:87], v[32:35], v[80:83], v[84:87]
    v_xor_b32 v61, s51, v32
    s_waitcnt vmcnt(5)
    v_mfma_f32_16x16x32_bf16 v[84:87], v[20:23], v[80:83], v[84:87]
    v_xor_b32 v62, s51, v20
    v_or3_b32 v60, v60, v61, v62
    s_waitcnt vmcnt(4)
    v_mfma_f32_16x16x32_bf16 v[84:87], v[24:27], v[80:83], v[84:87]
    v_xor_b32 v61, s51, v24
    v_or_b32 v60, v60, v61
    v_and_b32 v60, 1, v60
    v_cmp_ne_u32 vcc, 0, v60
    s_nop 3
    v_permlane32_swap_b32 v84, v86
    v_permlane32_swap_b32 v85, v87
    v_pk_add_f32 v[84:85], v[84:85], v[86:87]
    v_cvt_pk_bf16_f32 v84, v84, v85
    v_min_u32 v60, -2, v84
    v_min_u32 v61, -2, v84
    s_nop 1
    v_permlane32_swap_b32 v60, v61
    s_cbranch_vccnz L_ch_paos1
    s_mov_b64 exec, s[58:59]
    buffer_store_dwordx2 v[60:61], v2, s[32:35], s46 offen sc1
    buffer_store_dwordx2 v[60:61], v2, s[32:35], s47 offen sc1
    buffer_store_dwordx2 v[52:53], v2, s[32:35], s49 offen sc1
    s_mov_b64 exec, -1
    s_waitcnt vmcnt(3)
    s_branch L_ch_joins1
L_ch_paos1:
    buffer_load_dwordx4 v[28:31], v8, s[32:35], s66 offen offset:0 sc1
    buffer_load_dwordx4 v[32:35], v8, s[32:35], s66 offen offset:1024 sc1
    buffer_load_dwordx4 v[20:23], v8, s[32:35], s66 offen offset:2048 sc1
    buffer_load_dwordx4 v[24:27], v8, s[32:35], s66 offen offset:3072 sc1
    s_waitcnt vmcnt(7)
    v_mfma_f32_16x16x32_bf16 v[84:87], v[36:39], v[80:83], 0
    v_xor_b32 v60, s51, v36
    s_waitcnt vmcnt(6)
    v_mfma_f32_16x16x32_bf16 v[84:87], v[40:43], v[80:83], v[84:87]
    v_xor_b32 v61, s51, v40
    s_waitcnt vmcnt(5)
    v_mfma_f32_16x16x32_bf16 v[84:87], v[44:47], v[80:83], v[84:87]
    v_xor_b32 v62, s51, v44
    v_or3_b32 v60, v60, v61, v62
    s_waitcnt vmcnt(4)
    v_mfma_f32_16x16x32_bf16 v[84:87], v[48:51], v[80:83], v[84:87]
    v_xor_b32 v61, s51, v48
    v_or_b32 v60, v60, v61
    v_and_b32 v60, 1, v60
    v_cmp_ne_u32 vcc, 0, v60
    s_nop 3
    v_permlane32_swap_b32 v84, v86
    v_permlane32_swap_b32 v85, v87
    v_pk_add_f32 v[84:85], v[84:85], v[86:87]
    v_cvt_pk_bf16_f32 v84, v84, v85
    v_min_u32 v60, -2, v84
    v_min_u32 v61, -2, v84
    s_nop 1
    v_permlane32_swap_b32 v60, v61
    s_cbranch_vccnz L_ch_pbos1
    s_branch L_ch_pokos1
L_ch_odds1:
    s_sleep 2
    buffer_load_dwordx4 v[36:39], v8, s[32:35], s66 offen offset:0 sc1
    buffer_load_dwordx4 v[40:43], v8, s[32:35], s66 offen offset:1024 sc1
    buffer_load_dwordx4 v[44:47], v8, s[32:35], s66 offen offset:2048 sc1
    buffer_load_dwordx4 v[48:51], v8, s[32:35], s66 offen offset:3072 sc1
    s_sleep 3
    buffer_load_dwordx4 v[28:31], v8, s[32:35], s66 offen offset:0 sc1
    buffer_load_dwordx4 v[32:35], v8, s[32:35], s66 offen offset:1024 sc1
    buffer_load_dwordx4 v[20:23], v8, s[32:35], s66 offen offset:2048 sc1
    buffer_load_dwordx4 v[24:27], v8, s[32:35], s66 offen offset:3072 sc1
    s_waitcnt vmcnt(7)
    v_mfma_f32_16x16x32_bf16 v[84:87], v[36:39], v[80:83], 0
    v_xor_b32 v60, s51, v36
    s_waitcnt vmcnt(6)
    v_mfma_f32_16x16x32_bf16 v[84:87], v[40:43], v[80:83], v[84:87]
    v_xor_b32 v61, s51, v40
    s_waitcnt vmcnt(5)
    v_mfma_f32_16x16x32_bf16 v[84:87], v[44:47], v[80:83], v[84:87]
    v_xor_b32 v62, s51, v44
    v_or3_b32 v60, v60, v61, v62
    s_waitcnt vmcnt(4)
    v_mfma_f32_16x16x32_bf16 v[84:87], v[48:51], v[80:83], v[84:87]
    v_xor_b32 v61, s51, v48
    v_or_b32 v60, v60, v61
    v_and_b32 v60, 1, v60
    v_cmp_ne_u32 vcc, 0, v60
    s_nop 3
    v_permlane32_swap_b32 v84, v86
    v_permlane32_swap_b32 v85, v87
    v_pk_add_f32 v[84:85], v[84:85], v[86:87]
    v_cvt_pk_bf16_f32 v84, v84, v85
    v_min_u32 v60, -2, v84
    v_min_u32 v61, -2, v84
    s_nop 1
    v_permlane32_swap_b32 v60, v61
    s_cbranch_vccnz L_ch_pbos1
L_ch_pokos1:
    s_mov_b64 exec, s[58:59]
    buffer_store_dwordx2 v[60:61], v2, s[32:35], s46 offen sc1
    buffer_store_dwordx2 v[60:61], v2, s[32:35], s47 offen sc1
    buffer_store_dwordx2 v[52:53], v2, s[32:35], s49 offen sc1
    s_mov_b64 exec, -1
    s_branch L_ch_joins1
L_ch_pbs1:
    s_sub_u32 s65, s65, 1
    s_cbranch_scc1 L_ch_abort
    buffer_load_dwordx4 v[36:39], v8, s[32:35], s66 offen offset:0 sc1
    buffer_load_dwordx4 v[40:43], v8, s[32:35], s66 offen offset:1024 sc1
    buffer_load_dwordx4 v[44:47], v8, s[32:35], s66 offen offset:2048 sc1
    buffer_load_dwordx4 v[48:51], v8, s[32:35], s66 offen offset:3072 sc1
    s_waitcnt vmcnt(7)
    v_mfma_f32_16x16x32_bf16 v[84:87], v[28:31], v[80:83], 0
    v_xor_b32 v60, s51, v28
    s_waitcnt vmcnt(6)
    v_mfma_f32_16x16x32_bf16 v[84:87], v[32:35], v[80:83], v[84:87]
    v_xor_b32 v61, s51, v32
    s_waitcnt vmcnt(5)
    v_mfma_f32_16x16x32_bf16 v[84:87], v[20:23], v[80:83], v[84:87]
    v_xor_b32 v62, s51, v20
    v_or3_b32 v60, v60, v61, v62
    s_waitcnt vmcnt(4)
    v_mfma_f32_16x16x32_bf16 v[84:87], v[24:27], v[80:83], v[84:87]
    v_xor_b32 v61, s51, v24
    v_or_b32 v60, v60, v61
    v_and_b32 v60, 1, v60
    v_cmp_ne_u32 vcc, 0, v60
    s_nop 3
    v_permlane32_swap_b32 v84, v86
    v_permlane32_swap_b32 v85, v87
    v_pk_add_f32 v[84:85], v[84:85], v[86:87]
    v_cvt_pk_bf16_f32 v84, v84, v85
    v_min_u32 v60, -2, v84
    v_min_u32 v62, -2, v84
    s_nop 1
    v_permlane16_swap_b32 v60, v62
    v_mov_b32 v61, v60
    v_mov_b32 v63, v62
    s_nop 0
    v_permlane32_swap_b32 v60, v61
    v_permlane32_swap_b32 v62, v63
    s_cbranch_vccnz L_ch_pas1
    s_mov_b64 exec, s[58:59]
    buffer_store_dwordx4 v[60:63], v2, s[32:35], s46 offen sc1
    buffer_store_dwordx4 v[60:63], v2, s[32:35], s47 offen sc1
    buffer_store_dwordx4 v[52:55], v2, s[32:35], s49 offen sc1
    s_mov_b64 exec, -1
    s_waitcnt vmcnt(3)
    s_branch L_ch_joins1
L_ch_pas1:
    buffer_load_dwordx4 v[28:31], v8, s[32:35], s66 offen offset:0 sc1
    buffer_load_dwordx4 v[32:35], v8, s[32:35], s66 offen offset:1024 sc1
    buffer_load_dwordx4 v[20:23], v8, s[32:35], s66 offen offset:2048 sc1
    buffer_load_dwordx4 v[24:27], v8, s[32:35], s66 offen offset:3072 sc1
    s_waitcnt vmcnt(7)
    v_mfma_f32_16x16x32_bf16 v[84:87], v[36:39], v[80:83], 0
    v_xor_b32 v60, s51, v36
    s_waitcnt vmcnt(6)
    v_mfma_f32_16x16x32_bf16 v[84:87], v[40:43], v[80:83], v[84:87]
    v_xor_b32 v61, s51, v40
    s_waitcnt vmcnt(5)
    v_mfma_f32_16x16x32_bf16 v[84:87], v[44:47], v[80:83], v[84:87]
    v_xor_b32 v62, s51, v44
    v_or3_b32 v60, v60, v61, v62
    s_waitcnt vmcnt(4)
    v_mfma_f32_16x16x32_bf16 v[84:87], v[48:51], v[80:83], v[84:87]
    v_xor_b32 v61, s51, v48
    v_or_b32 v60, v60, v61
    v_and_b32 v60, 1, v60
    v_cmp_ne_u32 vcc, 0, v60
    s_nop 3
    v_permlane32_swap_b32 v84, v86
    v_permlane32_swap_b32 v85, v87
    v_pk_add_f32 v[84:85], v[84:85], v[86:87]
    v_cvt_pk_bf16_f32 v84, v84, v85
    v_min_u32 v60, -2, v84
    v_min_u32 v62, -2, v84
    s_nop 1
    v_permlane16_swap_b32 v60, v62
    v_mov_b32 v61, v60
    v_mov_b32 v63, v62
    s_nop 0
    v_permlane32_swap_b32 v60, v61
    v_permlane32_swap_b32 v62, v63
    s_cbranch_vccnz L_ch_pbs1
    s_branch L_ch_poks1
L_ch_abort:
    s_endpgm
.p2align 8
L_table:
.long 0x0, 0x0, 0x0, 0x0, 0x0, 0x0, 0x0, 0x0, 0x0, 0x0, 0x0, 0x0, 0x0, 0x0, 0x0, 0x0, 0x0, 0x0, 0x0, 0x0, 0x0, 0x0, 0x0, 0x0, 0x0, 0x0, 0x0, 0x0, 0x0, 0x0, 0x0, 0x0
.long 0x0, 0x0, 0x0, 0x0, 0x0, 0x0, 0x0, 0x0, 0x0, 0x0, 0x0, 0x0, 0x0, 0x0, 0x0, 0x0, 0x0, 0x0, 0x0, 0x0, 0x0, 0x0, 0x0, 0x0, 0x0, 0x0, 0x0, 0x0, 0x0, 0x0, 0x0, 0x0
.long 0xff010000, 0xff0000, 0x0, 0x0, 0x810100, 0x2000000, 0x2000040, 0x2000001, 0x2040341, 0x2000080, 0x2000081, 0x2000082, 0x2000083, 0x2050b84, 0xff, 0xff, 0xff, 0xff, 0xff, 0xff, 0xff, 0xff, 0xff, 0xff, 0x0, 0x0, 0x0, 0x0, 0x0, 0x0, 0x0, 0x0
.long 0xff010100, 0xff0100, 0x0, 0x0, 0x81010b, 0x6000009, 0x6000049, 0x600000a, 0x600004a, 0x605070b, 0x6000092, 0x6000093, 0x6000094, 0x6000095, 0x6050f96, 0xff, 0xff, 0xff, 0xff, 0xff, 0xff, 0xff, 0xff, 0xff, 0x0, 0x0, 0x0, 0x0, 0x0, 0x0, 0x0, 0x0
.long 0xff010200, 0xff0200, 0x0, 0x0, 0x810116, 0x3000054, 0x3000015, 0x3000055, 0x3040416, 0x30000a6, 0x30000a7, 0x30000a8, 0x30000a9, 0x30000aa, 0x3060cab, 0xff, 0xff, 0xff, 0xff, 0xff, 0xff, 0xff, 0xff, 0xff, 0x0, 0x0, 0x0, 0x0, 0x0, 0x0, 0x0, 0x0
.long 0xff010300, 0xff0300, 0x0, 0x0, 0x810160, 0x700005e, 0x700001f, 0x700005f, 0x7000020, 0x7050860, 0x70000b8, 0x70000b9, 0x70000ba, 0x70000bb, 0x70510bc, 0xff, 0xff, 0xff, 0xff, 0xff, 0xff, 0xff, 0xff, 0xff, 0x0, 0x0, 0x0, 0x0, 0x0, 0x0, 0x0, 0x0
.long 0xff010400, 0xff0400, 0x0, 0x0, 0x81012b, 0x400006a, 0x400002b, 0x400006b, 0x400002c, 0x405056c, 0x40000ce, 0x40000cf, 0x40000d0, 0x4040dd1, 0xff, 0xff, 0xff, 0xff, 0xff, 0xff, 0xff, 0xff, 0xff, 0xff, 0x0, 0x0, 0x0, 0x0, 0x0, 0x0, 0x0, 0x0
.long 0xff010500, 0xff0500, 0x0, 0x0, 0x810175, 0x7000034, 0x7000074, 0x7000035, 0x7000075, 0x7050836, 0x70000e0, 0x70000e1, 0x70000e2, 0x70410e3, 0xff, 0xff, 0xff, 0xff, 0xff, 0xff, 0xff, 0xff, 0xff, 0xff, 0x0, 0x0, 0x0, 0x0, 0x0, 0x0, 0x0, 0x0
.long 0x0, 0x0, 0x0, 0x0, 0x0, 0x0, 0x0, 0x0, 0x0, 0x0, 0x0, 0x0, 0x0, 0x0, 0x0, 0x0, 0x0, 0x0, 0x0, 0x0, 0x0, 0x0, 0x0, 0x0, 0x0, 0x0, 0x0, 0x0, 0x0, 0x0, 0x0, 0x0
.long 0x0, 0x0, 0x0, 0x0, 0x0, 0x0, 0x0, 0x0, 0x0, 0x0, 0x0, 0x0, 0x0, 0x0, 0x0, 0x0, 0x0, 0x0, 0x0, 0x0, 0x0, 0x0, 0x0, 0x0, 0x0, 0x0, 0x0, 0x0, 0x0, 0x0, 0x0, 0x0
.long 0xff010600, 0xff0001, 0x0, 0x0, 0x810140, 0x3000000, 0x3000040, 0x3000001, 0x3040441, 0x3000080, 0x3000081, 0x3000082, 0x3000083, 0x3050c84, 0xff, 0xff, 0xff, 0xff, 0xff, 0xff, 0xff, 0xff, 0xff, 0xff, 0x0, 0x0, 0x0, 0x0, 0x0, 0x0, 0x0, 0x0
.long 0xff010700, 0xff0101, 0x0, 0x0, 0x81014b, 0x7000009, 0x7000049, 0x700000a, 0x700004a, 0x705080b, 0x7000092, 0x7000093, 0x7000094, 0x7041095, 0xff, 0xff, 0xff, 0xff, 0xff, 0xff, 0xff, 0xff, 0xff, 0xff, 0x0, 0x0, 0x0, 0x0, 0x0, 0x0, 0x0, 0x0
.long 0xff011000, 0xff0201, 0x0, 0x0, 0x810156, 0x4000015, 0x4000055, 0x4000016, 0x4000056, 0x4050517, 0x40000a7, 0x40000a8, 0x40000a9, 0x40000aa, 0x4050dab, 0xff, 0xff, 0xff, 0xff, 0xff, 0xff, 0xff, 0xff, 0xff, 0x0, 0x0, 0x0, 0x0, 0x0, 0x0, 0x0, 0x0
.long 0xff011100, 0xff0301, 0x0, 0x0, 0x810121, 0x2000020, 0x2000060, 0x2000021, 0x2040361, 0x20000bb, 0x20000bc, 0x20000bd, 0x20000be, 0x2050bbf, 0xff, 0xff, 0xff, 0xff, 0xff, 0xff, 0xff, 0xff, 0xff, 0xff, 0x0, 0x0, 0x0, 0x0, 0x0, 0x0, 0x0, 0x0
.long 0xff011200, 0xff0401, 0x0, 0x0, 0x81016b, 0x500006a, 0x500002b, 0x500006b, 0x500002c, 0x505066c, 0x50000cf, 0x50000d0, 0x50000d1, 0x5040ed2, 0xff, 0xff, 0xff, 0xff, 0xff, 0xff, 0xff, 0xff, 0xff, 0xff, 0x0, 0x0, 0x0, 0x0, 0x0, 0x0, 0x0, 0x0
.long 0xff011300, 0xff0501, 0x0, 0x0, 0x810136, 0x2000074, 0x2000035, 0x2000075, 0x2040336, 0x20000e1, 0x20000e2, 0x20000e3, 0x20000e4, 0x2050be5, 0xff, 0xff, 0xff, 0xff, 0xff, 0xff, 0xff, 0xff, 0xff, 0xff, 0x0, 0x0, 0x0, 0x0, 0x0, 0x0, 0x0, 0x0
.long 0x0, 0x0, 0x0, 0x0, 0x0, 0x0, 0x0, 0x0, 0x0, 0x0, 0x0, 0x0, 0x0, 0x0, 0x0, 0x0, 0x0, 0x0, 0x0, 0x0, 0x0, 0x0, 0x0, 0x0, 0x0, 0x0, 0x0, 0x0, 0x0, 0x0, 0x0, 0x0
.long 0x0, 0x0, 0x0, 0x0, 0x0, 0x0, 0x0, 0x0, 0x0, 0x0, 0x0, 0x0, 0x0, 0x0, 0x0, 0x0, 0x0, 0x0, 0x0, 0x0, 0x0, 0x0, 0x0, 0x0, 0x0, 0x0, 0x0, 0x0, 0x0, 0x0, 0x0, 0x0
.long 0xff011400, 0xff0002, 0x0, 0x0, 0x810101, 0x4000000, 0x4000040, 0x4000001, 0x4040541, 0x4000080, 0x4000081, 0x4000082, 0x4000083, 0x4050d84, 0xff, 0xff, 0xff, 0xff, 0xff, 0xff, 0xff, 0xff, 0xff, 0xff, 0x0, 0x0, 0x0, 0x0, 0x0, 0x0, 0x0, 0x0
.long 0xff011500, 0xff0102, 0x0, 0x0, 0x81010c, 0x200000b, 0x200004b, 0x200000c, 0x200004c, 0x205030d, 0x2000096, 0x2000097, 0x2000098, 0x2040b99, 0xff, 0xff, 0xff, 0xff, 0xff, 0xff, 0xff, 0xff, 0xff, 0xff, 0x0, 0x0, 0x0, 0x0, 0x0, 0x0, 0x0, 0x0
.long 0xff011600, 0xff0202, 0x0, 0x0, 0x810117, 0x5000015, 0x5000055, 0x5000016, 0x5000056, 0x5050617, 0x50000a8, 0x50000a9, 0x50000aa, 0x5040eab, 0xff, 0xff, 0xff, 0xff, 0xff, 0xff, 0xff, 0xff, 0xff, 0xff, 0x0, 0x0, 0x0, 0x0, 0x0, 0x0, 0x0, 0x0
.long 0xff011700, 0xff0302, 0x0, 0x0, 0x810161, 0x3000020, 0x3000060, 0x3000021, 0x3040461, 0x30000bc, 0x30000bd, 0x30000be, 0x30000bf, 0x3050cc0, 0xff, 0xff, 0xff, 0xff, 0xff, 0xff, 0xff, 0xff, 0xff, 0xff, 0x0, 0x0, 0x0, 0x0, 0x0, 0x0, 0x0, 0x0
.long 0xff011800, 0xff0402, 0x0, 0x0, 0x81012c, 0x600006a, 0x600002b, 0x600006b, 0x600002c, 0x605076c, 0x60000cf, 0x60000d0, 0x60000d1, 0x6040fd2, 0xff, 0xff, 0xff, 0xff, 0xff, 0xff, 0xff, 0xff, 0xff, 0xff, 0x0, 0x0, 0x0, 0x0, 0x0, 0x0, 0x0, 0x0
.long 0xff011900, 0xff0502, 0x0, 0x0, 0x810176, 0x3000074, 0x3000035, 0x3000075, 0x3040436, 0x30000e1, 0x30000e2, 0x30000e3, 0x30000e4, 0x3050ce5, 0xff, 0xff, 0xff, 0xff, 0xff, 0xff, 0xff, 0xff, 0xff, 0xff, 0x0, 0x0, 0x0, 0x0, 0x0, 0x0, 0x0, 0x0
.long 0x0, 0x0, 0x0, 0x0, 0x0, 0x0, 0x0, 0x0, 0x0, 0x0, 0x0, 0x0, 0x0, 0x0, 0x0, 0x0, 0x0, 0x0, 0x0, 0x0, 0x0, 0x0, 0x0, 0x0, 0x0, 0x0, 0x0, 0x0, 0x0, 0x0, 0x0, 0x0
.long 0x0, 0x0, 0x0, 0x0, 0x0, 0x0, 0x0, 0x0, 0x0, 0x0, 0x0, 0x0, 0x0, 0x0, 0x0, 0x0, 0x0, 0x0, 0x0, 0x0, 0x0, 0x0, 0x0, 0x0, 0x0, 0x0, 0x0, 0x0, 0x0, 0x0, 0x0, 0x0
.long 0xff011a00, 0xff0003, 0x0, 0x0, 0x810141, 0x5000000, 0x5000040, 0x5000001, 0x5040641, 0x5000080, 0x5000081, 0x5000082, 0x5000083, 0x5050e84, 0xff, 0xff, 0xff, 0xff, 0xff, 0xff, 0xff, 0xff, 0xff, 0xff, 0x0, 0x0, 0x0, 0x0, 0x0, 0x0, 0x0, 0x0
.long 0xff011b00, 0xff0103, 0x0, 0x0, 0x81014c, 0x300000b, 0x300004b, 0x300000c, 0x300004c, 0x305040d, 0x3000096, 0x3000097, 0x3000098, 0x3040c99, 0xff, 0xff, 0xff, 0xff, 0xff, 0xff, 0xff, 0xff, 0xff, 0xff, 0x0, 0x0, 0x0, 0x0, 0x0, 0x0, 0x0, 0x0
.long 0xff011c00, 0xff0203, 0x0, 0x0, 0x810157, 0x6000015, 0x6000055, 0x6000016, 0x6000056, 0x6050717, 0x60000a8, 0x60000a9, 0x60000aa, 0x60000ab, 0x6050fac, 0xff, 0xff, 0xff, 0xff, 0xff, 0xff, 0xff, 0xff, 0xff, 0x0, 0x0, 0x0, 0x0, 0x0, 0x0, 0x0, 0x0
.long 0xff011d00, 0xff0303, 0x0, 0x0, 0x810122, 0x4000021, 0x4000061, 0x4000022, 0x4000062, 0x4050523, 0x40000bc, 0x40000bd, 0x40000be, 0x40000bf, 0x4050dc0, 0xff, 0xff, 0xff, 0xff, 0xff, 0xff, 0xff, 0xff, 0xff, 0x0, 0x0, 0x0, 0x0, 0x0, 0x0, 0x0, 0x0
.long 0xff011e00, 0xff0403, 0x0, 0x0, 0x81016c, 0x700006a, 0x700002b, 0x700006b, 0x700002c, 0x705086c, 0x70000ce, 0x70000cf, 0x70000d0, 0x70000d1, 0x70510d2, 0xff, 0xff, 0xff, 0xff, 0xff, 0xff, 0xff, 0xff, 0xff, 0x0, 0x0, 0x0, 0x0, 0x0, 0x0, 0x0, 0x0
.long 0xff011f00, 0xff0503, 0x0, 0x0, 0x810137, 0x4000076, 0x4000037, 0x4000077, 0x4040538, 0x40000e4, 0x40000e5, 0x40000e6, 0x40000e7, 0x4050de8, 0xff, 0xff, 0xff, 0xff, 0xff, 0xff, 0xff, 0xff, 0xff, 0xff, 0x0, 0x0, 0x0, 0x0, 0x0, 0x0, 0x0, 0x0
.long 0x0, 0x0, 0x0, 0x0, 0x0, 0x0, 0x0, 0x0, 0x0, 0x0, 0x0, 0x0, 0x0, 0x0, 0x0, 0x0, 0x0, 0x0, 0x0, 0x0, 0x0, 0x0, 0x0, 0x0, 0x0, 0x0, 0x0, 0x0, 0x0, 0x0, 0x0, 0x0
.long 0x0, 0x0, 0x0, 0x0, 0x0, 0x0, 0x0, 0x0, 0x0, 0x0, 0x0, 0x0, 0x0, 0x0, 0x0, 0x0, 0x0, 0x0, 0x0, 0x0, 0x0, 0x0, 0x0, 0x0, 0x0, 0x0, 0x0, 0x0, 0x0, 0x0, 0x0, 0x0
.long 0xff012000, 0xff0004, 0x0, 0x0, 0x810102, 0x6000000, 0x6000040, 0x6000001, 0x6040741, 0x6000080, 0x6000081, 0x6000082, 0x6000083, 0x6050f84, 0xff, 0xff, 0xff, 0xff, 0xff, 0xff, 0xff, 0xff, 0xff, 0xff, 0x0, 0x0, 0x0, 0x0, 0x0, 0x0, 0x0, 0x0
.long 0xff012100, 0xff0104, 0x0, 0x0, 0x81010d, 0x400004b, 0x400000c, 0x400004c, 0x400000d, 0x405054d, 0x4000096, 0x4000097, 0x4000098, 0x4040d99, 0xff, 0xff, 0xff, 0xff, 0xff, 0xff, 0xff, 0xff, 0xff, 0xff, 0x0, 0x0, 0x0, 0x0, 0x0, 0x0, 0x0, 0x0
.long 0xff012200, 0xff0204, 0x0, 0x0, 0x810118, 0x7000015, 0x7000055, 0x7000016, 0x7000056, 0x7050817, 0x70000a7, 0x70000a8, 0x70000a9, 0x70410aa, 0xff, 0xff, 0xff, 0xff, 0xff, 0xff, 0xff, 0xff, 0xff, 0xff, 0x0, 0x0, 0x0, 0x0, 0x0, 0x0, 0x0, 0x0
.long 0xff012300, 0xff0304, 0x0, 0x0, 0x810162, 0x5000021, 0x5000061, 0x5000022, 0x5000062, 0x5050623, 0x50000bd, 0x50000be, 0x50000bf, 0x5040ec0, 0xff, 0xff, 0xff, 0xff, 0xff, 0xff, 0xff, 0xff, 0xff, 0xff, 0x0, 0x0, 0x0, 0x0, 0x0, 0x0, 0x0, 0x0
.long 0xff012400, 0xff0404, 0x0, 0x0, 0x81012d, 0x200002b, 0x200006b, 0x200002c, 0x200006c, 0x205032d, 0x20000d1, 0x20000d2, 0x20000d3, 0x2040bd4, 0xff, 0xff, 0xff, 0xff, 0xff, 0xff, 0xff, 0xff, 0xff, 0xff, 0x0, 0x0, 0x0, 0x0, 0x0, 0x0, 0x0, 0x0
.long 0xff012500, 0xff0504, 0x0, 0x0, 0x810177, 0x5000076, 0x5000037, 0x5000077, 0x5040638, 0x50000e4, 0x50000e5, 0x50000e6, 0x50000e7, 0x5050ee8, 0xff, 0xff, 0xff, 0xff, 0xff, 0xff, 0xff, 0xff, 0xff, 0xff, 0x0, 0x0, 0x0, 0x0, 0x0, 0x0, 0x0, 0x0
.long 0x0, 0x0, 0x0, 0x0, 0x0, 0x0, 0x0, 0x0, 0x0, 0x0, 0x0, 0x0, 0x0, 0x0, 0x0, 0x0, 0x0, 0x0, 0x0, 0x0, 0x0, 0x0, 0x0, 0x0, 0x0, 0x0, 0x0, 0x0, 0x0, 0x0, 0x0, 0x0
.long 0x0, 0x0, 0x0, 0x0, 0x0, 0x0, 0x0, 0x0, 0x0, 0x0, 0x0, 0x0, 0x0, 0x0, 0x0, 0x0, 0x0, 0x0, 0x0, 0x0, 0x0, 0x0, 0x0, 0x0, 0x0, 0x0, 0x0, 0x0, 0x0, 0x0, 0x0, 0x0
.long 0xff012600, 0xff0005, 0x0, 0x0, 0x810142, 0x7000000, 0x7000040, 0x7000001, 0x7040841, 0x7000080, 0x7000081, 0x7000082, 0x7000083, 0x7051084, 0xff, 0xff, 0xff, 0xff, 0xff, 0xff, 0xff, 0xff, 0xff, 0xff, 0x0, 0x0, 0x0, 0x0, 0x0, 0x0, 0x0, 0x0
.long 0xff012700, 0xff0105, 0x0, 0x0, 0x81014d, 0x500004b, 0x500000c, 0x500004c, 0x500000d, 0x505064d, 0x5000096, 0x5000097, 0x5000098, 0x5040e99, 0xff, 0xff, 0xff, 0xff, 0xff, 0xff, 0xff, 0xff, 0xff, 0xff, 0x0, 0x0, 0x0, 0x0, 0x0, 0x0, 0x0, 0x0
.long 0xff012800, 0xff0205, 0x0, 0x0, 0x810158, 0x2000056, 0x2000017, 0x2000057, 0x2000018, 0x2050358, 0x20000ab, 0x20000ac, 0x20000ad, 0x2040bae, 0xff, 0xff, 0xff, 0xff, 0xff, 0xff, 0xff, 0xff, 0xff, 0xff, 0x0, 0x0, 0x0, 0x0, 0x0, 0x0, 0x0, 0x0
.long 0xff012900, 0xff0305, 0x0, 0x0, 0x810123, 0x6000021, 0x6000061, 0x6000022, 0x6000062, 0x6050723, 0x60000bd, 0x60000be, 0x60000bf, 0x60000c0, 0x6050fc1, 0xff, 0xff, 0xff, 0xff, 0xff, 0xff, 0xff, 0xff, 0xff, 0x0, 0x0, 0x0, 0x0, 0x0, 0x0, 0x0, 0x0
.long 0xff012a00, 0xff0405, 0x0, 0x0, 0x81016d, 0x300002b, 0x300006b, 0x300002c, 0x300006c, 0x305042d, 0x30000d1, 0x30000d2, 0x30000d3, 0x3040cd4, 0xff, 0xff, 0xff, 0xff, 0xff, 0xff, 0xff, 0xff, 0xff, 0xff, 0x0, 0x0, 0x0, 0x0, 0x0, 0x0, 0x0, 0x0
.long 0xff012b00, 0xff0505, 0x0, 0x0, 0x810138, 0x6000076, 0x6000037, 0x6000077, 0x6040738, 0x60000e4, 0x60000e5, 0x60000e6, 0x60000e7, 0x6050fe8, 0xff, 0xff, 0xff, 0xff, 0xff, 0xff, 0xff, 0xff, 0xff, 0xff, 0x0, 0x0, 0x0, 0x0, 0x0, 0x0, 0x0, 0x0
.long 0x0, 0x0, 0x0, 0x0, 0x0, 0x0, 0x0, 0x0, 0x0, 0x0, 0x0, 0x0, 0x0, 0x0, 0x0, 0x0, 0x0, 0x0, 0x0, 0x0, 0x0, 0x0, 0x0, 0x0, 0x0, 0x0, 0x0, 0x0, 0x0, 0x0, 0x0, 0x0
.long 0x0, 0x0, 0x0, 0x0, 0x0, 0x0, 0x0, 0x0, 0x0, 0x0, 0x0, 0x0, 0x0, 0x0, 0x0, 0x0, 0x0, 0x0, 0x0, 0x0, 0x0, 0x0, 0x0, 0x0, 0x0, 0x0, 0x0, 0x0, 0x0, 0x0, 0x0, 0x0
.long 0xff012c00, 0xff0006, 0x0, 0x0, 0x810103, 0x2000002, 0x2000042, 0x2000003, 0x2000043, 0x2050304, 0x2000085, 0x2000086, 0x2000087, 0x2040b88, 0xff, 0xff, 0xff, 0xff, 0xff, 0xff, 0xff, 0xff, 0xff, 0xff, 0x0, 0x0, 0x0, 0x0, 0x0, 0x0, 0x0, 0x0
.long 0xff012d00, 0xff0106, 0x0, 0x0, 0x81010e, 0x600004b, 0x600000c, 0x600004c, 0x600000d, 0x605074d, 0x6000097, 0x6000098, 0x6000099, 0x6040f9a, 0xff, 0xff, 0xff, 0xff, 0xff, 0xff, 0xff, 0xff, 0xff, 0xff, 0x0, 0x0, 0x0, 0x0, 0x0, 0x0, 0x0, 0x0
.long 0xff012e00, 0xff0206, 0x0, 0x0, 0x810119, 0x3000056, 0x3000017, 0x3000057, 0x3000018, 0x3050458, 0x30000ac, 0x30000ad, 0x30000ae, 0x3040caf, 0xff, 0xff, 0xff, 0xff, 0xff, 0xff, 0xff, 0xff, 0xff, 0xff, 0x0, 0x0, 0x0, 0x0, 0x0, 0x0, 0x0, 0x0
.long 0xff012f00, 0xff0306, 0x0, 0x0, 0x810163, 0x7000021, 0x7000061, 0x7000022, 0x7000062, 0x7050823, 0x70000bd, 0x70000be, 0x70000bf, 0x70410c0, 0xff, 0xff, 0xff, 0xff, 0xff, 0xff, 0xff, 0xff, 0xff, 0xff, 0x0, 0x0, 0x0, 0x0, 0x0, 0x0, 0x0, 0x0
.long 0xff013000, 0xff0406, 0x0, 0x0, 0x81012e, 0x400002d, 0x400006d, 0x400002e, 0x404056e, 0x40000d2, 0x40000d3, 0x40000d4, 0x40000d5, 0x40000d6, 0x4060dd7, 0xff, 0xff, 0xff, 0xff, 0xff, 0xff, 0xff, 0xff, 0xff, 0x0, 0x0, 0x0, 0x0, 0x0, 0x0, 0x0, 0x0
.long 0xff013100, 0xff0506, 0x0, 0x0, 0x810178, 0x7000076, 0x7000037, 0x7000077, 0x7040838, 0x70000e4, 0x70000e5, 0x70000e6, 0x70000e7, 0x70510e8, 0xff, 0xff, 0xff, 0xff, 0xff, 0xff, 0xff, 0xff, 0xff, 0xff, 0x0, 0x0, 0x0, 0x0, 0x0, 0x0, 0x0, 0x0
.long 0x0, 0x0, 0x0, 0x0, 0x0, 0x0, 0x0, 0x0, 0x0, 0x0, 0x0, 0x0, 0x0, 0x0, 0x0, 0x0, 0x0, 0x0, 0x0, 0x0, 0x0, 0x0, 0x0, 0x0, 0x0, 0x0, 0x0, 0x0, 0x0, 0x0, 0x0, 0x0
.long 0x0, 0x0, 0x0, 0x0, 0x0, 0x0, 0x0, 0x0, 0x0, 0x0, 0x0, 0x0, 0x0, 0x0, 0x0, 0x0, 0x0, 0x0, 0x0, 0x0, 0x0, 0x0, 0x0, 0x0, 0x0, 0x0, 0x0, 0x0, 0x0, 0x0, 0x0, 0x0
.long 0xff013200, 0xff0007, 0x0, 0x0, 0x810143, 0x3000002, 0x3000042, 0x3000003, 0x3000043, 0x3050404, 0x3000085, 0x3000086, 0x3000087, 0x3040c88, 0xff, 0xff, 0xff, 0xff, 0xff, 0xff, 0xff, 0xff, 0xff, 0xff, 0x0, 0x0, 0x0, 0x0, 0x0, 0x0, 0x0, 0x0
.long 0xff013300, 0xff0107, 0x0, 0x0, 0x81014e, 0x700004b, 0x700000c, 0x700004c, 0x700000d, 0x705084d, 0x7000096, 0x7000097, 0x7000098, 0x7000099, 0x705109a, 0xff, 0xff, 0xff, 0xff, 0xff, 0xff, 0xff, 0xff, 0xff, 0x0, 0x0, 0x0, 0x0, 0x0, 0x0, 0x0, 0x0
.long 0xff013400, 0xff0207, 0x0, 0x0, 0x810159, 0x4000057, 0x4000018, 0x4000058, 0x4000019, 0x4050559, 0x40000ac, 0x40000ad, 0x40000ae, 0x4040daf, 0xff, 0xff, 0xff, 0xff, 0xff, 0xff, 0xff, 0xff, 0xff, 0xff, 0x0, 0x0, 0x0, 0x0, 0x0, 0x0, 0x0, 0x0
.long 0xff013500, 0xff0307, 0x0, 0x0, 0x810124, 0x2000022, 0x2000062, 0x2000023, 0x2000063, 0x2050324, 0x20000c0, 0x20000c1, 0x20000c2, 0x2040bc3, 0xff, 0xff, 0xff, 0xff, 0xff, 0xff, 0xff, 0xff, 0xff, 0xff, 0x0, 0x0, 0x0, 0x0, 0x0, 0x0, 0x0, 0x0
.long 0xff013600, 0xff0407, 0x0, 0x0, 0x81016e, 0x500002d, 0x500006d, 0x500002e, 0x504066e, 0x50000d3, 0x50000d4, 0x50000d5, 0x50000d6, 0x5050ed7, 0xff, 0xff, 0xff, 0xff, 0xff, 0xff, 0xff, 0xff, 0xff, 0xff, 0x0, 0x0, 0x0, 0x0, 0x0, 0x0, 0x0, 0x0
.long 0xff013700, 0xff0507, 0x0, 0x0, 0x810139, 0x2000076, 0x2000037, 0x2000077, 0x2000038, 0x2050378, 0x20000e6, 0x20000e7, 0x20000e8, 0x2040be9, 0xff, 0xff, 0xff, 0xff, 0xff, 0xff, 0xff, 0xff, 0xff, 0xff, 0x0, 0x0, 0x0, 0x0, 0x0, 0x0, 0x0, 0x0
.long 0x0, 0x0, 0x0, 0x0, 0x0, 0x0, 0x0, 0x0, 0x0, 0x0, 0x0, 0x0, 0x0, 0x0, 0x0, 0x0, 0x0, 0x0, 0x0, 0x0, 0x0, 0x0, 0x0, 0x0, 0x0, 0x0, 0x0, 0x0, 0x0, 0x0, 0x0, 0x0
.long 0x0, 0x0, 0x0, 0x0, 0x0, 0x0, 0x0, 0x0, 0x0, 0x0, 0x0, 0x0, 0x0, 0x0, 0x0, 0x0, 0x0, 0x0, 0x0, 0x0, 0x0, 0x0, 0x0, 0x0, 0x0, 0x0, 0x0, 0x0, 0x0, 0x0, 0x0, 0x0
.long 0xff013800, 0xff0008, 0x0, 0x0, 0x810104, 0x4000002, 0x4000042, 0x4000003, 0x4000043, 0x4050504, 0x4000085, 0x4000086, 0x4000087, 0x4040d88, 0xff, 0xff, 0xff, 0xff, 0xff, 0xff, 0xff, 0xff, 0xff, 0xff, 0x0, 0x0, 0x0, 0x0, 0x0, 0x0, 0x0, 0x0
.long 0xff013900, 0xff0108, 0x0, 0x0, 0x81010f, 0x200004d, 0x200000e, 0x200004e, 0x200000f, 0x205034f, 0x200009a, 0x200009b, 0x200009c, 0x2040b9d, 0xff, 0xff, 0xff, 0xff, 0xff, 0xff, 0xff, 0xff, 0xff, 0xff, 0x0, 0x0, 0x0, 0x0, 0x0, 0x0, 0x0, 0x0
.long 0xff013a00, 0xff0208, 0x0, 0x0, 0x81011a, 0x5000057, 0x5000018, 0x5000058, 0x5000019, 0x5050659, 0x50000ac, 0x50000ad, 0x50000ae, 0x5040eaf, 0xff, 0xff, 0xff, 0xff, 0xff, 0xff, 0xff, 0xff, 0xff, 0xff, 0x0, 0x0, 0x0, 0x0, 0x0, 0x0, 0x0, 0x0
.long 0xff013b00, 0xff0308, 0x0, 0x0, 0x810164, 0x3000022, 0x3000062, 0x3000023, 0x3000063, 0x3050424, 0x30000c1, 0x30000c2, 0x30000c3, 0x3040cc4, 0xff, 0xff, 0xff, 0xff, 0xff, 0xff, 0xff, 0xff, 0xff, 0xff, 0x0, 0x0, 0x0, 0x0, 0x0, 0x0, 0x0, 0x0
.long 0xff013c00, 0xff0408, 0x0, 0x0, 0x81012f, 0x600002d, 0x600006d, 0x600002e, 0x604076e, 0x60000d3, 0x60000d4, 0x60000d5, 0x60000d6, 0x60000d7, 0x6060fd8, 0xff, 0xff, 0xff, 0xff, 0xff, 0xff, 0xff, 0xff, 0xff, 0x0, 0x0, 0x0, 0x0, 0x0, 0x0, 0x0, 0x0
.long 0xff013d00, 0xff0508, 0x0, 0x0, 0x810179, 0x3000076, 0x3000037, 0x3000077, 0x3000038, 0x3050478, 0x30000e6, 0x30000e7, 0x30000e8, 0x3040ce9, 0xff, 0xff, 0xff, 0xff, 0xff, 0xff, 0xff, 0xff, 0xff, 0xff, 0x0, 0x0, 0x0, 0x0, 0x0, 0x0, 0x0, 0x0
.long 0x0, 0x0, 0x0, 0x0, 0x0, 0x0, 0x0, 0x0, 0x0, 0x0, 0x0, 0x0, 0x0, 0x0, 0x0, 0x0, 0x0, 0x0, 0x0, 0x0, 0x0, 0x0, 0x0, 0x0, 0x0, 0x0, 0x0, 0x0, 0x0, 0x0, 0x0, 0x0
.long 0x0, 0x0, 0x0, 0x0, 0x0, 0x0, 0x0, 0x0, 0x0, 0x0, 0x0, 0x0, 0x0, 0x0, 0x0, 0x0, 0x0, 0x0, 0x0, 0x0, 0x0, 0x0, 0x0, 0x0, 0x0, 0x0, 0x0, 0x0, 0x0, 0x0, 0x0, 0x0
.long 0xff013e00, 0xff0009, 0x0, 0x0, 0x810144, 0x5000002, 0x5000042, 0x5000003, 0x5000043, 0x5050604, 0x5000085, 0x5000086, 0x5000087, 0x5040e88, 0xff, 0xff, 0xff, 0xff, 0xff, 0xff, 0xff, 0xff, 0xff, 0xff, 0x0, 0x0, 0x0, 0x0, 0x0, 0x0, 0x0, 0x0
.long 0xff013f00, 0xff0109, 0x0, 0x0, 0x81014f, 0x300004d, 0x300000e, 0x300004e, 0x300000f, 0x305044f, 0x300009a, 0x300009b, 0x300009c, 0x3040c9d, 0xff, 0xff, 0xff, 0xff, 0xff, 0xff, 0xff, 0xff, 0xff, 0xff, 0x0, 0x0, 0x0, 0x0, 0x0, 0x0, 0x0, 0x0
.long 0x1ff00, 0xff0209, 0x0, 0x0, 0x81015a, 0x6000057, 0x6000018, 0x6000058, 0x6000019, 0x6050759, 0x60000ad, 0x60000ae, 0x60000af, 0x6040fb0, 0xff, 0xff, 0xff, 0xff, 0xff, 0xff, 0xff, 0xff, 0xff, 0xff, 0x0, 0x0, 0x0, 0x0, 0x0, 0x0, 0x0, 0x0
.long 0x101ff00, 0xff0309, 0x0, 0x0, 0x810125, 0x4000063, 0x4000024, 0x4000064, 0x4040525, 0x40000c1, 0x40000c2, 0x40000c3, 0x40000c4, 0x4050dc5, 0xff, 0xff, 0xff, 0xff, 0xff, 0xff, 0xff, 0xff, 0xff, 0xff, 0x0, 0x0, 0x0, 0x0, 0x0, 0x0, 0x0, 0x0
.long 0x201ff00, 0xff0409, 0x0, 0x0, 0x81016f, 0x700002d, 0x700006d, 0x700002e, 0x704086e, 0x70000d3, 0x70000d4, 0x70000d5, 0x70000d6, 0x70510d7, 0xff, 0xff, 0xff, 0xff, 0xff, 0xff, 0xff, 0xff, 0xff, 0xff, 0x0, 0x0, 0x0, 0x0, 0x0, 0x0, 0x0, 0x0
.long 0x301ff00, 0xff0509, 0x0, 0x0, 0x81013a, 0x4000078, 0x4000039, 0x4000079, 0x400003a, 0x405057a, 0x40000e9, 0x40000ea, 0x40000eb, 0x40000ec, 0x4050ded, 0xff, 0xff, 0xff, 0xff, 0xff, 0xff, 0xff, 0xff, 0xff, 0x0, 0x0, 0x0, 0x0, 0x0, 0x0, 0x0, 0x0
.long 0x0, 0x0, 0x0, 0x0, 0x0, 0x0, 0x0, 0x0, 0x0, 0x0, 0x0, 0x0, 0x0, 0x0, 0x0, 0x0, 0x0, 0x0, 0x0, 0x0, 0x0, 0x0, 0x0, 0x0, 0x0, 0x0, 0x0, 0x0, 0x0, 0x0, 0x0, 0x0
.long 0x0, 0x0, 0x0, 0x0, 0x0, 0x0, 0x0, 0x0, 0x0, 0x0, 0x0, 0x0, 0x0, 0x0, 0x0, 0x0, 0x0, 0x0, 0x0, 0x0, 0x0, 0x0, 0x0, 0x0, 0x0, 0x0, 0x0, 0x0, 0x0, 0x0, 0x0, 0x0
.long 0x401ff00, 0xff000a, 0x0, 0x0, 0x810105, 0x6000002, 0x6000042, 0x6000003, 0x6000043, 0x6050704, 0x6000085, 0x6000086, 0x6000087, 0x6040f88, 0xff, 0xff, 0xff, 0xff, 0xff, 0xff, 0xff, 0xff, 0xff, 0xff, 0x0, 0x0, 0x0, 0x0, 0x0, 0x0, 0x0, 0x0
.long 0x501ff00, 0xff010a, 0x0, 0x0, 0x810110, 0x400000e, 0x400004e, 0x400000f, 0x400004f, 0x4050510, 0x400009a, 0x400009b, 0x400009c, 0x4040d9d, 0xff, 0xff, 0xff, 0xff, 0xff, 0xff, 0xff, 0xff, 0xff, 0xff, 0x0, 0x0, 0x0, 0x0, 0x0, 0x0, 0x0, 0x0
.long 0x601ff00, 0xff020a, 0x0, 0x0, 0x81011b, 0x7000057, 0x7000018, 0x7000058, 0x7000019, 0x7050859, 0x70000ab, 0x70000ac, 0x70000ad, 0x70000ae, 0x70510af, 0xff, 0xff, 0xff, 0xff, 0xff, 0xff, 0xff, 0xff, 0xff, 0x0, 0x0, 0x0, 0x0, 0x0, 0x0, 0x0, 0x0
.long 0x701ff00, 0xff030a, 0x0, 0x0, 0x810165, 0x5000063, 0x5000024, 0x5000064, 0x5040625, 0x50000c1, 0x50000c2, 0x50000c3, 0x50000c4, 0x50000c5, 0x5060ec6, 0xff, 0xff, 0xff, 0xff, 0xff, 0xff, 0xff, 0xff, 0xff, 0x0, 0x0, 0x0, 0x0, 0x0, 0x0, 0x0, 0x0
.long 0x801ff00, 0xff040a, 0x0, 0x0, 0x810130, 0x200006d, 0x200002e, 0x200006e, 0x200002f, 0x205036f, 0x20000d5, 0x20000d6, 0x20000d7, 0x2040bd8, 0xff, 0xff, 0xff, 0xff, 0xff, 0xff, 0xff, 0xff, 0xff, 0xff, 0x0, 0x0, 0x0, 0x0, 0x0, 0x0, 0x0, 0x0
.long 0x901ff00, 0xff050a, 0x0, 0x0, 0x81017a, 0x5000078, 0x5000039, 0x5000079, 0x500003a, 0x505067a, 0x50000e9, 0x50000ea, 0x50000eb, 0x50000ec, 0x5050eed, 0xff, 0xff, 0xff, 0xff, 0xff, 0xff, 0xff, 0xff, 0xff, 0x0, 0x0, 0x0, 0x0, 0x0, 0x0, 0x0, 0x0
.long 0x0, 0x0, 0x0, 0x0, 0x0, 0x0, 0x0, 0x0, 0x0, 0x0, 0x0, 0x0, 0x0, 0x0, 0x0, 0x0, 0x0, 0x0, 0x0, 0x0, 0x0, 0x0, 0x0, 0x0, 0x0, 0x0, 0x0, 0x0, 0x0, 0x0, 0x0, 0x0
.long 0x0, 0x0, 0x0, 0x0, 0x0, 0x0, 0x0, 0x0, 0x0, 0x0, 0x0, 0x0, 0x0, 0x0, 0x0, 0x0, 0x0, 0x0, 0x0, 0x0, 0x0, 0x0, 0x0, 0x0, 0x0, 0x0, 0x0, 0x0, 0x0, 0x0, 0x0, 0x0
.long 0xa01ff00, 0xff000b, 0x0, 0x0, 0x810145, 0x7000002, 0x7000042, 0x7000003, 0x7000043, 0x7050804, 0x7000085, 0x7000086, 0x7000087, 0x7041088, 0xff, 0xff, 0xff, 0xff, 0xff, 0xff, 0xff, 0xff, 0xff, 0xff, 0x0, 0x0, 0x0, 0x0, 0x0, 0x0, 0x0, 0x0
.long 0xb01ff00, 0xff010b, 0x0, 0x0, 0x810150, 0x500000e, 0x500004e, 0x500000f, 0x500004f, 0x5050610, 0x500009a, 0x500009b, 0x500009c, 0x500009d, 0x5050e9e, 0xff, 0xff, 0xff, 0xff, 0xff, 0xff, 0xff, 0xff, 0xff, 0x0, 0x0, 0x0, 0x0, 0x0, 0x0, 0x0, 0x0
.long 0xc01ff00, 0xff020b, 0x0, 0x0, 0x81015b, 0x2000019, 0x2000059, 0x200001a, 0x204035a, 0x20000af, 0x20000b0, 0x20000b1, 0x20000b2, 0x2050bb3, 0xff, 0xff, 0xff, 0xff, 0xff, 0xff, 0xff, 0xff, 0xff, 0xff, 0x0, 0x0, 0x0, 0x0, 0x0, 0x0, 0x0, 0x0
.long 0xd01ff00, 0xff030b, 0x0, 0x0, 0x810126, 0x6000063, 0x6000024, 0x6000064, 0x6040725, 0x60000c2, 0x60000c3, 0x60000c4, 0x60000c5, 0x6050fc6, 0xff, 0xff, 0xff, 0xff, 0xff, 0xff, 0xff, 0xff, 0xff, 0xff, 0x0, 0x0, 0x0, 0x0, 0x0, 0x0, 0x0, 0x0
.long 0xe01ff00, 0xff040b, 0x0, 0x0, 0x810170, 0x300006d, 0x300002e, 0x300006e, 0x300002f, 0x305046f, 0x30000d5, 0x30000d6, 0x30000d7, 0x3040cd8, 0xff, 0xff, 0xff, 0xff, 0xff, 0xff, 0xff, 0xff, 0xff, 0xff, 0x0, 0x0, 0x0, 0x0, 0x0, 0x0, 0x0, 0x0
.long 0xf01ff00, 0xff050b, 0x0, 0x0, 0x81013b, 0x6000078, 0x6000039, 0x6000079, 0x600003a, 0x605077a, 0x60000e9, 0x60000ea, 0x60000eb, 0x60000ec, 0x6050fed, 0xff, 0xff, 0xff, 0xff, 0xff, 0xff, 0xff, 0xff, 0xff, 0x0, 0x0, 0x0, 0x0, 0x0, 0x0, 0x0, 0x0
.long 0x0, 0x0, 0x0, 0x0, 0x0, 0x0, 0x0, 0x0, 0x0, 0x0, 0x0, 0x0, 0x0, 0x0, 0x0, 0x0, 0x0, 0x0, 0x0, 0x0, 0x0, 0x0, 0x0, 0x0, 0x0, 0x0, 0x0, 0x0, 0x0, 0x0, 0x0, 0x0
.long 0x0, 0x0, 0x0, 0x0, 0x0, 0x0, 0x0, 0x0, 0x0, 0x0, 0x0, 0x0, 0x0, 0x0, 0x0, 0x0, 0x0, 0x0, 0x0, 0x0, 0x0, 0x0, 0x0, 0x0, 0x0, 0x0, 0x0, 0x0, 0x0, 0x0, 0x0, 0x0
.long 0x1001ff00, 0xff000c, 0x0, 0x0, 0x810106, 0x2000044, 0x2000005, 0x2000045, 0x2040306, 0x2000089, 0x200008a, 0x200008b, 0x200008c, 0x2050b8d, 0xff, 0xff, 0xff, 0xff, 0xff, 0xff, 0xff, 0xff, 0xff, 0xff, 0x0, 0x0, 0x0, 0x0, 0x0, 0x0, 0x0, 0x0
.long 0x1101ff00, 0xff010c, 0x0, 0x0, 0x810111, 0x600000e, 0x600004e, 0x600000f, 0x600004f, 0x6050710, 0x600009b, 0x600009c, 0x600009d, 0x6040f9e, 0xff, 0xff, 0xff, 0xff, 0xff, 0xff, 0xff, 0xff, 0xff, 0xff, 0x0, 0x0, 0x0, 0x0, 0x0, 0x0, 0x0, 0x0
.long 0x1201ff00, 0xff020c, 0x0, 0x0, 0x81011c, 0x3000019, 0x3000059, 0x300001a, 0x304045a, 0x30000b0, 0x30000b1, 0x30000b2, 0x30000b3, 0x3050cb4, 0xff, 0xff, 0xff, 0xff, 0xff, 0xff, 0xff, 0xff, 0xff, 0xff, 0x0, 0x0, 0x0, 0x0, 0x0, 0x0, 0x0, 0x0
.long 0x1301ff00, 0xff030c, 0x0, 0x0, 0x810166, 0x7000063, 0x7000024, 0x7000064, 0x7040825, 0x70000c1, 0x70000c2, 0x70000c3, 0x70000c4, 0x70510c5, 0xff, 0xff, 0xff, 0xff, 0xff, 0xff, 0xff, 0xff, 0xff, 0xff, 0x0, 0x0, 0x0, 0x0, 0x0, 0x0, 0x0, 0x0
.long 0x1401ff00, 0xff040c, 0x0, 0x0, 0x810131, 0x400002f, 0x400006f, 0x4000030, 0x4000070, 0x4050531, 0x40000d8, 0x40000d9, 0x40000da, 0x4040ddb, 0xff, 0xff, 0xff, 0xff, 0xff, 0xff, 0xff, 0xff, 0xff, 0xff, 0x0, 0x0, 0x0, 0x0, 0x0, 0x0, 0x0, 0x0
.long 0x1501ff00, 0xff050c, 0x0, 0x0, 0x81017b, 0x7000078, 0x7000039, 0x7000079, 0x700003a, 0x705087a, 0x70000e9, 0x70000ea, 0x70000eb, 0x70000ec, 0x70510ed, 0xff, 0xff, 0xff, 0xff, 0xff, 0xff, 0xff, 0xff, 0xff, 0x0, 0x0, 0x0, 0x0, 0x0, 0x0, 0x0, 0x0
.long 0x0, 0x0, 0x0, 0x0, 0x0, 0x0, 0x0, 0x0, 0x0, 0x0, 0x0, 0x0, 0x0, 0x0, 0x0, 0x0, 0x0, 0x0, 0x0, 0x0, 0x0, 0x0, 0x0, 0x0, 0x0, 0x0, 0x0, 0x0, 0x0, 0x0, 0x0, 0x0
.long 0x0, 0x0, 0x0, 0x0, 0x0, 0x0, 0x0, 0x0, 0x0, 0x0, 0x0, 0x0, 0x0, 0x0, 0x0, 0x0, 0x0, 0x0, 0x0, 0x0, 0x0, 0x0, 0x0, 0x0, 0x0, 0x0, 0x0, 0x0, 0x0, 0x0, 0x0, 0x0
.long 0x1601ff00, 0xff000d, 0x0, 0x0, 0x810146, 0x3000044, 0x3000005, 0x3000045, 0x3040406, 0x3000089, 0x300008a, 0x300008b, 0x300008c, 0x3050c8d, 0xff, 0xff, 0xff, 0xff, 0xff, 0xff, 0xff, 0xff, 0xff, 0xff, 0x0, 0x0, 0x0, 0x0, 0x0, 0x0, 0x0, 0x0
.long 0x1701ff00, 0xff010d, 0x0, 0x0, 0x810151, 0x700000e, 0x700004e, 0x700000f, 0x700004f, 0x7050810, 0x700009b, 0x700009c, 0x700009d, 0x704109e, 0xff, 0xff, 0xff, 0xff, 0xff, 0xff, 0xff, 0xff, 0xff, 0xff, 0x0, 0x0, 0x0, 0x0, 0x0, 0x0, 0x0, 0x0
.long 0x1801ff00, 0xff020d, 0x0, 0x0, 0x81015c, 0x400001a, 0x400005a, 0x400001b, 0x404055b, 0x40000b0, 0x40000b1, 0x40000b2, 0x40000b3, 0x4050db4, 0xff, 0xff, 0xff, 0xff, 0xff, 0xff, 0xff, 0xff, 0xff, 0xff, 0x0, 0x0, 0x0, 0x0, 0x0, 0x0, 0x0, 0x0
.long 0x1901ff00, 0xff030d, 0x0, 0x0, 0x810127, 0x2000064, 0x2000025, 0x2000065, 0x2040326, 0x20000c4, 0x20000c5, 0x20000c6, 0x20000c7, 0x2050bc8, 0xff, 0xff, 0xff, 0xff, 0xff, 0xff, 0xff, 0xff, 0xff, 0xff, 0x0, 0x0, 0x0, 0x0, 0x0, 0x0, 0x0, 0x0
.long 0x1a01ff00, 0xff040d, 0x0, 0x0, 0x810171, 0x500002f, 0x500006f, 0x5000030, 0x5000070, 0x5050631, 0x50000d8, 0x50000d9, 0x50000da, 0x50000db, 0x5050edc, 0xff, 0xff, 0xff, 0xff, 0xff, 0xff, 0xff, 0xff, 0xff, 0x0, 0x0, 0x0, 0x0, 0x0, 0x0, 0x0, 0x0
.long 0x1b01ff00, 0xff050d, 0x0, 0x0, 0x81013c, 0x2000039, 0x2000079, 0x200003a, 0x204037a, 0x20000ea, 0x20000eb, 0x20000ec, 0x20000ed, 0x2050bee, 0xff, 0xff, 0xff, 0xff, 0xff, 0xff, 0xff, 0xff, 0xff, 0xff, 0x0, 0x0, 0x0, 0x0, 0x0, 0x0, 0x0, 0x0
.long 0x0, 0x0, 0x0, 0x0, 0x0, 0x0, 0x0, 0x0, 0x0, 0x0, 0x0, 0x0, 0x0, 0x0, 0x0, 0x0, 0x0, 0x0, 0x0, 0x0, 0x0, 0x0, 0x0, 0x0, 0x0, 0x0, 0x0, 0x0, 0x0, 0x0, 0x0, 0x0
.long 0x0, 0x0, 0x0, 0x0, 0x0, 0x0, 0x0, 0x0, 0x0, 0x0, 0x0, 0x0, 0x0, 0x0, 0x0, 0x0, 0x0, 0x0, 0x0, 0x0, 0x0, 0x0, 0x0, 0x0, 0x0, 0x0, 0x0, 0x0, 0x0, 0x0, 0x0, 0x0
.long 0x1c01ff00, 0xff000e, 0x0, 0x0, 0x810107, 0x4000044, 0x4000005, 0x4000045, 0x4000006, 0x4050546, 0x4000089, 0x400008a, 0x400008b, 0x400008c, 0x4050d8d, 0xff, 0xff, 0xff, 0xff, 0xff, 0xff, 0xff, 0xff, 0xff, 0x0, 0x0, 0x0, 0x0, 0x0, 0x0, 0x0, 0x0
.long 0x1d01ff00, 0xff010e, 0x0, 0x0, 0x810112, 0x2000010, 0x2000050, 0x2000011, 0x2040351, 0x200009e, 0x200009f, 0x20000a0, 0x20000a1, 0x2050ba2, 0xff, 0xff, 0xff, 0xff, 0xff, 0xff, 0xff, 0xff, 0xff, 0xff, 0x0, 0x0, 0x0, 0x0, 0x0, 0x0, 0x0, 0x0
.long 0x1e01ff00, 0xff020e, 0x0, 0x0, 0x81011d, 0x500001a, 0x500005a, 0x500001b, 0x504065b, 0x50000b0, 0x50000b1, 0x50000b2, 0x50000b3, 0x50000b4, 0x5060eb5, 0xff, 0xff, 0xff, 0xff, 0xff, 0xff, 0xff, 0xff, 0xff, 0x0, 0x0, 0x0, 0x0, 0x0, 0x0, 0x0, 0x0
.long 0x1f01ff00, 0xff030e, 0x0, 0x0, 0x810167, 0x3000064, 0x3000025, 0x3000065, 0x3040426, 0x30000c5, 0x30000c6, 0x30000c7, 0x30000c8, 0x3050cc9, 0xff, 0xff, 0xff, 0xff, 0xff, 0xff, 0xff, 0xff, 0xff, 0xff, 0x0, 0x0, 0x0, 0x0, 0x0, 0x0, 0x0, 0x0
.long 0x2001ff00, 0xff040e, 0x0, 0x0, 0x810132, 0x600002f, 0x600006f, 0x6000030, 0x6000070, 0x6050731, 0x60000d9, 0x60000da, 0x60000db, 0x6040fdc, 0xff, 0xff, 0xff, 0xff, 0xff, 0xff, 0xff, 0xff, 0xff, 0xff, 0x0, 0x0, 0x0, 0x0, 0x0, 0x0, 0x0, 0x0
.long 0x2101ff00, 0xff050e, 0x0, 0x0, 0x81017c, 0x3000039, 0x3000079, 0x300003a, 0x304047a, 0x30000ea, 0x30000eb, 0x30000ec, 0x30000ed, 0x3050cee, 0xff, 0xff, 0xff, 0xff, 0xff, 0xff, 0xff, 0xff, 0xff, 0xff, 0x0, 0x0, 0x0, 0x0, 0x0, 0x0, 0x0, 0x0
.long 0x0, 0x0, 0x0, 0x0, 0x0, 0x0, 0x0, 0x0, 0x0, 0x0, 0x0, 0x0, 0x0, 0x0, 0x0, 0x0, 0x0, 0x0, 0x0, 0x0, 0x0, 0x0, 0x0, 0x0, 0x0, 0x0, 0x0, 0x0, 0x0, 0x0, 0x0, 0x0
.long 0x0, 0x0, 0x0, 0x0, 0x0, 0x0, 0x0, 0x0, 0x0, 0x0, 0x0, 0x0, 0x0, 0x0, 0x0, 0x0, 0x0, 0x0, 0x0, 0x0, 0x0, 0x0, 0x0, 0x0, 0x0, 0x0, 0x0, 0x0, 0x0, 0x0, 0x0, 0x0
.long 0x2201ff00, 0xff000f, 0x0, 0x0, 0x810147, 0x5000044, 0x5000005, 0x5000045, 0x5000006, 0x5050646, 0x5000089, 0x500008a, 0x500008b, 0x500008c, 0x5050e8d, 0xff, 0xff, 0xff, 0xff, 0xff, 0xff, 0xff, 0xff, 0xff, 0x0, 0x0, 0x0, 0x0, 0x0, 0x0, 0x0, 0x0
.long 0x2301ff00, 0xff010f, 0x0, 0x0, 0x810152, 0x3000010, 0x3000050, 0x3000011, 0x3040451, 0x300009e, 0x300009f, 0x30000a0, 0x30000a1, 0x3050ca2, 0xff, 0xff, 0xff, 0xff, 0xff, 0xff, 0xff, 0xff, 0xff, 0xff, 0x0, 0x0, 0x0, 0x0, 0x0, 0x0, 0x0, 0x0
.long 0x2401ff00, 0xff020f, 0x0, 0x0, 0x81015d, 0x600001a, 0x600005a, 0x600001b, 0x604075b, 0x60000b1, 0x60000b2, 0x60000b3, 0x60000b4, 0x6050fb5, 0xff, 0xff, 0xff, 0xff, 0xff, 0xff, 0xff, 0xff, 0xff, 0xff, 0x0, 0x0, 0x0, 0x0, 0x0, 0x0, 0x0, 0x0
.long 0x2501ff00, 0xff030f, 0x0, 0x0, 0x810128, 0x4000065, 0x4000026, 0x4000066, 0x4000027, 0x4050567, 0x40000c6, 0x40000c7, 0x40000c8, 0x4040dc9, 0xff, 0xff, 0xff, 0xff, 0xff, 0xff, 0xff, 0xff, 0xff, 0xff, 0x0, 0x0, 0x0, 0x0, 0x0, 0x0, 0x0, 0x0
.long 0x2601ff00, 0xff040f, 0x0, 0x0, 0x810172, 0x700002f, 0x700006f, 0x7000030, 0x7000070, 0x7050831, 0x70000d8, 0x70000d9, 0x70000da, 0x70410db, 0xff, 0xff, 0xff, 0xff, 0xff, 0xff, 0xff, 0xff, 0xff, 0xff, 0x0, 0x0, 0x0, 0x0, 0x0, 0x0, 0x0, 0x0
.long 0x2701ff00, 0xff050f, 0x0, 0x0, 0x81013d, 0x400003b, 0x400007b, 0x400003c, 0x400007c, 0x405053d, 0x40000ee, 0x40000ef, 0x40000f0, 0x4040df1, 0xff, 0xff, 0xff, 0xff, 0xff, 0xff, 0xff, 0xff, 0xff, 0xff, 0x0, 0x0, 0x0, 0x0, 0x0, 0x0, 0x0, 0x0
.long 0x0, 0x0, 0x0, 0x0, 0x0, 0x0, 0x0, 0x0, 0x0, 0x0, 0x0, 0x0, 0x0, 0x0, 0x0, 0x0, 0x0, 0x0, 0x0, 0x0, 0x0, 0x0, 0x0, 0x0, 0x0, 0x0, 0x0, 0x0, 0x0, 0x0, 0x0, 0x0
.long 0x0, 0x0, 0x0, 0x0, 0x0, 0x0, 0x0, 0x0, 0x0, 0x0, 0x0, 0x0, 0x0, 0x0, 0x0, 0x0, 0x0, 0x0, 0x0, 0x0, 0x0, 0x0, 0x0, 0x0, 0x0, 0x0, 0x0, 0x0, 0x0, 0x0, 0x0, 0x0
.long 0x2801ff00, 0xff0010, 0x0, 0x0, 0x810108, 0x6000044, 0x6000005, 0x6000045, 0x6000006, 0x6050746, 0x6000089, 0x600008a, 0x600008b, 0x600008c, 0x6050f8d, 0xff, 0xff, 0xff, 0xff, 0xff, 0xff, 0xff, 0xff, 0xff, 0x0, 0x0, 0x0, 0x0, 0x0, 0x0, 0x0, 0x0
.long 0x2901ff00, 0xff0110, 0x0, 0x0, 0x810113, 0x4000050, 0x4000011, 0x4000051, 0x4040512, 0x400009e, 0x400009f, 0x40000a0, 0x40000a1, 0x40000a2, 0x4060da3, 0xff, 0xff, 0xff, 0xff, 0xff, 0xff, 0xff, 0xff, 0xff, 0x0, 0x0, 0x0, 0x0, 0x0, 0x0, 0x0, 0x0
.long 0x2a01ff00, 0xff0210, 0x0, 0x0, 0x81011e, 0x700001a, 0x700005a, 0x700001b, 0x704085b, 0x70000b0, 0x70000b1, 0x70000b2, 0x70000b3, 0x70510b4, 0xff, 0xff, 0xff, 0xff, 0xff, 0xff, 0xff, 0xff, 0xff, 0xff, 0x0, 0x0, 0x0, 0x0, 0x0, 0x0, 0x0, 0x0
.long 0x2b01ff00, 0xff0310, 0x0, 0x0, 0x810168, 0x5000065, 0x5000026, 0x5000066, 0x5000027, 0x5050667, 0x50000c7, 0x50000c8, 0x50000c9, 0x5040eca, 0xff, 0xff, 0xff, 0xff, 0xff, 0xff, 0xff, 0xff, 0xff, 0xff, 0x0, 0x0, 0x0, 0x0, 0x0, 0x0, 0x0, 0x0
.long 0x2c01ff00, 0xff0410, 0x0, 0x0, 0x810133, 0x2000030, 0x2000070, 0x2000031, 0x2040371, 0x20000d9, 0x20000da, 0x20000db, 0x20000dc, 0x2050bdd, 0xff, 0xff, 0xff, 0xff, 0xff, 0xff, 0xff, 0xff, 0xff, 0xff, 0x0, 0x0, 0x0, 0x0, 0x0, 0x0, 0x0, 0x0
.long 0x2d01ff00, 0xff0510, 0x0, 0x0, 0x81017d, 0x500003b, 0x500007b, 0x500003c, 0x500007c, 0x505063d, 0x50000ee, 0x50000ef, 0x50000f0, 0x5040ef1, 0xff, 0xff, 0xff, 0xff, 0xff, 0xff, 0xff, 0xff, 0xff, 0xff, 0x0, 0x0, 0x0, 0x0, 0x0, 0x0, 0x0, 0x0
.long 0x0, 0x0, 0x0, 0x0, 0x0, 0x0, 0x0, 0x0, 0x0, 0x0, 0x0, 0x0, 0x0, 0x0, 0x0, 0x0, 0x0, 0x0, 0x0, 0x0, 0x0, 0x0, 0x0, 0x0, 0x0, 0x0, 0x0, 0x0, 0x0, 0x0, 0x0, 0x0
.long 0x0, 0x0, 0x0, 0x0, 0x0, 0x0, 0x0, 0x0, 0x0, 0x0, 0x0, 0x0, 0x0, 0x0, 0x0, 0x0, 0x0, 0x0, 0x0, 0x0, 0x0, 0x0, 0x0, 0x0, 0x0, 0x0, 0x0, 0x0, 0x0, 0x0, 0x0, 0x0
.long 0x2e01ff00, 0xff0011, 0x0, 0x0, 0x810148, 0x7000044, 0x7000005, 0x7000045, 0x7000006, 0x7050846, 0x7000089, 0x700008a, 0x700008b, 0x700008c, 0x705108d, 0xff, 0xff, 0xff, 0xff, 0xff, 0xff, 0xff, 0xff, 0xff, 0x0, 0x0, 0x0, 0x0, 0x0, 0x0, 0x0, 0x0
.long 0x2f01ff00, 0xff0111, 0x0, 0x0, 0x810153, 0x5000050, 0x5000011, 0x5000051, 0x5040612, 0x500009f, 0x50000a0, 0x50000a1, 0x50000a2, 0x5050ea3, 0xff, 0xff, 0xff, 0xff, 0xff, 0xff, 0xff, 0xff, 0xff, 0xff, 0x0, 0x0, 0x0, 0x0, 0x0, 0x0, 0x0, 0x0
.long 0x3001ff00, 0xff0211, 0x0, 0x0, 0x81015e, 0x200001b, 0x200005b, 0x200001c, 0x200005c, 0x205031d, 0x20000b4, 0x20000b5, 0x20000b6, 0x2040bb7, 0xff, 0xff, 0xff, 0xff, 0xff, 0xff, 0xff, 0xff, 0xff, 0xff, 0x0, 0x0, 0x0, 0x0, 0x0, 0x0, 0x0, 0x0
.long 0x3101ff00, 0xff0311, 0x0, 0x0, 0x810129, 0x6000065, 0x6000026, 0x6000066, 0x6000027, 0x6050767, 0x60000c7, 0x60000c8, 0x60000c9, 0x6040fca, 0xff, 0xff, 0xff, 0xff, 0xff, 0xff, 0xff, 0xff, 0xff, 0xff, 0x0, 0x0, 0x0, 0x0, 0x0, 0x0, 0x0, 0x0
.long 0x3201ff00, 0xff0411, 0x0, 0x0, 0x810173, 0x3000030, 0x3000070, 0x3000031, 0x3040471, 0x30000d9, 0x30000da, 0x30000db, 0x30000dc, 0x3050cdd, 0xff, 0xff, 0xff, 0xff, 0xff, 0xff, 0xff, 0xff, 0xff, 0xff, 0x0, 0x0, 0x0, 0x0, 0x0, 0x0, 0x0, 0x0
.long 0x3301ff00, 0xff0511, 0x0, 0x0, 0x81013e, 0x600003b, 0x600007b, 0x600003c, 0x600007c, 0x605073d, 0x60000ee, 0x60000ef, 0x60000f0, 0x6040ff1, 0xff, 0xff, 0xff, 0xff, 0xff, 0xff, 0xff, 0xff, 0xff, 0xff, 0x0, 0x0, 0x0, 0x0, 0x0, 0x0, 0x0, 0x0
.long 0x0, 0x0, 0x0, 0x0, 0x0, 0x0, 0x0, 0x0, 0x0, 0x0, 0x0, 0x0, 0x0, 0x0, 0x0, 0x0, 0x0, 0x0, 0x0, 0x0, 0x0, 0x0, 0x0, 0x0, 0x0, 0x0, 0x0, 0x0, 0x0, 0x0, 0x0, 0x0
.long 0x0, 0x0, 0x0, 0x0, 0x0, 0x0, 0x0, 0x0, 0x0, 0x0, 0x0, 0x0, 0x0, 0x0, 0x0, 0x0, 0x0, 0x0, 0x0, 0x0, 0x0, 0x0, 0x0, 0x0, 0x0, 0x0, 0x0, 0x0, 0x0, 0x0, 0x0, 0x0
.long 0x3401ff00, 0xff0012, 0x0, 0x0, 0x810109, 0x2000046, 0x2000007, 0x2000047, 0x2000008, 0x2050348, 0x200008e, 0x200008f, 0x2000090, 0x2040b91, 0xff, 0xff, 0xff, 0xff, 0xff, 0xff, 0xff, 0xff, 0xff, 0xff, 0x0, 0x0, 0x0, 0x0, 0x0, 0x0, 0x0, 0x0
.long 0x3501ff00, 0xff0112, 0x0, 0x0, 0x810114, 0x6000050, 0x6000011, 0x6000051, 0x6040712, 0x600009f, 0x60000a0, 0x60000a1, 0x60000a2, 0x60000a3, 0x6060fa4, 0xff, 0xff, 0xff, 0xff, 0xff, 0xff, 0xff, 0xff, 0xff, 0x0, 0x0, 0x0, 0x0, 0x0, 0x0, 0x0, 0x0
.long 0x3601ff00, 0xff0212, 0x0, 0x0, 0x81011f, 0x300001b, 0x300005b, 0x300001c, 0x300005c, 0x305041d, 0x30000b5, 0x30000b6, 0x30000b7, 0x3040cb8, 0xff, 0xff, 0xff, 0xff, 0xff, 0xff, 0xff, 0xff, 0xff, 0xff, 0x0, 0x0, 0x0, 0x0, 0x0, 0x0, 0x0, 0x0
.long 0x3701ff00, 0xff0312, 0x0, 0x0, 0x810169, 0x7000065, 0x7000026, 0x7000066, 0x7000027, 0x7050867, 0x70000c6, 0x70000c7, 0x70000c8, 0x70000c9, 0x70510ca, 0xff, 0xff, 0xff, 0xff, 0xff, 0xff, 0xff, 0xff, 0xff, 0x0, 0x0, 0x0, 0x0, 0x0, 0x0, 0x0, 0x0
.long 0x3801ff00, 0xff0412, 0x0, 0x0, 0x810134, 0x4000071, 0x4000032, 0x4000072, 0x4000033, 0x4050573, 0x40000dc, 0x40000dd, 0x40000de, 0x4040ddf, 0xff, 0xff, 0xff, 0xff, 0xff, 0xff, 0xff, 0xff, 0xff, 0xff, 0x0, 0x0, 0x0, 0x0, 0x0, 0x0, 0x0, 0x0
.long 0x3901ff00, 0xff0512, 0x0, 0x0, 0x81017e, 0x700003b, 0x700007b, 0x700003c, 0x700007c, 0x705083d, 0x70000ee, 0x70000ef, 0x70000f0, 0x70410f1, 0xff, 0xff, 0xff, 0xff, 0xff, 0xff, 0xff, 0xff, 0xff, 0xff, 0x0, 0x0, 0x0, 0x0, 0x0, 0x0, 0x0, 0x0
.long 0x0, 0x0, 0x0, 0x0, 0x0, 0x0, 0x0, 0x0, 0x0, 0x0, 0x0, 0x0, 0x0, 0x0, 0x0, 0x0, 0x0, 0x0, 0x0, 0x0, 0x0, 0x0, 0x0, 0x0, 0x0, 0x0, 0x0, 0x0, 0x0, 0x0, 0x0, 0x0
.long 0x0, 0x0, 0x0, 0x0, 0x0, 0x0, 0x0, 0x0, 0x0, 0x0, 0x0, 0x0, 0x0, 0x0, 0x0, 0x0, 0x0, 0x0, 0x0, 0x0, 0x0, 0x0, 0x0, 0x0, 0x0, 0x0, 0x0, 0x0, 0x0, 0x0, 0x0, 0x0
.long 0x3a01ff00, 0xff0013, 0x0, 0x0, 0x810149, 0x3000046, 0x3000007, 0x3000047, 0x3000008, 0x3050448, 0x300008e, 0x300008f, 0x3000090, 0x3040c91, 0xff, 0xff, 0xff, 0xff, 0xff, 0xff, 0xff, 0xff, 0xff, 0xff, 0x0, 0x0, 0x0, 0x0, 0x0, 0x0, 0x0, 0x0
.long 0x3b01ff00, 0xff0113, 0x0, 0x0, 0x810154, 0x92, 0x93, 0x94, 0x95, 0x96, 0x97, 0x98, 0x99, 0x9099a, 0xff, 0xff, 0xff, 0xff, 0xff, 0xff, 0xff, 0xff, 0xff, 0xff, 0x0, 0x0, 0x0, 0x0, 0x0, 0x0, 0x0, 0x0
.long 0x3c01ff00, 0xff0213, 0x0, 0x0, 0x81015f, 0xad, 0xae, 0xaf, 0xb0, 0xb1, 0xb2, 0xb3, 0xb4, 0x909b5, 0xff, 0xff, 0xff, 0xff, 0xff, 0xff, 0xff, 0xff, 0xff, 0xff, 0x0, 0x0, 0x0, 0x0, 0x0, 0x0, 0x0, 0x0
.long 0x3d01ff00, 0xff0313, 0x0, 0x0, 0x81012a, 0xbf, 0xc0, 0xc1, 0xc2, 0xc3, 0xc4, 0xc5, 0xc6, 0x909c7, 0xff, 0xff, 0xff, 0xff, 0xff, 0xff, 0xff, 0xff, 0xff, 0xff, 0x0, 0x0, 0x0, 0x0, 0x0, 0x0, 0x0, 0x0
.long 0x3e01ff00, 0xff0413, 0x0, 0x0, 0x810174, 0xd1, 0xd2, 0xd3, 0xd4, 0xd5, 0xd6, 0xd7, 0xd8, 0x909d9, 0xff, 0xff, 0xff, 0xff, 0xff, 0xff, 0xff, 0xff, 0xff, 0xff, 0x0, 0x0, 0x0, 0x0, 0x0, 0x0, 0x0, 0x0
.long 0x3f01ff00, 0xff0513, 0x0, 0x0, 0x81013f, 0xe3, 0xe4, 0xe5, 0xe6, 0xe7, 0xe8, 0xe9, 0xea, 0x909eb, 0xff, 0xff, 0xff, 0xff, 0xff, 0xff, 0xff, 0xff, 0xff, 0xff, 0x0, 0x0, 0x0, 0x0, 0x0, 0x0, 0x0, 0x0
.long 0x0, 0x0, 0x0, 0x0, 0x0, 0x0, 0x0, 0x0, 0x0, 0x0, 0x0, 0x0, 0x0, 0x0, 0x0, 0x0, 0x0, 0x0, 0x0, 0x0, 0x0, 0x0, 0x0, 0x0, 0x0, 0x0, 0x0, 0x0, 0x0, 0x0, 0x0, 0x0
.long 0x0, 0x0, 0x0, 0x0, 0x0, 0x0, 0x0, 0x0, 0x0, 0x0, 0x0, 0x0, 0x0, 0x0, 0x0, 0x0, 0x0, 0x0, 0x0, 0x0, 0x0, 0x0, 0x0, 0x0, 0x0, 0x0, 0x0, 0x0, 0x0, 0x0, 0x0, 0x0
.long 0x4000ff00, 0xff0000, 0x0, 0x0, 0x81010a, 0x80, 0x81, 0x82, 0x83, 0x84, 0x85, 0x86, 0x87, 0x90988, 0xff, 0xff, 0xff, 0xff, 0xff, 0xff, 0xff, 0xff, 0xff, 0xff, 0x0, 0x0, 0x0, 0x0, 0x0, 0x0, 0x0, 0x0
.long 0x4100ff00, 0xff0001, 0x0, 0x0, 0x810115, 0x9b, 0x9c, 0x9d, 0x9e, 0x9f, 0xa0, 0xa1, 0xa2, 0x909a3, 0xff, 0xff, 0xff, 0xff, 0xff, 0xff, 0xff, 0xff, 0xff, 0xff, 0x0, 0x0, 0x0, 0x0, 0x0, 0x0, 0x0, 0x0
.long 0x4200ff00, 0xff0002, 0x0, 0x0, 0x810120, 0xb6, 0xb7, 0xb8, 0xb9, 0xba, 0xbb, 0xbc, 0xbd, 0x909be, 0xff, 0xff, 0xff, 0xff, 0xff, 0xff, 0xff, 0xff, 0xff, 0xff, 0x0, 0x0, 0x0, 0x0, 0x0, 0x0, 0x0, 0x0
.long 0x4300ff00, 0xff0003, 0x0, 0x0, 0x81016a, 0xc8, 0xc9, 0xca, 0xcb, 0xcc, 0xcd, 0xce, 0xcf, 0x909d0, 0xff, 0xff, 0xff, 0xff, 0xff, 0xff, 0xff, 0xff, 0xff, 0xff, 0x0, 0x0, 0x0, 0x0, 0x0, 0x0, 0x0, 0x0
.long 0x4400ff00, 0xff0004, 0x0, 0x0, 0x810135, 0xda, 0xdb, 0xdc, 0xdd, 0xde, 0xdf, 0xe0, 0xe1, 0x909e2, 0xff, 0xff, 0xff, 0xff, 0xff, 0xff, 0xff, 0xff, 0xff, 0xff, 0x0, 0x0, 0x0, 0x0, 0x0, 0x0, 0x0, 0x0
.long 0x4500ff00, 0xff0501, 0x0, 0x0, 0x81017f, 0xec, 0xed, 0xee, 0xef, 0xf0, 0xf1, 0xf2, 0xf3, 0xf4, 0xa09f5, 0xff, 0xff, 0xff, 0xff, 0xff, 0xff, 0xff, 0xff, 0xff, 0x0, 0x0, 0x0, 0x0, 0x0, 0x0, 0x0, 0x0
.long 0x0, 0x0, 0x0, 0x0, 0x0, 0x0, 0x0, 0x0, 0x0, 0x0, 0x0, 0x0, 0x0, 0x0, 0x0, 0x0, 0x0, 0x0, 0x0, 0x0, 0x0, 0x0, 0x0, 0x0, 0x0, 0x0, 0x0, 0x0, 0x0, 0x0, 0x0, 0x0
.long 0x0, 0x0, 0x0, 0x0, 0x0, 0x0, 0x0, 0x0, 0x0, 0x0, 0x0, 0x0, 0x0, 0x0, 0x0, 0x0, 0x0, 0x0, 0x0, 0x0, 0x0, 0x0, 0x0, 0x0, 0x0, 0x0, 0x0, 0x0, 0x0, 0x0, 0x0, 0x0
.long 0x4600ff00, 0xff0005, 0x0, 0x0, 0x81014a, 0x89, 0x8a, 0x8b, 0x8c, 0x8d, 0x8e, 0x8f, 0x90, 0x90991, 0xff, 0xff, 0xff, 0xff, 0xff, 0xff, 0xff, 0xff, 0xff, 0xff, 0x0, 0x0, 0x0, 0x0, 0x0, 0x0, 0x0, 0x0
.long 0x4700ff00, 0xff0006, 0x0, 0x0, 0x810155, 0xa4, 0xa5, 0xa6, 0xa7, 0xa8, 0xa9, 0xaa, 0xab, 0x909ac, 0xff, 0xff, 0xff, 0xff, 0xff, 0xff, 0xff, 0xff, 0xff, 0xff, 0x0, 0x0, 0x0, 0x0, 0x0, 0x0, 0x0, 0x0
.long 0xff000800, 0xff0502, 0x0, 0x0, 0x1000013, 0x1820253, 0x400001c, 0x400005c, 0x400001d, 0x400005d, 0x405051e, 0x40000b5, 0x40000b6, 0x40000b7, 0x4040db8, 0xff, 0xff, 0xff, 0xff, 0xff, 0xff, 0xff, 0xff, 0xff, 0x0, 0x0, 0x0, 0x0, 0x0, 0x0, 0x0, 0x0
.long 0xff000900, 0xff0007, 0x0, 0x0, 0x100001e, 0x182025e, 0x2000066, 0x2000027, 0x2000067, 0x2000028, 0x2050368, 0x20000c9, 0x20000ca, 0x2030bcb, 0xff, 0xff, 0xff, 0xff, 0xff, 0xff, 0xff, 0xff, 0xff, 0xff, 0x0, 0x0, 0x0, 0x0, 0x0, 0x0, 0x0, 0x0
.long 0xff000a00, 0xff0100, 0x0, 0x0, 0x1000069, 0x182022a, 0x5000071, 0x5000032, 0x5000072, 0x5000033, 0x5050673, 0x50000dd, 0x50000de, 0x5030edf, 0xff, 0xff, 0xff, 0xff, 0xff, 0xff, 0xff, 0xff, 0xff, 0xff, 0x0, 0x0, 0x0, 0x0, 0x0, 0x0, 0x0, 0x0
.long 0xff000b00, 0xff0101, 0x0, 0x0, 0x1000074, 0x1820235, 0x200003b, 0x200007b, 0x200003c, 0x200007c, 0x205033d, 0x20000ef, 0x20000f0, 0x2030bf1, 0xff, 0xff, 0xff, 0xff, 0xff, 0xff, 0xff, 0xff, 0xff, 0xff, 0x0, 0x0, 0x0, 0x0, 0x0, 0x0, 0x0, 0x0
.long 0x0, 0x0, 0x0, 0x0, 0x0, 0x0, 0x0, 0x0, 0x0, 0x0, 0x0, 0x0, 0x0, 0x0, 0x0, 0x0, 0x0, 0x0, 0x0, 0x0, 0x0, 0x0, 0x0, 0x0, 0x0, 0x0, 0x0, 0x0, 0x0, 0x0, 0x0, 0x0
.long 0x0, 0x0, 0x0, 0x0, 0x0, 0x0, 0x0, 0x0, 0x0, 0x0, 0x0, 0x0, 0x0, 0x0, 0x0, 0x0, 0x0, 0x0, 0x0, 0x0, 0x0, 0x0, 0x0, 0x0, 0x0, 0x0, 0x0, 0x0, 0x0, 0x0, 0x0, 0x0
.long 0xff000c00, 0xff0102, 0x0, 0x0, 0x1000000, 0x1820240, 0x4000007, 0x4000047, 0x4000008, 0x4040548, 0x400008e, 0x400008f, 0x4000090, 0x4040d91, 0xff, 0xff, 0xff, 0xff, 0xff, 0xff, 0xff, 0xff, 0xff, 0xff, 0x0, 0x0, 0x0, 0x0, 0x0, 0x0, 0x0, 0x0
.long 0xff000d00, 0xff0103, 0x0, 0x0, 0x1000009, 0x1820249, 0x7000050, 0x7000011, 0x7000051, 0x7040812, 0x700009f, 0x70000a0, 0x70000a1, 0x70410a2, 0xff, 0xff, 0xff, 0xff, 0xff, 0xff, 0xff, 0xff, 0xff, 0xff, 0x0, 0x0, 0x0, 0x0, 0x0, 0x0, 0x0, 0x0
.long 0xff000e00, 0xff0104, 0x0, 0x0, 0x1000014, 0x1820254, 0x500001c, 0x500005c, 0x500001d, 0x500005d, 0x505061e, 0x50000b6, 0x50000b7, 0x5030eb8, 0xff, 0xff, 0xff, 0xff, 0xff, 0xff, 0xff, 0xff, 0xff, 0xff, 0x0, 0x0, 0x0, 0x0, 0x0, 0x0, 0x0, 0x0
.long 0xff000f00, 0xff0105, 0x0, 0x0, 0x100001f, 0x100005f, 0x1830220, 0x3000066, 0x3000027, 0x3000067, 0x3000028, 0x3050468, 0x30000ca, 0x3020ccb, 0xff, 0xff, 0xff, 0xff, 0xff, 0xff, 0xff, 0xff, 0xff, 0xff, 0x0, 0x0, 0x0, 0x0, 0x0, 0x0, 0x0, 0x0
.long 0xff00ff00, 0x106, 0x0, 0x0, 0x100006a, 0x182022b, 0x6000071, 0x6000032, 0x6000072, 0x6000033, 0x6050773, 0x60000dd, 0x60000de, 0x6030fdf, 0xff, 0xff, 0xff, 0xff, 0xff, 0xff, 0xff, 0xff, 0xff, 0xff, 0x0, 0x0, 0x0, 0x0, 0x0, 0x0, 0x0, 0x0
.long 0xff00ff00, 0x10107, 0x0, 0x0, 0x1000075, 0x1820236, 0x300003b, 0x300007b, 0x300003c, 0x300007c, 0x305043d, 0x30000ef, 0x30000f0, 0x3030cf1, 0xff, 0xff, 0xff, 0xff, 0xff, 0xff, 0xff, 0xff, 0xff, 0xff, 0x0, 0x0, 0x0, 0x0, 0x0, 0x0, 0x0, 0x0
.long 0x0, 0x0, 0x0, 0x0, 0x0, 0x0, 0x0, 0x0, 0x0, 0x0, 0x0, 0x0, 0x0, 0x0, 0x0, 0x0, 0x0, 0x0, 0x0, 0x0, 0x0, 0x0, 0x0, 0x0, 0x0, 0x0, 0x0, 0x0, 0x0, 0x0, 0x0, 0x0
.long 0x0, 0x0, 0x0, 0x0, 0x0, 0x0, 0x0, 0x0, 0x0, 0x0, 0x0, 0x0, 0x0, 0x0, 0x0, 0x0, 0x0, 0x0, 0x0, 0x0, 0x0, 0x0, 0x0, 0x0, 0x0, 0x0, 0x0, 0x0, 0x0, 0x0, 0x0, 0x0
.long 0xff00ff00, 0x20200, 0x0, 0x0, 0x1000001, 0x1820241, 0x5000007, 0x5000047, 0x5000008, 0x5040648, 0x500008e, 0x500008f, 0x5000090, 0x5040e91, 0xff, 0xff, 0xff, 0xff, 0xff, 0xff, 0xff, 0xff, 0xff, 0xff, 0x0, 0x0, 0x0, 0x0, 0x0, 0x0, 0x0, 0x0
.long 0xff00ff00, 0x30201, 0x0, 0x0, 0x100000a, 0x182024a, 0x2000012, 0x2000052, 0x2000013, 0x2000053, 0x2050314, 0x20000a3, 0x20000a4, 0x2030ba5, 0xff, 0xff, 0xff, 0xff, 0xff, 0xff, 0xff, 0xff, 0xff, 0xff, 0x0, 0x0, 0x0, 0x0, 0x0, 0x0, 0x0, 0x0
.long 0xff00ff00, 0x40503, 0x0, 0x0, 0x1000015, 0x1820255, 0x600001c, 0x600005c, 0x600001d, 0x600005d, 0x605071e, 0x60000b6, 0x60000b7, 0x60000b8, 0x6040fb9, 0xff, 0xff, 0xff, 0xff, 0xff, 0xff, 0xff, 0xff, 0xff, 0x0, 0x0, 0x0, 0x0, 0x0, 0x0, 0x0, 0x0
.long 0xff00ff00, 0x50504, 0x0, 0x0, 0x1000060, 0x1820221, 0x4000028, 0x4000068, 0x4000029, 0x4000069, 0x405052a, 0x40000ca, 0x40000cb, 0x40000cc, 0x4040dcd, 0xff, 0xff, 0xff, 0xff, 0xff, 0xff, 0xff, 0xff, 0xff, 0x0, 0x0, 0x0, 0x0, 0x0, 0x0, 0x0, 0x0
.long 0xff00ff00, 0x60505, 0x0, 0x0, 0x100006b, 0x182022c, 0x7000071, 0x7000032, 0x7000072, 0x7000033, 0x7050873, 0x70000dc, 0x70000dd, 0x70000de, 0x70410df, 0xff, 0xff, 0xff, 0xff, 0xff, 0xff, 0xff, 0xff, 0xff, 0x0, 0x0, 0x0, 0x0, 0x0, 0x0, 0x0, 0x0
.long 0xff00ff00, 0x70506, 0x0, 0x0, 0x1000076, 0x1820237, 0x400007d, 0x400003e, 0x400007e, 0x400003f, 0x405057f, 0x40000f2, 0x40000f3, 0x40000f4, 0x4040df5, 0xff, 0xff, 0xff, 0xff, 0xff, 0xff, 0xff, 0xff, 0xff, 0x0, 0x0, 0x0, 0x0, 0x0, 0x0, 0x0, 0x0
.long 0x0, 0x0, 0x0, 0x0, 0x0, 0x0, 0x0, 0x0, 0x0, 0x0, 0x0, 0x0, 0x0, 0x0, 0x0, 0x0, 0x0, 0x0, 0x0, 0x0, 0x0, 0x0, 0x0, 0x0, 0x0, 0x0, 0x0, 0x0, 0x0, 0x0, 0x0, 0x0
.long 0x0, 0x0, 0x0, 0x0, 0x0, 0x0, 0x0, 0x0, 0x0, 0x0, 0x0, 0x0, 0x0, 0x0, 0x0, 0x0, 0x0, 0x0, 0x0, 0x0, 0x0, 0x0, 0x0, 0x0, 0x0, 0x0, 0x0, 0x0, 0x0, 0x0, 0x0, 0x0
.long 0xff00ff00, 0x80202, 0x0, 0x0, 0x1000002, 0x1820242, 0x6000007, 0x6000047, 0x6000008, 0x6040748, 0x600008e, 0x600008f, 0x6000090, 0x6040f91, 0xff, 0xff, 0xff, 0xff, 0xff, 0xff, 0xff, 0xff, 0xff, 0xff, 0x0, 0x0, 0x0, 0x0, 0x0, 0x0, 0x0, 0x0
.long 0xff00ff00, 0x90203, 0x0, 0x0, 0x100000b, 0x182024b, 0x3000012, 0x3000052, 0x3000013, 0x3000053, 0x3050414, 0x30000a3, 0x30000a4, 0x3030ca5, 0xff, 0xff, 0xff, 0xff, 0xff, 0xff, 0xff, 0xff, 0xff, 0xff, 0x0, 0x0, 0x0, 0x0, 0x0, 0x0, 0x0, 0x0
.long 0xff00ff00, 0xa0204, 0x0, 0x0, 0x1000016, 0x1820256, 0x700001c, 0x700005c, 0x700001d, 0x700005d, 0x705081e, 0x70000b5, 0x70000b6, 0x70310b7, 0xff, 0xff, 0xff, 0xff, 0xff, 0xff, 0xff, 0xff, 0xff, 0xff, 0x0, 0x0, 0x0, 0x0, 0x0, 0x0, 0x0, 0x0
.long 0xff00ff00, 0xb0507, 0x0, 0x0, 0x1000061, 0x1820222, 0x5000028, 0x5000068, 0x5000029, 0x5000069, 0x505062a, 0x50000cb, 0x50000cc, 0x50000cd, 0x5040ece, 0xff, 0xff, 0xff, 0xff, 0xff, 0xff, 0xff, 0xff, 0xff, 0x0, 0x0, 0x0, 0x0, 0x0, 0x0, 0x0, 0x0
.long 0xff00ff00, 0xc0205, 0x0, 0x0, 0x100006c, 0x182022d, 0x2000032, 0x2000072, 0x2000033, 0x2000073, 0x2050334, 0x20000de, 0x20000df, 0x2030be0, 0xff, 0xff, 0xff, 0xff, 0xff, 0xff, 0xff, 0xff, 0xff, 0xff, 0x0, 0x0, 0x0, 0x0, 0x0, 0x0, 0x0, 0x0
.long 0xff00ff00, 0xd0600, 0x0, 0x0, 0x1000077, 0x1820238, 0x500007d, 0x500003e, 0x500007e, 0x500003f, 0x505067f, 0x50000f2, 0x50000f3, 0x50000f4, 0x5040ef5, 0xff, 0xff, 0xff, 0xff, 0xff, 0xff, 0xff, 0xff, 0xff, 0x0, 0x0, 0x0, 0x0, 0x0, 0x0, 0x0, 0x0
.long 0x0, 0x0, 0x0, 0x0, 0x0, 0x0, 0x0, 0x0, 0x0, 0x0, 0x0, 0x0, 0x0, 0x0, 0x0, 0x0, 0x0, 0x0, 0x0, 0x0, 0x0, 0x0, 0x0, 0x0, 0x0, 0x0, 0x0, 0x0, 0x0, 0x0, 0x0, 0x0
.long 0x0, 0x0, 0x0, 0x0, 0x0, 0x0, 0x0, 0x0, 0x0, 0x0, 0x0, 0x0, 0x0, 0x0, 0x0, 0x0, 0x0, 0x0, 0x0, 0x0, 0x0, 0x0, 0x0, 0x0, 0x0, 0x0, 0x0, 0x0, 0x0, 0x0, 0x0, 0x0
.long 0xff00ff00, 0xe0206, 0x0, 0x0, 0x1000003, 0x1820243, 0x7000007, 0x7000047, 0x7000008, 0x7040848, 0x700008e, 0x700008f, 0x7000090, 0x7041091, 0xff, 0xff, 0xff, 0xff, 0xff, 0xff, 0xff, 0xff, 0xff, 0xff, 0x0, 0x0, 0x0, 0x0, 0x0, 0x0, 0x0, 0x0
.long 0xff00ff00, 0xf0207, 0x0, 0x0, 0x100000c, 0x182024c, 0x4000052, 0x4000013, 0x4000053, 0x4000014, 0x4050554, 0x40000a4, 0x40000a5, 0x4030da6, 0xff, 0xff, 0xff, 0xff, 0xff, 0xff, 0xff, 0xff, 0xff, 0xff, 0x0, 0x0, 0x0, 0x0, 0x0, 0x0, 0x0, 0x0
.long 0xff00ff00, 0x100300, 0x0, 0x0, 0x1000017, 0x1820257, 0x200005d, 0x200001e, 0x200005e, 0x200001f, 0x205035f, 0x20000b8, 0x20000b9, 0x2030bba, 0xff, 0xff, 0xff, 0xff, 0xff, 0xff, 0xff, 0xff, 0xff, 0xff, 0x0, 0x0, 0x0, 0x0, 0x0, 0x0, 0x0, 0x0
.long 0xff00ff00, 0x110601, 0x0, 0x0, 0x1000062, 0x1820223, 0x6000028, 0x6000068, 0x6000029, 0x6000069, 0x605072a, 0x60000cb, 0x60000cc, 0x60000cd, 0x6040fce, 0xff, 0xff, 0xff, 0xff, 0xff, 0xff, 0xff, 0xff, 0xff, 0x0, 0x0, 0x0, 0x0, 0x0, 0x0, 0x0, 0x0
.long 0xff00ff00, 0x120301, 0x0, 0x0, 0x100006d, 0x182022e, 0x3000032, 0x3000072, 0x3000033, 0x3000073, 0x3050434, 0x30000de, 0x30000df, 0x3030ce0, 0xff, 0xff, 0xff, 0xff, 0xff, 0xff, 0xff, 0xff, 0xff, 0xff, 0x0, 0x0, 0x0, 0x0, 0x0, 0x0, 0x0, 0x0
.long 0xff00ff00, 0x130602, 0x0, 0x0, 0x1000078, 0x1820239, 0x600007d, 0x600003e, 0x600007e, 0x600003f, 0x605077f, 0x60000f2, 0x60000f3, 0x60000f4, 0x6040ff5, 0xff, 0xff, 0xff, 0xff, 0xff, 0xff, 0xff, 0xff, 0xff, 0x0, 0x0, 0x0, 0x0, 0x0, 0x0, 0x0, 0x0
.long 0x0, 0x0, 0x0, 0x0, 0x0, 0x0, 0x0, 0x0, 0x0, 0x0, 0x0, 0x0, 0x0, 0x0, 0x0, 0x0, 0x0, 0x0, 0x0, 0x0, 0x0, 0x0, 0x0, 0x0, 0x0, 0x0, 0x0, 0x0, 0x0, 0x0, 0x0, 0x0
.long 0x0, 0x0, 0x0, 0x0, 0x0, 0x0, 0x0, 0x0, 0x0, 0x0, 0x0, 0x0, 0x0, 0x0, 0x0, 0x0, 0x0, 0x0, 0x0, 0x0, 0x0, 0x0, 0x0, 0x0, 0x0, 0x0, 0x0, 0x0, 0x0, 0x0, 0x0, 0x0
.long 0xff00ff00, 0x140302, 0x0, 0x0, 0x1000004, 0x1820244, 0x2000009, 0x2000049, 0x200000a, 0x204034a, 0x2000092, 0x2000093, 0x2000094, 0x2040b95, 0xff, 0xff, 0xff, 0xff, 0xff, 0xff, 0xff, 0xff, 0xff, 0xff, 0x0, 0x0, 0x0, 0x0, 0x0, 0x0, 0x0, 0x0
.long 0xff00ff00, 0x150603, 0x0, 0x0, 0x100000d, 0x182024d, 0x5000052, 0x5000013, 0x5000053, 0x5000014, 0x5050654, 0x50000a4, 0x50000a5, 0x50000a6, 0x5040ea7, 0xff, 0xff, 0xff, 0xff, 0xff, 0xff, 0xff, 0xff, 0xff, 0x0, 0x0, 0x0, 0x0, 0x0, 0x0, 0x0, 0x0
.long 0xff00ff00, 0x160303, 0x0, 0x0, 0x1000018, 0x1820258, 0x300005d, 0x300001e, 0x300005e, 0x300001f, 0x305045f, 0x30000b9, 0x30000ba, 0x3030cbb, 0xff, 0xff, 0xff, 0xff, 0xff, 0xff, 0xff, 0xff, 0xff, 0xff, 0x0, 0x0, 0x0, 0x0, 0x0, 0x0, 0x0, 0x0
.long 0xff00ff00, 0x170304, 0x0, 0x0, 0x1000063, 0x1820224, 0x7000028, 0x7000068, 0x7000029, 0x7000069, 0x705082a, 0x70000cb, 0x70000cc, 0x70310cd, 0xff, 0xff, 0xff, 0xff, 0xff, 0xff, 0xff, 0xff, 0xff, 0xff, 0x0, 0x0, 0x0, 0x0, 0x0, 0x0, 0x0, 0x0
.long 0xff00ff00, 0x180604, 0x0, 0x0, 0x100006e, 0x182022f, 0x4000034, 0x4000074, 0x4000035, 0x4000075, 0x4050536, 0x40000e0, 0x40000e1, 0x40000e2, 0x4040de3, 0xff, 0xff, 0xff, 0xff, 0xff, 0xff, 0xff, 0xff, 0xff, 0x0, 0x0, 0x0, 0x0, 0x0, 0x0, 0x0, 0x0
.long 0xff00ff00, 0x190605, 0x0, 0x0, 0x1000079, 0x182023a, 0x700007d, 0x700003e, 0x700007e, 0x700003f, 0x705087f, 0x70000f2, 0x70000f3, 0x70000f4, 0x70410f5, 0xff, 0xff, 0xff, 0xff, 0xff, 0xff, 0xff, 0xff, 0xff, 0x0, 0x0, 0x0, 0x0, 0x0, 0x0, 0x0, 0x0
.long 0x0, 0x0, 0x0, 0x0, 0x0, 0x0, 0x0, 0x0, 0x0, 0x0, 0x0, 0x0, 0x0, 0x0, 0x0, 0x0, 0x0, 0x0, 0x0, 0x0, 0x0, 0x0, 0x0, 0x0, 0x0, 0x0, 0x0, 0x0, 0x0, 0x0, 0x0, 0x0
.long 0x0, 0x0, 0x0, 0x0, 0x0, 0x0, 0x0, 0x0, 0x0, 0x0, 0x0, 0x0, 0x0, 0x0, 0x0, 0x0, 0x0, 0x0, 0x0, 0x0, 0x0, 0x0, 0x0, 0x0, 0x0, 0x0, 0x0, 0x0, 0x0, 0x0, 0x0, 0x0
.long 0xff00ff00, 0x1a0305, 0x0, 0x0, 0x1000005, 0x1820245, 0x3000009, 0x3000049, 0x300000a, 0x304044a, 0x3000092, 0x3000093, 0x3000094, 0x3040c95, 0xff, 0xff, 0xff, 0xff, 0xff, 0xff, 0xff, 0xff, 0xff, 0xff, 0x0, 0x0, 0x0, 0x0, 0x0, 0x0, 0x0, 0x0
.long 0xff00ff00, 0x1b0306, 0x0, 0x0, 0x100000e, 0x182024e, 0x6000052, 0x6000013, 0x6000053, 0x6000014, 0x6050754, 0x60000a5, 0x60000a6, 0x6030fa7, 0xff, 0xff, 0xff, 0xff, 0xff, 0xff, 0xff, 0xff, 0xff, 0xff, 0x0, 0x0, 0x0, 0x0, 0x0, 0x0, 0x0, 0x0
.long 0xff00ff00, 0x1c0307, 0x0, 0x0, 0x1000019, 0x1820259, 0x400005e, 0x400001f, 0x400005f, 0x4000020, 0x4050560, 0x40000b9, 0x40000ba, 0x4030dbb, 0xff, 0xff, 0xff, 0xff, 0xff, 0xff, 0xff, 0xff, 0xff, 0xff, 0x0, 0x0, 0x0, 0x0, 0x0, 0x0, 0x0, 0x0
.long 0xff00ff00, 0x1d0606, 0x0, 0x0, 0x1000064, 0x1820225, 0x2000029, 0x2000069, 0x200002a, 0x204036a, 0x20000cc, 0x20000cd, 0x20000ce, 0x20000cf, 0x2050bd0, 0xff, 0xff, 0xff, 0xff, 0xff, 0xff, 0xff, 0xff, 0xff, 0x0, 0x0, 0x0, 0x0, 0x0, 0x0, 0x0, 0x0
.long 0xff00ff00, 0x1e0607, 0x0, 0x0, 0x100006f, 0x1820230, 0x5000034, 0x5000074, 0x5000035, 0x5000075, 0x5050636, 0x50000e0, 0x50000e1, 0x50000e2, 0x5040ee3, 0xff, 0xff, 0xff, 0xff, 0xff, 0xff, 0xff, 0xff, 0xff, 0x0, 0x0, 0x0, 0x0, 0x0, 0x0, 0x0, 0x0
.long 0xff00ff00, 0x1f0700, 0x0, 0x0, 0x100007a, 0x182023b, 0x200007d, 0x200003e, 0x200007e, 0x200003f, 0x205037f, 0x20000f2, 0x20000f3, 0x20000f4, 0x2040bf5, 0xff, 0xff, 0xff, 0xff, 0xff, 0xff, 0xff, 0xff, 0xff, 0x0, 0x0, 0x0, 0x0, 0x0, 0x0, 0x0, 0x0
.long 0x0, 0x0, 0x0, 0x0, 0x0, 0x0, 0x0, 0x0, 0x0, 0x0, 0x0, 0x0, 0x0, 0x0, 0x0, 0x0, 0x0, 0x0, 0x0, 0x0, 0x0, 0x0, 0x0, 0x0, 0x0, 0x0, 0x0, 0x0, 0x0, 0x0, 0x0, 0x0
.long 0x0, 0x0, 0x0, 0x0, 0x0, 0x0, 0x0, 0x0, 0x0, 0x0, 0x0, 0x0, 0x0, 0x0, 0x0, 0x0, 0x0, 0x0, 0x0, 0x0, 0x0, 0x0, 0x0, 0x0, 0x0, 0x0, 0x0, 0x0, 0x0, 0x0, 0x0, 0x0
.long 0xff00ff00, 0x200701, 0x0, 0x0, 0x1000006, 0x1820246, 0x4000009, 0x4000049, 0x400000a, 0x400004a, 0x405050b, 0x4000092, 0x4000093, 0x4000094, 0x4040d95, 0xff, 0xff, 0xff, 0xff, 0xff, 0xff, 0xff, 0xff, 0xff, 0x0, 0x0, 0x0, 0x0, 0x0, 0x0, 0x0, 0x0
.long 0xff00ff00, 0x210702, 0x0, 0x0, 0x100000f, 0x182024f, 0x7000052, 0x7000013, 0x7000053, 0x7000014, 0x7050854, 0x70000a3, 0x70000a4, 0x70000a5, 0x70410a6, 0xff, 0xff, 0xff, 0xff, 0xff, 0xff, 0xff, 0xff, 0xff, 0x0, 0x0, 0x0, 0x0, 0x0, 0x0, 0x0, 0x0
.long 0xff00ff00, 0x220703, 0x0, 0x0, 0x100001a, 0x182025a, 0x500005e, 0x500001f, 0x500005f, 0x5000020, 0x5050660, 0x50000b9, 0x50000ba, 0x50000bb, 0x5040ebc, 0xff, 0xff, 0xff, 0xff, 0xff, 0xff, 0xff, 0xff, 0xff, 0x0, 0x0, 0x0, 0x0, 0x0, 0x0, 0x0, 0x0
.long 0xff00ff00, 0x230704, 0x0, 0x0, 0x1000065, 0x1820226, 0x3000029, 0x3000069, 0x300002a, 0x304046a, 0x30000cc, 0x30000cd, 0x30000ce, 0x30000cf, 0x3050cd0, 0xff, 0xff, 0xff, 0xff, 0xff, 0xff, 0xff, 0xff, 0xff, 0x0, 0x0, 0x0, 0x0, 0x0, 0x0, 0x0, 0x0
.long 0xff00ff00, 0x240705, 0x0, 0x0, 0x1000070, 0x1820231, 0x6000034, 0x6000074, 0x6000035, 0x6000075, 0x6050736, 0x60000e0, 0x60000e1, 0x60000e2, 0x6040fe3, 0xff, 0xff, 0xff, 0xff, 0xff, 0xff, 0xff, 0xff, 0xff, 0x0, 0x0, 0x0, 0x0, 0x0, 0x0, 0x0, 0x0
.long 0xff00ff00, 0x250706, 0x0, 0x0, 0x100007b, 0x182023c, 0x300007d, 0x300003e, 0x300007e, 0x300003f, 0x305047f, 0x30000f2, 0x30000f3, 0x30000f4, 0x3040cf5, 0xff, 0xff, 0xff, 0xff, 0xff, 0xff, 0xff, 0xff, 0xff, 0x0, 0x0, 0x0, 0x0, 0x0, 0x0, 0x0, 0x0
.long 0x0, 0x0, 0x0, 0x0, 0x0, 0x0, 0x0, 0x0, 0x0, 0x0, 0x0, 0x0, 0x0, 0x0, 0x0, 0x0, 0x0, 0x0, 0x0, 0x0, 0x0, 0x0, 0x0, 0x0, 0x0, 0x0, 0x0, 0x0, 0x0, 0x0, 0x0, 0x0
.long 0x0, 0x0, 0x0, 0x0, 0x0, 0x0, 0x0, 0x0, 0x0, 0x0, 0x0, 0x0, 0x0, 0x0, 0x0, 0x0, 0x0, 0x0, 0x0, 0x0, 0x0, 0x0, 0x0, 0x0, 0x0, 0x0, 0x0, 0x0, 0x0, 0x0, 0x0, 0x0
.long 0xff00ff00, 0x260707, 0x0, 0x0, 0x1000007, 0x1820247, 0x5000009, 0x5000049, 0x500000a, 0x500004a, 0x505060b, 0x5000092, 0x5000093, 0x5000094, 0x5040e95, 0xff, 0xff, 0xff, 0xff, 0xff, 0xff, 0xff, 0xff, 0xff, 0x0, 0x0, 0x0, 0x0, 0x0, 0x0, 0x0, 0x0
.long 0xff02ff00, 0x270000, 0x0, 0x0, 0x1000010, 0x1820250, 0x2000054, 0x2000015, 0x2000055, 0x2040316, 0x20000a6, 0x20000a7, 0x20000a8, 0x20000a9, 0x2050baa, 0xff, 0xff, 0xff, 0xff, 0xff, 0xff, 0xff, 0xff, 0xff, 0x0, 0x0, 0x0, 0x0, 0x0, 0x0, 0x0, 0x0
.long 0x4800ff00, 0xff0400, 0x0, 0x0, 0x100001b, 0x182025b, 0x600005e, 0x600001f, 0x600005f, 0x6000020, 0x6050760, 0x60000ba, 0x60000bb, 0x6030fbc, 0xff, 0xff, 0xff, 0xff, 0xff, 0xff, 0xff, 0xff, 0xff, 0xff, 0x0, 0x0, 0x0, 0x0, 0x0, 0x0, 0x0, 0x0
.long 0x4900ff00, 0xff0401, 0x0, 0x0, 0x1000066, 0x1820227, 0x10000aa, 0x10000ab, 0x10000ac, 0x10000ad, 0x10000ae, 0x10000af, 0x10000b0, 0x1080ab1, 0xff, 0xff, 0xff, 0xff, 0xff, 0xff, 0xff, 0xff, 0xff, 0xff, 0x0, 0x0, 0x0, 0x0, 0x0, 0x0, 0x0, 0x0
.long 0x4a00ff00, 0xff0402, 0x0, 0x0, 0x1000071, 0x1820232, 0x10000c3, 0x10000c4, 0x10000c5, 0x10000c6, 0x10000c7, 0x10000c8, 0x10000c9, 0x1080aca, 0xff, 0xff, 0xff, 0xff, 0xff, 0xff, 0xff, 0xff, 0xff, 0xff, 0x0, 0x0, 0x0, 0x0, 0x0, 0x0, 0x0, 0x0
.long 0x4b02ff00, 0xff0000, 0x0, 0x0, 0x100007c, 0x182023d, 0x10000dc, 0x10000dd, 0x10000de, 0x10000df, 0x10000e0, 0x10000e1, 0x10000e2, 0x10000e3, 0x1090ae4, 0xff, 0xff, 0xff, 0xff, 0xff, 0xff, 0xff, 0xff, 0xff, 0x0, 0x0, 0x0, 0x0, 0x0, 0x0, 0x0, 0x0
.long 0x0, 0x0, 0x0, 0x0, 0x0, 0x0, 0x0, 0x0, 0x0, 0x0, 0x0, 0x0, 0x0, 0x0, 0x0, 0x0, 0x0, 0x0, 0x0, 0x0, 0x0, 0x0, 0x0, 0x0, 0x0, 0x0, 0x0, 0x0, 0x0, 0x0, 0x0, 0x0
.long 0x0, 0x0, 0x0, 0x0, 0x0, 0x0, 0x0, 0x0, 0x0, 0x0, 0x0, 0x0, 0x0, 0x0, 0x0, 0x0, 0x0, 0x0, 0x0, 0x0, 0x0, 0x0, 0x0, 0x0, 0x0, 0x0, 0x0, 0x0, 0x0, 0x0, 0x0, 0x0
.long 0x4c00ff00, 0xff0403, 0x0, 0x0, 0x1000008, 0x1820248, 0x1000080, 0x1000081, 0x1000082, 0x1000083, 0x1000084, 0x1000085, 0x1000086, 0x1080a87, 0xff, 0xff, 0xff, 0xff, 0xff, 0xff, 0xff, 0xff, 0xff, 0xff, 0x0, 0x0, 0x0, 0x0, 0x0, 0x0, 0x0, 0x0
.long 0x4d00ff00, 0xff0404, 0x0, 0x0, 0x1000011, 0x1820251, 0x1000088, 0x1000089, 0x100008a, 0x100008b, 0x100008c, 0x100008d, 0x100008e, 0x1080a8f, 0xff, 0xff, 0xff, 0xff, 0xff, 0xff, 0xff, 0xff, 0xff, 0xff, 0x0, 0x0, 0x0, 0x0, 0x0, 0x0, 0x0, 0x0
.long 0x4e00ff00, 0xff0405, 0x0, 0x0, 0x100001c, 0x182025c, 0x1000099, 0x100009a, 0x100009b, 0x100009c, 0x100009d, 0x100009e, 0x100009f, 0x1080aa0, 0xff, 0xff, 0xff, 0xff, 0xff, 0xff, 0xff, 0xff, 0xff, 0xff, 0x0, 0x0, 0x0, 0x0, 0x0, 0x0, 0x0, 0x0
.long 0x4f02ff00, 0xff0000, 0x0, 0x0, 0x1000067, 0x1820228, 0x10000b2, 0x10000b3, 0x10000b4, 0x10000b5, 0x10000b6, 0x10000b7, 0x10000b8, 0x10000b9, 0x1090aba, 0xff, 0xff, 0xff, 0xff, 0xff, 0xff, 0xff, 0xff, 0xff, 0x0, 0x0, 0x0, 0x0, 0x0, 0x0, 0x0, 0x0
.long 0xff02ff00, 0xff0000, 0x0, 0x0, 0x1000072, 0x1820233, 0x10000cb, 0x10000cc, 0x10000cd, 0x10000ce, 0x10000cf, 0x10000d0, 0x10000d1, 0x10000d2, 0x1090ad3, 0xff, 0xff, 0xff, 0xff, 0xff, 0xff, 0xff, 0xff, 0xff, 0x0, 0x0, 0x0, 0x0, 0x0, 0x0, 0x0, 0x0
.long 0xff00ff00, 0xff0406, 0x0, 0x0, 0x100007d, 0x182023e, 0x10000e5, 0x10000e6, 0x10000e7, 0x10000e8, 0x10000e9, 0x10000ea, 0x10000eb, 0x1080aec, 0xff, 0xff, 0xff, 0xff, 0xff, 0xff, 0xff, 0xff, 0xff, 0xff, 0x0, 0x0, 0x0, 0x0, 0x0, 0x0, 0x0, 0x0
.long 0x0, 0x0, 0x0, 0x0, 0x0, 0x0, 0x0, 0x0, 0x0, 0x0, 0x0, 0x0, 0x0, 0x0, 0x0, 0x0, 0x0, 0x0, 0x0, 0x0, 0x0, 0x0, 0x0, 0x0, 0x0, 0x0, 0x0, 0x0, 0x0, 0x0, 0x0, 0x0
.long 0x0, 0x0, 0x0, 0x0, 0x0, 0x0, 0x0, 0x0, 0x0, 0x0, 0x0, 0x0, 0x0, 0x0, 0x0, 0x0, 0x0, 0x0, 0x0, 0x0, 0x0, 0x0, 0x0, 0x0, 0x0, 0x0, 0x0, 0x0, 0x0, 0x0, 0x0, 0x0
.long 0xff03ff00, 0xff0000, 0x0, 0x0, 0xff, 0xff, 0xff, 0xff, 0xff, 0xff, 0xff, 0xff, 0xff, 0xff, 0xff, 0xff, 0xff, 0xff, 0xff, 0xff, 0xff, 0xff, 0xff, 0xff, 0x0, 0x0, 0x0, 0x0, 0x0, 0x0, 0x0, 0x0
.long 0xff02ff00, 0xff0000, 0x0, 0x0, 0x1000012, 0x1820252, 0x1000090, 0x1000091, 0x1000092, 0x1000093, 0x1000094, 0x1000095, 0x1000096, 0x1000097, 0x1090a98, 0xff, 0xff, 0xff, 0xff, 0xff, 0xff, 0xff, 0xff, 0xff, 0x0, 0x0, 0x0, 0x0, 0x0, 0x0, 0x0, 0x0
.long 0xff02ff00, 0xff0000, 0x0, 0x0, 0x100001d, 0x182025d, 0x10000a1, 0x10000a2, 0x10000a3, 0x10000a4, 0x10000a5, 0x10000a6, 0x10000a7, 0x10000a8, 0x1090aa9, 0xff, 0xff, 0xff, 0xff, 0xff, 0xff, 0xff, 0xff, 0xff, 0x0, 0x0, 0x0, 0x0, 0x0, 0x0, 0x0, 0x0
.long 0xff00ff00, 0xff0407, 0x0, 0x0, 0x1000068, 0x1820229, 0x10000bb, 0x10000bc, 0x10000bd, 0x10000be, 0x10000bf, 0x10000c0, 0x10000c1, 0x1080ac2, 0xff, 0xff, 0xff, 0xff, 0xff, 0xff, 0xff, 0xff, 0xff, 0xff, 0x0, 0x0, 0x0, 0x0, 0x0, 0x0, 0x0, 0x0
.long 0xff00ff00, 0xff0500, 0x0, 0x0, 0x1000073, 0x1820234, 0x10000d4, 0x10000d5, 0x10000d6, 0x10000d7, 0x10000d8, 0x10000d9, 0x10000da, 0x1080adb, 0xff, 0xff, 0xff, 0xff, 0xff, 0xff, 0xff, 0xff, 0xff, 0xff, 0x0, 0x0, 0x0, 0x0, 0x0, 0x0, 0x0, 0x0
.long 0xff02ff00, 0xff0000, 0x0, 0x0, 0x100007e, 0x100003f, 0x183027f, 0x10000ed, 0x10000ee, 0x10000ef, 0x10000f0, 0x10000f1, 0x10000f2, 0x10000f3, 0x10000f4, 0x1090af5, 0xff, 0xff, 0xff, 0xff, 0xff, 0xff, 0xff, 0xff, 0x0, 0x0, 0x0, 0x0, 0x0, 0x0, 0x0, 0x0
.section .rodata,"a"
.p2align 6
.amdhsa_kernel parallel_sum__memory_aug_recurrent_mem_tr__glu_gated_glu__prompt_kernel
  .amdhsa_next_free_vgpr 512
  .amdhsa_next_free_sgpr 102
  .amdhsa_accum_offset 256
  .amdhsa_group_segment_fixed_size 0
  .amdhsa_kernarg_size 112
  .amdhsa_user_sgpr_count 2
  .amdhsa_user_sgpr_kernarg_segment_ptr 1
  .amdhsa_system_sgpr_workgroup_id_x 1
  .amdhsa_float_denorm_mode_32 3
.end_amdhsa_kernel
```
